```python
import torch

def _softmax(x, axis=-1):
    return torch.softmax(x, dim=axis)
def _gelu(x):
    return torch.nn.functional.gelu(x, approximate="tanh")
def _silu(x):
    return torch.nn.functional.silu(x)
def _sigmoid(x):
    return torch.sigmoid(x)
def _layernorm(x, axis=-1, eps=1e-5):
    m = x.mean(dim=axis, keepdim=True)
    v = x.var(dim=axis, keepdim=True, unbiased=False)
    return (x - m) / torch.sqrt(v + eps)
def _scatter_add(tgt, idx, src, axis=0):
    return tgt.clone().index_add_(axis, idx, src)
def _segment_sum(src, seg, n):
    out = torch.zeros((n,) + src.shape[1:], dtype=src.dtype)
    return out.index_add_(0, seg, src)
def _pad(x, pw):
    flat = tuple(v for pair in reversed(pw) for v in pair)
    return torch.nn.functional.pad(x, flat)

kernel_name = 'concat_heads__gqa_block_cached__mha_block_cached__near_ridge'

def setup_inputs():

    _w = (lambda a: (lambda t: t.to(torch.bfloat16) if t.is_floating_point() else t)(torch.as_tensor(a)))
    def _A_setup():
        B, Sq, D = 8, 128, 448
        Hq, Hkv, Sk, Dh = 16, 8, 1024, 256
        assert Hq % Hkv == 0, (Hq, Hkv)
        return {
            "x": _w((lambda *s: torch.randn(*s, dtype=torch.bfloat16) * 0.8)(B, Sq, D)),
            "k_cache": _w((lambda *s: torch.randn(*s, dtype=torch.bfloat16) * 0.8)(B, Hkv, Sk, Dh)),
            "v_cache": _w((lambda *s: torch.randn(*s, dtype=torch.bfloat16) * 0.05)(B, Hkv, Sk, Dh)),
            "wq": _w((lambda *s: torch.randn(*s, dtype=torch.bfloat16) * 0.8)(D, Hq * Dh) * (D ** -0.5)),
            "wo": _w((lambda *s: torch.randn(*s, dtype=torch.bfloat16) * 0.05)(Hq * Dh, D) * ((Hq * Dh) ** -0.5)),
        }
    _A_in = _A_setup()

    def _B_setup():
        B, Sq, D = 8, 128, 448
        H, Sk, Dh = 16, 1024, 256
        return {
            "x": _w((lambda *s: torch.randn(*s, dtype=torch.bfloat16) * 0.8)(B, Sq, D)),
            "k_cache": _w((lambda *s: torch.randn(*s, dtype=torch.bfloat16) * 0.8)(B, H, Sk, Dh)),
            "v_cache": _w((lambda *s: torch.randn(*s, dtype=torch.bfloat16) * 0.05)(B, H, Sk, Dh)),
            "wq": _w((lambda *s: torch.randn(*s, dtype=torch.bfloat16) * 0.8)(D, H * Dh) * (D ** -0.5)),
            "wo": _w((lambda *s: torch.randn(*s, dtype=torch.bfloat16) * 0.05)(H * Dh, D) * ((H * Dh) ** -0.5)),
        }
    _B_in = _B_setup()

    return {
        "A_x": _A_in["x"],
        "A_k_cache": _A_in["k_cache"],
        "A_v_cache": _A_in["v_cache"],
        "A_wq": _A_in["wq"],
        "A_wo": _A_in["wo"],
        "B_x": _B_in["x"],
        "B_k_cache": _B_in["k_cache"],
        "B_v_cache": _B_in["v_cache"],
        "B_wq": _B_in["wq"],
        "B_wo": _B_in["wo"],
    }

def reference(A_x, A_k_cache, A_v_cache, A_wq, A_wo, B_x, B_k_cache, B_v_cache, B_wq, B_wo):
    def _A_ref(x, k_cache, v_cache, wq, wo):
        B, Sq, D = x.shape
        Hq, Dh = 16, 256
        Hkv = k_cache.shape[1]
        rep = Hq // Hkv
        q = (lambda x, *d: x.permute(*d))((x @ wq).reshape(B, Sq, Hq, Dh), 0, 2, 1, 3)
        k = (lambda x, n, axis: torch.repeat_interleave(x, n, dim=axis))(k_cache, rep, axis=1)
        v = (lambda x, n, axis: torch.repeat_interleave(x, n, dim=axis))(v_cache, rep, axis=1)
        scores = torch.einsum("bhqd,bhkd->bhqk", q, k) * (Dh ** -0.5)
        p = _softmax(scores, axis=-1)
        o = torch.einsum("bhqk,bhkd->bhqd", p, v)
        return (lambda x, *d: x.permute(*d))(o, 0, 2, 1, 3).reshape(B, Sq, Hq * Dh) @ wo

    def _B_ref(x, k_cache, v_cache, wq, wo):
        B, Sq, D = x.shape
        H, Dh = 16, 256
        q = (lambda x, *d: x.permute(*d))((x @ wq).reshape(B, Sq, H, Dh), 0, 2, 1, 3)
        scores = torch.einsum("bhqd,bhkd->bhqk", q, k_cache) * (Dh ** -0.5)
        p = _softmax(scores, axis=-1)
        o = torch.einsum("bhqk,bhkd->bhqd", p, v_cache)
        return (lambda x, *d: x.permute(*d))(o, 0, 2, 1, 3).reshape(B, Sq, H * Dh) @ wo

    a = _A_ref(A_x, A_k_cache, A_v_cache, A_wq, A_wo)
    b = _B_ref(B_x, B_k_cache, B_v_cache, B_wq, B_wo)
    return torch.concatenate([a, b], axis=-1)
```

```asm
; @launch grid=(256,1,1) block=(256,1,1) lds=163840
.amdgcn_target "amdgcn-amd-amdhsa--gfx950"
.text
.globl concat_heads__gqa_block_cached__mha_block_cached__near_ridge_kernel
.p2align 8
.type concat_heads__gqa_block_cached__mha_block_cached__near_ridge_kernel,@function
concat_heads__gqa_block_cached__mha_block_cached__near_ridge_kernel:
    s_cmp_ge_u32 s2, 256
    s_cbranch_scc1 L_end
    s_load_dwordx16 s[4:19], s[0:1], 0
    s_load_dwordx8 s[20:27], s[0:1], 64
    s_load_dwordx2 s[28:29], s[0:1], 96
    s_getpc_b64 s[90:91]
L_pc:
    s_bfe_u32 s63, s2, 0x30003
    v_lshrrev_b32 v1, 6, v0
    v_and_b32 v58, 15, v0
    s_lshl_b32 s69, s63, 13
    v_lshl_add_u32 v59, v1, 4, v58
    v_lshl_add_u32 v59, v59, 7, s69
    v_min_u32 v59, (L_codeend-L_pc-4), v59
    v_readfirstlane_b32 s61, v1
    global_load_dword a255, v59, s[90:91]
    s_and_b32 s30, s2, 7
    s_lshr_b32 s62, s2, 7
    s_bfe_u32 s3, s2, 0x10006
    s_lshl_b32 s64, s30, 1
    s_add_u32 s64, s64, s3
    s_lshl_b32 s60, s61, 12
    s_and_b32 s68, s63, 3
    s_lshl_b32 s68, s68, 1
    v_and_b32 v2, 63, v0
    v_lshrrev_b32 v5, 3, v2
    v_and_b32 v6, 7, v2
    v_lshrrev_b32 v7, 4, v2
    v_lshl_add_u32 v60, v1, 5, v5
    v_mul_u32_u24 v60, 896, v60
    v_xor_b32 v59, v6, v7
    v_lshl_add_u32 v38, v59, 4, v60
    v_xor_b32 v59, 4, v59
    v_lshl_add_u32 v39, v59, 4, v60
    v_add_u32 v40, 12288, v38
    v_add_u32 v41, 18432, v39
    v_add_u32 v39, 6144, v39
    s_mul_i32 s70, s63, 114688
    s_mov_b32 s34, 114688
    s_mov_b32 s35, 0x20000
    s_lshl_b32 s31, s64, 9
    s_sub_u32 s46, 3670016, s31
    s_mov_b32 s47, 0x20000
    v_lshrrev_b32 v3, 5, v2
    v_and_b32 v4, 31, v2
    v_lshl_add_u32 v5, v1, 3, v3
    v_and_b32 v61, 1, v1
    v_lshl_add_u32 v61, v61, 2, v3
    v_lshlrev_b32 v61, 1, v61
    v_xor_b32 v61, v61, v4
    v_lshlrev_b32 v61, 4, v61
    v_xor_b32 v59, 64, v61
    v_lshl_add_u32 v34, v5, 13, v61
    v_lshl_add_u32 v35, v5, 13, v59
    v_add_u32 v36, 30720, v34
    v_add_u32 v37, 46080, v35
    v_add_u32 v35, 15360, v35
    s_cmp_eq_u32 s62, 0
    s_waitcnt lgkmcnt(0)
    s_cselect_b32 s32, s4, s14
    s_cselect_b32 s33, s5, s15
    s_cselect_b32 s44, s10, s20
    s_cselect_b32 s45, s11, s21
    s_add_u32 s32, s32, s70
    s_addc_u32 s33, s33, 0
    s_add_u32 s44, s44, s31
    s_addc_u32 s45, s45, 0
    s_lshl_b32 s69, s68, 7
    s_add_u32 m0, s60, 131072
    s_nop 0
    buffer_load_dwordx4 v38, s[32:35], s69 offen offset:0 lds
    buffer_load_dwordx4 v39, s[32:35], s69 offen offset:1024 lds
    buffer_load_dwordx4 v40, s[32:35], s69 offen offset:2048 lds
    buffer_load_dwordx4 v41, s[32:35], s69 offen offset:3072 lds
    s_lshl_b32 s70, s68, 19
    s_add_u32 m0, s60, 98304
    s_nop 0
    buffer_load_dwordx4 v34, s[44:47], s70 offen offset:0 lds
    buffer_load_dwordx4 v35, s[44:47], s70 offen offset:1024 lds
    buffer_load_dwordx4 v36, s[44:47], s70 offen offset:2048 lds
    buffer_load_dwordx4 v37, s[44:47], s70 offen offset:3072 lds
    s_add_u32 s70, s70, 0x40000
    s_add_u32 m0, s60, 114688
    s_nop 0
    buffer_load_dwordx4 v34, s[44:47], s70 offen offset:0 lds
    buffer_load_dwordx4 v35, s[44:47], s70 offen offset:1024 lds
    buffer_load_dwordx4 v36, s[44:47], s70 offen offset:2048 lds
    buffer_load_dwordx4 v37, s[44:47], s70 offen offset:3072 lds
    s_add_u32 s68, s68, 1
    s_cmp_eq_u32 s68, 7
    s_cselect_b32 s68, 0, s68
    s_lshl_b32 s69, s68, 7
    s_add_u32 m0, s60, 147456
    s_nop 0
    buffer_load_dwordx4 v38, s[32:35], s69 offen offset:0 lds
    buffer_load_dwordx4 v39, s[32:35], s69 offen offset:1024 lds
    buffer_load_dwordx4 v40, s[32:35], s69 offen offset:2048 lds
    buffer_load_dwordx4 v41, s[32:35], s69 offen offset:3072 lds
    s_sub_u32 s74, s63, 7
    s_min_u32 s74, s74, s63
    v_lshl_add_u32 v32, v5, 9, v61
    v_lshl_add_u32 v33, v5, 9, v59
    v_lshl_add_u32 v61, v1, 2, v3
    v_xor_b32 v61, v61, v4
    v_lshlrev_b32 v61, 4, v61
    v_xor_b32 v59, 32, v61
    v_lshl_add_u32 v30, v5, 9, v61
    v_lshl_add_u32 v31, v5, 9, v59
    v_lshlrev_b32 v59, 1, v7
    v_xor_b32 v59, v59, v6
    v_lshl_add_u32 v42, v59, 4, v60
    v_add_u32 v43, 6144, v42
    v_add_u32 v44, 12288, v42
    v_add_u32 v45, 18432, v42
    v_lshlrev_b32 v50, 4, v2
    s_lshl_b32 s65, s62, 3
    s_add_u32 s65, s65, s63
    s_lshl_b32 s69, s63, 3
    s_add_u32 s69, s69, s30
    s_lshl_b32 s31, s63, 4
    s_add_u32 s31, s31, s64
    s_cmp_eq_u32 s62, 0
    s_cselect_b32 s31, s69, s31
    s_cselect_b32 s36, s6, s16
    s_cselect_b32 s37, s7, s17
    s_cselect_b32 s40, s8, s18
    s_cselect_b32 s41, s9, s19
    s_cselect_b32 s48, s12, s22
    s_cselect_b32 s49, s13, s23
    s_lshl_b32 s31, s31, 19
    s_add_u32 s36, s36, s31
    s_addc_u32 s37, s37, 0
    s_mov_b32 s38, 0x80000
    s_mov_b32 s39, 0x20000
    s_add_u32 s40, s40, s31
    s_addc_u32 s41, s41, 0
    s_mov_b32 s42, 0x80000
    s_mov_b32 s43, 0x20000
    s_mul_i32 s69, s64, 229376
    s_add_u32 s48, s48, s69
    s_addc_u32 s49, s49, 0
    s_mov_b32 s50, 229376
    s_mov_b32 s51, 0x20000
    s_mul_i32 s69, s65, 1835008
    s_add_u32 s69, s69, 16777216
    s_add_u32 s52, s28, s69
    s_addc_u32 s53, s29, 0
    s_mov_b32 s54, 1835008
    s_mov_b32 s55, 0x20000
    s_mov_b32 s56, s24
    s_mov_b32 s57, s25
    s_mov_b32 s58, 1835008
    s_mov_b32 s59, 0x20000
    s_mul_i32 s76, s64, 114688
    s_mul_i32 s69, s61, 28672
    s_add_u32 s76, s76, s69
    s_lshl_b32 s69, s65, 12
    s_add_u32 s69, s69, 1048576
    s_add_u32 s80, s28, s69
    s_addc_u32 s81, s29, 0
    s_bfe_u32 s66, s31, 0x10016
    s_lshl_b32 s66, s66, 18
    s_bfe_u32 s67, s31, 0x10016
    s_lshl_b32 s67, s67, 18
    s_cmp_eq_u32 s62, 0
    s_cselect_b32 s66, s66, s67
    s_bfe_u32 s67, s31, 0x13
    s_lshl_b32 s67, s67, 0
    s_add_u32 s66, s66, s67
    s_mov_b32 s67, s66
    s_mov_b32 s82, 0x3db8aa3b
    s_mov_b32 s83, s82
    s_mov_b32 s72, 0x48800000
    s_lshl_b32 s88, s65, 4
    s_mov_b32 s89, 1
    s_mov_b32 s100, 0x3f80
    s_mov_b32 s101, 0x3f800000
    s_lshl_b32 s69, s64, 8
    v_lshl_add_u32 v52, v4, 2, s69
    s_lshl_b32 s69, s64, 2
    v_lshl_add_u32 v53, v58, 8, s69
    v_mov_b32 v55, 0
    v_mov_b32 v56, s88
    v_mov_b32 v54, 1
    v_bfe_u32 v5, v2, 2, 2
    v_and_b32 v6, 3, v2
    v_lshl_add_u32 v59, v7, 3, v5
    v_lshlrev_b32 v59, 9, v59
    v_lshl_add_u32 v59, v6, 3, v59
    v_and_b32 v60, 1, v7
    v_lshl_add_u32 v60, v60, 2, v5
    v_xor_b32 v61, 0, v60
    v_lshl_add_u32 v20, v61, 5, v59
    v_add_u32 v12, 0x10000, v20
    v_xor_b32 v61, 1, v60
    v_lshl_add_u32 v21, v61, 5, v59
    v_add_u32 v13, 0x10000, v21
    v_xor_b32 v61, 2, v60
    v_lshl_add_u32 v22, v61, 5, v59
    v_add_u32 v14, 0x10000, v22
    v_xor_b32 v61, 3, v60
    v_lshl_add_u32 v23, v61, 5, v59
    v_add_u32 v15, 0x10000, v23
    v_xor_b32 v61, 4, v60
    v_lshl_add_u32 v24, v61, 5, v59
    v_add_u32 v16, 0x10000, v24
    v_xor_b32 v61, 5, v60
    v_lshl_add_u32 v25, v61, 5, v59
    v_add_u32 v17, 0x10000, v25
    v_xor_b32 v61, 6, v60
    v_lshl_add_u32 v26, v61, 5, v59
    v_add_u32 v18, 0x10000, v26
    v_xor_b32 v61, 7, v60
    v_lshl_add_u32 v27, v61, 5, v59
    v_add_u32 v19, 0x10000, v27
    v_lshrrev_b32 v59, 1, v58
    v_xor_b32 v59, v59, v7
    v_lshlrev_b32 v60, 7, v58
    v_lshl_add_u32 v60, v1, 12, v60
    v_add_u32 v60, 0x20000, v60
    v_lshl_add_u32 v28, v59, 4, v60
    v_xor_b32 v29, 64, v28
    s_lshl_b32 s70, s68, 19
    s_add_u32 m0, s60, 65536
    s_nop 0
    buffer_load_dwordx4 v34, s[44:47], s70 offen offset:0 lds
    buffer_load_dwordx4 v35, s[44:47], s70 offen offset:1024 lds
    buffer_load_dwordx4 v36, s[44:47], s70 offen offset:2048 lds
    buffer_load_dwordx4 v37, s[44:47], s70 offen offset:3072 lds
    s_waitcnt vmcnt(12)
    s_barrier
    ds_read_b128 a[128:131], v28 offset:0
    ds_read_b128 a[132:135], v28 offset:2048
    ds_read_b128 a[136:139], v29 offset:0
    ds_read_b128 a[140:143], v29 offset:2048
    ds_read_b64_tr_b16 a[64:65], v12 offset:32768
    ds_read_b64_tr_b16 a[66:67], v12 offset:34816
    ds_read_b64_tr_b16 a[68:69], v13 offset:32768
    ds_read_b64_tr_b16 a[70:71], v13 offset:34816
    s_waitcnt lgkmcnt(2)
    v_mfma_f32_16x16x32_bf16 v[128:131], a[64:67], a[128:131], 0
    s_add_u32 s70, s70, 0x40000
    s_add_u32 m0, s60, 32768
    ds_read_b64_tr_b16 a[72:73], v14 offset:32768
    v_mfma_f32_16x16x32_bf16 v[132:135], a[64:67], a[132:135], 0
    s_waitcnt lgkmcnt(1)
    ds_read_b64_tr_b16 a[74:75], v14 offset:34816
    v_mfma_f32_16x16x32_bf16 v[136:139], a[68:71], a[128:131], 0
    ds_read_b64_tr_b16 a[76:77], v15 offset:32768
    v_mfma_f32_16x16x32_bf16 v[140:143], a[68:71], a[132:135], 0
    s_waitcnt lgkmcnt(1)
    ds_read_b64_tr_b16 a[78:79], v15 offset:34816
    buffer_load_dwordx4 v34, s[44:47], s70 offen offset:0 lds
    v_mfma_f32_16x16x32_bf16 v[144:147], a[72:75], a[128:131], 0
    s_add_u32 s30, s74, 0
    ds_read_b64_tr_b16 a[80:81], v16 offset:32768
    v_mfma_f32_16x16x32_bf16 v[148:151], a[72:75], a[132:135], 0
    s_waitcnt lgkmcnt(1)
    ds_read_b64_tr_b16 a[82:83], v16 offset:34816
    buffer_load_dwordx4 v35, s[44:47], s70 offen offset:1024 lds
    v_mfma_f32_16x16x32_bf16 v[152:155], a[76:79], a[128:131], 0
    s_sub_u32 s31, s30, 7
    ds_read_b64_tr_b16 a[84:85], v17 offset:32768
    v_mfma_f32_16x16x32_bf16 v[156:159], a[76:79], a[132:135], 0
    s_waitcnt lgkmcnt(1)
    ds_read_b64_tr_b16 a[86:87], v17 offset:34816
    buffer_load_dwordx4 v36, s[44:47], s70 offen offset:2048 lds
    v_mfma_f32_16x16x32_bf16 v[160:163], a[80:83], a[128:131], 0
    s_min_u32 s30, s30, s31
    ds_read_b64_tr_b16 a[88:89], v18 offset:32768
    v_mfma_f32_16x16x32_bf16 v[164:167], a[80:83], a[132:135], 0
    s_waitcnt lgkmcnt(1)
    ds_read_b64_tr_b16 a[90:91], v18 offset:34816
    buffer_load_dwordx4 v37, s[44:47], s70 offen offset:3072 lds
    v_mfma_f32_16x16x32_bf16 v[168:171], a[84:87], a[128:131], 0
    s_add_u32 s68, s68, 1
    s_cmp_eq_u32 s68, 7
    s_cselect_b32 s68, 0, s68
    s_lshl_b32 s70, s68, 19
    s_add_u32 m0, s60, 81920
    v_mfma_f32_16x16x32_bf16 v[172:175], a[84:87], a[132:135], 0
    s_waitcnt lgkmcnt(0)
    ds_read_b64_tr_b16 a[92:93], v19 offset:32768
    ds_read_b64_tr_b16 a[94:95], v19 offset:34816
    v_mfma_f32_16x16x32_bf16 v[176:179], a[88:91], a[128:131], 0
    s_lshl_b32 s4, s30, 7
    ds_read_b64_tr_b16 a[96:97], v12 offset:33024
    v_mfma_f32_16x16x32_bf16 v[180:183], a[88:91], a[132:135], 0
    s_waitcnt lgkmcnt(1)
    ds_read_b64_tr_b16 a[98:99], v12 offset:35072
    buffer_load_dwordx4 v34, s[44:47], s70 offen offset:0 lds
    v_mfma_f32_16x16x32_bf16 v[184:187], a[92:95], a[128:131], 0
    s_add_u32 s5, s4, 114688
    ds_read_b64_tr_b16 a[100:101], v13 offset:33024
    v_mfma_f32_16x16x32_bf16 v[188:191], a[92:95], a[132:135], 0
    s_waitcnt lgkmcnt(1)
    ds_read_b64_tr_b16 a[102:103], v13 offset:35072
    v_mfma_f32_16x16x32_bf16 v[192:195], a[96:99], a[128:131], 0
    s_lshl_b32 s30, s30, 12
    ds_read_b64_tr_b16 a[104:105], v14 offset:33024
    v_mfma_f32_16x16x32_bf16 v[196:199], a[96:99], a[132:135], 0
    s_waitcnt lgkmcnt(1)
    ds_read_b64_tr_b16 a[106:107], v14 offset:35072
    buffer_load_dwordx4 v35, s[44:47], s70 offen offset:1024 lds
    v_mfma_f32_16x16x32_bf16 v[200:203], a[100:103], a[128:131], 0
    s_add_u32 s18, s30, s76
    ds_read_b64_tr_b16 a[108:109], v15 offset:33024
    v_mfma_f32_16x16x32_bf16 v[204:207], a[100:103], a[132:135], 0
    s_waitcnt lgkmcnt(1)
    ds_read_b64_tr_b16 a[110:111], v15 offset:35072
    buffer_load_dwordx4 v36, s[44:47], s70 offen offset:2048 lds
    v_mfma_f32_16x16x32_bf16 v[208:211], a[104:107], a[128:131], 0
    s_add_u32 s30, s74, 1
    ds_read_b64_tr_b16 a[112:113], v16 offset:33024
    v_mfma_f32_16x16x32_bf16 v[212:215], a[104:107], a[132:135], 0
    s_waitcnt lgkmcnt(1)
    ds_read_b64_tr_b16 a[114:115], v16 offset:35072
    buffer_load_dwordx4 v37, s[44:47], s70 offen offset:3072 lds
    v_mfma_f32_16x16x32_bf16 v[216:219], a[108:111], a[128:131], 0
    s_sub_u32 s31, s30, 7
    ds_read_b64_tr_b16 a[116:117], v17 offset:33024
    v_mfma_f32_16x16x32_bf16 v[220:223], a[108:111], a[132:135], 0
    s_waitcnt vmcnt(16) lgkmcnt(1)
    ds_read_b64_tr_b16 a[118:119], v17 offset:35072
    v_mfma_f32_16x16x32_bf16 v[224:227], a[112:115], a[128:131], 0
    s_barrier
    s_lshl_b32 s69, s68, 7
    s_add_u32 s70, s70, 0x40000
    s_add_u32 m0, s60, 49152
    v_mfma_f32_16x16x32_bf16 v[228:231], a[112:115], a[132:135], 0
    s_waitcnt lgkmcnt(0)
    ds_read_b64_tr_b16 a[120:121], v18 offset:33024
    ds_read_b64_tr_b16 a[122:123], v18 offset:35072
    v_mfma_f32_16x16x32_bf16 v[232:235], a[116:119], a[128:131], 0
    s_min_u32 s30, s30, s31
    ds_read_b64_tr_b16 a[124:125], v19 offset:33024
    v_mfma_f32_16x16x32_bf16 v[236:239], a[116:119], a[132:135], 0
    s_waitcnt lgkmcnt(1)
    ds_read_b64_tr_b16 a[126:127], v19 offset:35072
    buffer_load_dwordx4 v34, s[44:47], s70 offen offset:0 lds
    v_mfma_f32_16x16x32_bf16 v[240:243], a[120:123], a[128:131], 0
    s_lshl_b32 s6, s30, 7
    ds_read_b64_tr_b16 a[64:65], v12 offset:49152
    v_mfma_f32_16x16x32_bf16 v[244:247], a[120:123], a[132:135], 0
    s_waitcnt lgkmcnt(1)
    ds_read_b64_tr_b16 a[66:67], v12 offset:51200
    v_mfma_f32_16x16x32_bf16 v[248:251], a[124:127], a[128:131], 0
    s_add_u32 s7, s6, 114688
    ds_read_b64_tr_b16 a[68:69], v13 offset:49152
    v_mfma_f32_16x16x32_bf16 v[252:255], a[124:127], a[132:135], 0
    s_waitcnt lgkmcnt(1)
    ds_read_b64_tr_b16 a[70:71], v13 offset:51200
    buffer_load_dwordx4 v35, s[44:47], s70 offen offset:1024 lds
    v_mfma_f32_16x16x32_bf16 v[128:131], a[64:67], a[136:139], v[128:131]
    s_lshl_b32 s30, s30, 12
    ds_read_b64_tr_b16 a[72:73], v14 offset:49152
    v_mfma_f32_16x16x32_bf16 v[132:135], a[64:67], a[140:143], v[132:135]
    s_waitcnt lgkmcnt(1)
    ds_read_b64_tr_b16 a[74:75], v14 offset:51200
    s_cmp_lg_u32 s61, 0
    s_cbranch_scc1 L_noclr
    s_mov_b32 exec_hi, 0
    global_atomic_swap v63, v52, v55, s[80:81] sc0
    s_mov_b64 exec, -1
L_noclr:
    v_mfma_f32_16x16x32_bf16 v[136:139], a[68:71], a[136:139], v[136:139]
    s_add_u32 s19, s30, s76
    ds_read_b64_tr_b16 a[76:77], v15 offset:49152
    v_mfma_f32_16x16x32_bf16 v[140:143], a[68:71], a[140:143], v[140:143]
    s_waitcnt lgkmcnt(1)
    ds_read_b64_tr_b16 a[78:79], v15 offset:51200
    buffer_load_dwordx4 v36, s[44:47], s70 offen offset:2048 lds
    v_mfma_f32_16x16x32_bf16 v[144:147], a[72:75], a[136:139], v[144:147]
    s_add_u32 s30, s74, 2
    ds_read_b64_tr_b16 a[80:81], v16 offset:49152
    v_mfma_f32_16x16x32_bf16 v[148:151], a[72:75], a[140:143], v[148:151]
    s_waitcnt lgkmcnt(1)
    ds_read_b64_tr_b16 a[82:83], v16 offset:51200
    v_mfma_f32_16x16x32_bf16 v[152:155], a[76:79], a[136:139], v[152:155]
    s_sub_u32 s31, s30, 7
    ds_read_b64_tr_b16 a[84:85], v17 offset:49152
    v_mfma_f32_16x16x32_bf16 v[156:159], a[76:79], a[140:143], v[156:159]
    s_waitcnt lgkmcnt(1)
    ds_read_b64_tr_b16 a[86:87], v17 offset:51200
    buffer_load_dwordx4 v37, s[44:47], s70 offen offset:3072 lds
    v_mfma_f32_16x16x32_bf16 v[160:163], a[80:83], a[136:139], v[160:163]
    s_add_u32 s68, s68, 1
    s_cmp_eq_u32 s68, 7
    s_cselect_b32 s68, 0, s68
    s_add_u32 m0, s60, 131072
    v_mfma_f32_16x16x32_bf16 v[164:167], a[80:83], a[140:143], v[164:167]
    s_waitcnt lgkmcnt(0)
    ds_read_b64_tr_b16 a[88:89], v18 offset:49152
    ds_read_b64_tr_b16 a[90:91], v18 offset:51200
    v_mfma_f32_16x16x32_bf16 v[168:171], a[84:87], a[136:139], v[168:171]
    s_min_u32 s30, s30, s31
    ds_read_b64_tr_b16 a[92:93], v19 offset:49152
    v_mfma_f32_16x16x32_bf16 v[172:175], a[84:87], a[140:143], v[172:175]
    s_waitcnt lgkmcnt(1)
    ds_read_b64_tr_b16 a[94:95], v19 offset:51200
    buffer_load_dwordx4 v38, s[32:35], s69 offen offset:0 lds
    v_mfma_f32_16x16x32_bf16 v[176:179], a[88:91], a[136:139], v[176:179]
    s_lshl_b32 s8, s30, 7
    ds_read_b64_tr_b16 a[96:97], v12 offset:49408
    v_mfma_f32_16x16x32_bf16 v[180:183], a[88:91], a[140:143], v[180:183]
    s_waitcnt lgkmcnt(1)
    ds_read_b64_tr_b16 a[98:99], v12 offset:51456
    v_mfma_f32_16x16x32_bf16 v[184:187], a[92:95], a[136:139], v[184:187]
    s_add_u32 s9, s8, 114688
    ds_read_b64_tr_b16 a[100:101], v13 offset:49408
    v_mfma_f32_16x16x32_bf16 v[188:191], a[92:95], a[140:143], v[188:191]
    s_waitcnt lgkmcnt(1)
    ds_read_b64_tr_b16 a[102:103], v13 offset:51456
    buffer_load_dwordx4 v39, s[32:35], s69 offen offset:1024 lds
    v_mfma_f32_16x16x32_bf16 v[192:195], a[96:99], a[136:139], v[192:195]
    s_lshl_b32 s30, s30, 12
    ds_read_b64_tr_b16 a[104:105], v14 offset:49408
    v_mfma_f32_16x16x32_bf16 v[196:199], a[96:99], a[140:143], v[196:199]
    s_waitcnt lgkmcnt(1)
    ds_read_b64_tr_b16 a[106:107], v14 offset:51456
    v_mfma_f32_16x16x32_bf16 v[200:203], a[100:103], a[136:139], v[200:203]
    s_add_u32 s20, s30, s76
    ds_read_b64_tr_b16 a[108:109], v15 offset:49408
    v_mfma_f32_16x16x32_bf16 v[204:207], a[100:103], a[140:143], v[204:207]
    s_waitcnt lgkmcnt(1)
    ds_read_b64_tr_b16 a[110:111], v15 offset:51456
    buffer_load_dwordx4 v40, s[32:35], s69 offen offset:2048 lds
    v_mfma_f32_16x16x32_bf16 v[208:211], a[104:107], a[136:139], v[208:211]
    s_add_u32 s30, s74, 3
    ds_read_b64_tr_b16 a[112:113], v16 offset:49408
    v_mfma_f32_16x16x32_bf16 v[212:215], a[104:107], a[140:143], v[212:215]
    s_waitcnt lgkmcnt(1)
    ds_read_b64_tr_b16 a[114:115], v16 offset:51456
    v_mfma_f32_16x16x32_bf16 v[216:219], a[108:111], a[136:139], v[216:219]
    s_sub_u32 s31, s30, 7
    ds_read_b64_tr_b16 a[116:117], v17 offset:49408
    v_mfma_f32_16x16x32_bf16 v[220:223], a[108:111], a[140:143], v[220:223]
    s_waitcnt vmcnt(15) lgkmcnt(1)
    ds_read_b64_tr_b16 a[118:119], v17 offset:51456
    buffer_load_dwordx4 v41, s[32:35], s69 offen offset:3072 lds
    v_mfma_f32_16x16x32_bf16 v[224:227], a[112:115], a[136:139], v[224:227]
    s_barrier
    s_add_u32 m0, s60, 0
    ds_read_b64_tr_b16 a[120:121], v18 offset:49408
    v_mfma_f32_16x16x32_bf16 v[228:231], a[112:115], a[140:143], v[228:231]
    s_waitcnt lgkmcnt(1)
    ds_read_b64_tr_b16 a[122:123], v18 offset:51456
    ds_read_b128 a[144:147], v28 offset:16384
    v_mfma_f32_16x16x32_bf16 v[232:235], a[116:119], a[136:139], v[232:235]
    s_min_u32 s30, s30, s31
    ds_read_b64_tr_b16 a[124:125], v19 offset:49408
    ds_read_b64_tr_b16 a[126:127], v19 offset:51456
    v_mfma_f32_16x16x32_bf16 v[236:239], a[116:119], a[140:143], v[236:239]
    s_waitcnt lgkmcnt(3)
    ds_read_b128 a[148:151], v28 offset:18432
    buffer_load_dwordx4 v30, s[36:39], s66 offen offset:0 nt lds
    v_mfma_f32_16x16x32_bf16 v[240:243], a[120:123], a[136:139], v[240:243]
    s_lshl_b32 s10, s30, 7
    ds_read_b128 a[152:155], v29 offset:16384
    ds_read_b64_tr_b16 a[64:65], v12 offset:0
    v_mfma_f32_16x16x32_bf16 v[244:247], a[120:123], a[140:143], v[244:247]
    s_waitcnt lgkmcnt(3)
    ds_read_b64_tr_b16 a[66:67], v12 offset:2048
    v_mfma_f32_16x16x32_bf16 v[248:251], a[124:127], a[136:139], v[248:251]
    s_add_u32 s11, s10, 114688
    ds_read_b128 a[156:159], v29 offset:18432
    ds_read_b64_tr_b16 a[68:69], v13 offset:0
    v_mfma_f32_16x16x32_bf16 v[252:255], a[124:127], a[140:143], v[252:255]
    s_waitcnt lgkmcnt(2)
    ds_read_b64_tr_b16 a[70:71], v13 offset:2048
    buffer_load_dwordx4 v31, s[36:39], s66 offen offset:1024 nt lds
    v_mfma_f32_16x16x32_bf16 v[128:131], a[64:67], a[144:147], v[128:131]
    s_lshl_b32 s30, s30, 12
    ds_read_b64_tr_b16 a[72:73], v14 offset:0
    v_mfma_f32_16x16x32_bf16 v[132:135], a[64:67], a[148:151], v[132:135]
    s_waitcnt lgkmcnt(1)
    ds_read_b64_tr_b16 a[74:75], v14 offset:2048
    v_mfma_f32_16x16x32_bf16 v[136:139], a[68:71], a[144:147], v[136:139]
    s_add_u32 s21, s30, s76
    ds_read_b64_tr_b16 a[76:77], v15 offset:0
    v_mfma_f32_16x16x32_bf16 v[140:143], a[68:71], a[148:151], v[140:143]
    s_waitcnt lgkmcnt(1)
    ds_read_b64_tr_b16 a[78:79], v15 offset:2048
    buffer_load_dwordx4 v30, s[36:39], s66 offen offset:2048 nt lds
    v_mfma_f32_16x16x32_bf16 v[144:147], a[72:75], a[144:147], v[144:147]
    s_add_u32 s30, s74, 4
    ds_read_b64_tr_b16 a[80:81], v16 offset:0
    v_mfma_f32_16x16x32_bf16 v[148:151], a[72:75], a[148:151], v[148:151]
    s_waitcnt lgkmcnt(1)
    ds_read_b64_tr_b16 a[82:83], v16 offset:2048
    v_mfma_f32_16x16x32_bf16 v[152:155], a[76:79], a[144:147], v[152:155]
    s_sub_u32 s31, s30, 7
    ds_read_b64_tr_b16 a[84:85], v17 offset:0
    v_mfma_f32_16x16x32_bf16 v[156:159], a[76:79], a[148:151], v[156:159]
    s_waitcnt lgkmcnt(1)
    ds_read_b64_tr_b16 a[86:87], v17 offset:2048
    buffer_load_dwordx4 v31, s[36:39], s66 offen offset:3072 nt lds
    v_mfma_f32_16x16x32_bf16 v[160:163], a[80:83], a[144:147], v[160:163]
    s_add_u32 s66, s66, 16384
    s_lshl_b32 s70, s68, 19
    s_add_u32 m0, s60, 98304
    v_mfma_f32_16x16x32_bf16 v[164:167], a[80:83], a[148:151], v[164:167]
    s_waitcnt lgkmcnt(0)
    ds_read_b64_tr_b16 a[88:89], v18 offset:0
    ds_read_b64_tr_b16 a[90:91], v18 offset:2048
    v_mfma_f32_16x16x32_bf16 v[168:171], a[84:87], a[144:147], v[168:171]
    s_and_b32 s66, s66, 0x7ffff
    ds_read_b64_tr_b16 a[92:93], v19 offset:0
    v_mfma_f32_16x16x32_bf16 v[172:175], a[84:87], a[148:151], v[172:175]
    s_waitcnt lgkmcnt(1)
    ds_read_b64_tr_b16 a[94:95], v19 offset:2048
    buffer_load_dwordx4 v34, s[44:47], s70 offen offset:0 lds
    v_mfma_f32_16x16x32_bf16 v[176:179], a[88:91], a[144:147], v[176:179]
    s_min_u32 s30, s30, s31
    ds_read_b64_tr_b16 a[96:97], v12 offset:256
    v_mfma_f32_16x16x32_bf16 v[180:183], a[88:91], a[148:151], v[180:183]
    s_waitcnt lgkmcnt(1)
    ds_read_b64_tr_b16 a[98:99], v12 offset:2304
    v_mfma_f32_16x16x32_bf16 v[184:187], a[92:95], a[144:147], v[184:187]
    s_lshl_b32 s12, s30, 7
    ds_read_b64_tr_b16 a[100:101], v13 offset:256
    v_mfma_f32_16x16x32_bf16 v[188:191], a[92:95], a[148:151], v[188:191]
    s_waitcnt lgkmcnt(1)
    ds_read_b64_tr_b16 a[102:103], v13 offset:2304
    buffer_load_dwordx4 v35, s[44:47], s70 offen offset:1024 lds
    v_mfma_f32_16x16x32_bf16 v[192:195], a[96:99], a[144:147], v[192:195]
    s_add_u32 s13, s12, 114688
    ds_read_b64_tr_b16 a[104:105], v14 offset:256
    v_mfma_f32_16x16x32_bf16 v[196:199], a[96:99], a[148:151], v[196:199]
    s_waitcnt lgkmcnt(1)
    ds_read_b64_tr_b16 a[106:107], v14 offset:2304
    v_lshrrev_b32 v59, 2, v58
    v_mfma_f32_16x16x32_bf16 v[200:203], a[100:103], a[144:147], v[200:203]
    s_lshl_b32 s30, s30, 12
    ds_read_b64_tr_b16 a[108:109], v15 offset:256
    v_and_b32 v60, 3, v58
    v_mfma_f32_16x16x32_bf16 v[204:207], a[100:103], a[148:151], v[204:207]
    s_waitcnt lgkmcnt(1)
    ds_read_b64_tr_b16 a[110:111], v15 offset:2304
    buffer_load_dwordx4 v36, s[44:47], s70 offen offset:2048 lds
    v_mfma_f32_16x16x32_bf16 v[208:211], a[104:107], a[144:147], v[208:211]
    s_add_u32 s22, s30, s76
    ds_read_b64_tr_b16 a[112:113], v16 offset:256
    v_mfma_f32_16x16x32_bf16 v[212:215], a[104:107], a[148:151], v[212:215]
    s_waitcnt lgkmcnt(1)
    ds_read_b64_tr_b16 a[114:115], v16 offset:2304
    v_lshl_add_u32 v59, v59, 3, v60
    v_mfma_f32_16x16x32_bf16 v[216:219], a[108:111], a[144:147], v[216:219]
    s_add_u32 s30, s74, 5
    ds_read_b64_tr_b16 a[116:117], v17 offset:256
    v_mfma_f32_16x16x32_bf16 v[220:223], a[108:111], a[148:151], v[220:223]
    s_waitcnt vmcnt(19) lgkmcnt(1)
    ds_read_b64_tr_b16 a[118:119], v17 offset:2304
    buffer_load_dwordx4 v37, s[44:47], s70 offen offset:3072 lds
    v_mfma_f32_16x16x32_bf16 v[224:227], a[112:115], a[144:147], v[224:227]
    s_barrier
    s_lshl_b32 s69, s68, 7
    s_add_u32 s70, s70, 0x40000
    s_add_u32 m0, s60, 114688
    v_mfma_f32_16x16x32_bf16 v[228:231], a[112:115], a[148:151], v[228:231]
    s_waitcnt lgkmcnt(0)
    ds_read_b64_tr_b16 a[120:121], v18 offset:256
    ds_read_b64_tr_b16 a[122:123], v18 offset:2304
    v_mfma_f32_16x16x32_bf16 v[232:235], a[116:119], a[144:147], v[232:235]
    s_sub_u32 s31, s30, 7
    ds_read_b64_tr_b16 a[124:125], v19 offset:256
    v_lshlrev_b32 v59, 9, v59
    v_mfma_f32_16x16x32_bf16 v[236:239], a[116:119], a[148:151], v[236:239]
    s_waitcnt lgkmcnt(1)
    ds_read_b64_tr_b16 a[126:127], v19 offset:2304
    buffer_load_dwordx4 v34, s[44:47], s70 offen offset:0 lds
    v_mfma_f32_16x16x32_bf16 v[240:243], a[120:123], a[144:147], v[240:243]
    s_min_u32 s30, s30, s31
    ds_read_b64_tr_b16 a[64:65], v20 offset:32768
    v_mfma_f32_16x16x32_bf16 v[244:247], a[120:123], a[148:151], v[244:247]
    s_waitcnt lgkmcnt(1)
    ds_read_b64_tr_b16 a[66:67], v20 offset:34816
    v_mfma_f32_16x16x32_bf16 v[248:251], a[124:127], a[144:147], v[248:251]
    s_lshl_b32 s14, s30, 7
    ds_read_b64_tr_b16 a[68:69], v21 offset:32768
    v_bfrev_b32 v61, v7
    v_mfma_f32_16x16x32_bf16 v[252:255], a[124:127], a[148:151], v[252:255]
    s_waitcnt lgkmcnt(1)
    ds_read_b64_tr_b16 a[70:71], v21 offset:34816
    buffer_load_dwordx4 v35, s[44:47], s70 offen offset:1024 lds
    v_mfma_f32_16x16x32_bf16 v[128:131], a[64:67], a[152:155], v[128:131]
    s_add_u32 s15, s14, 114688
    ds_read_b64_tr_b16 a[72:73], v22 offset:32768
    v_mfma_f32_16x16x32_bf16 v[132:135], a[64:67], a[156:159], v[132:135]
    s_waitcnt lgkmcnt(1)
    ds_read_b64_tr_b16 a[74:75], v22 offset:34816
    v_lshrrev_b32 v51, 30, v61
    v_mfma_f32_16x16x32_bf16 v[136:139], a[68:71], a[152:155], v[136:139]
    s_lshl_b32 s30, s30, 12
    ds_read_b64_tr_b16 a[76:77], v23 offset:32768
    v_mfma_f32_16x16x32_bf16 v[140:143], a[68:71], a[156:159], v[140:143]
    s_waitcnt lgkmcnt(1)
    ds_read_b64_tr_b16 a[78:79], v23 offset:34816
    buffer_load_dwordx4 v36, s[44:47], s70 offen offset:2048 lds
    v_mfma_f32_16x16x32_bf16 v[144:147], a[72:75], a[152:155], v[144:147]
    s_add_u32 s23, s30, s76
    ds_read_b64_tr_b16 a[80:81], v24 offset:32768
    v_mfma_f32_16x16x32_bf16 v[148:151], a[72:75], a[156:159], v[148:151]
    s_waitcnt lgkmcnt(1)
    ds_read_b64_tr_b16 a[82:83], v24 offset:34816
    v_xor_b32 v60, v58, v51
    v_mfma_f32_16x16x32_bf16 v[152:155], a[76:79], a[152:155], v[152:155]
    s_add_u32 s30, s74, 6
    ds_read_b64_tr_b16 a[84:85], v25 offset:32768
    v_mfma_f32_16x16x32_bf16 v[156:159], a[76:79], a[156:159], v[156:159]
    s_waitcnt lgkmcnt(1)
    ds_read_b64_tr_b16 a[86:87], v25 offset:34816
    buffer_load_dwordx4 v37, s[44:47], s70 offen offset:3072 lds
    v_mfma_f32_16x16x32_bf16 v[160:163], a[80:83], a[152:155], v[160:163]
    s_add_u32 s68, s68, 1
    s_cmp_eq_u32 s68, 7
    s_cselect_b32 s68, 0, s68
    s_add_u32 m0, s60, 147456
    v_mfma_f32_16x16x32_bf16 v[164:167], a[80:83], a[156:159], v[164:167]
    s_waitcnt lgkmcnt(0)
    ds_read_b64_tr_b16 a[88:89], v26 offset:32768
    ds_read_b64_tr_b16 a[90:91], v26 offset:34816
    v_mfma_f32_16x16x32_bf16 v[168:171], a[84:87], a[152:155], v[168:171]
    s_sub_u32 s31, s30, 7
    ds_read_b64_tr_b16 a[92:93], v27 offset:32768
    v_xor_b32 v61, 0, v60
    v_mfma_f32_16x16x32_bf16 v[172:175], a[84:87], a[156:159], v[172:175]
    s_waitcnt lgkmcnt(1)
    ds_read_b64_tr_b16 a[94:95], v27 offset:34816
    buffer_load_dwordx4 v38, s[32:35], s69 offen offset:0 lds
    v_mfma_f32_16x16x32_bf16 v[176:179], a[88:91], a[152:155], v[176:179]
    s_min_u32 s30, s30, s31
    ds_read_b64_tr_b16 a[96:97], v20 offset:33024
    v_mfma_f32_16x16x32_bf16 v[180:183], a[88:91], a[156:159], v[180:183]
    s_waitcnt lgkmcnt(1)
    ds_read_b64_tr_b16 a[98:99], v20 offset:35072
    v_lshl_add_u32 v8, v61, 4, v59
    v_mfma_f32_16x16x32_bf16 v[184:187], a[92:95], a[152:155], v[184:187]
    s_lshl_b32 s16, s30, 7
    ds_read_b64_tr_b16 a[100:101], v21 offset:33024
    v_mfma_f32_16x16x32_bf16 v[188:191], a[92:95], a[156:159], v[188:191]
    s_waitcnt lgkmcnt(1)
    ds_read_b64_tr_b16 a[102:103], v21 offset:35072
    buffer_load_dwordx4 v39, s[32:35], s69 offen offset:1024 lds
    v_mfma_f32_16x16x32_bf16 v[192:195], a[96:99], a[152:155], v[192:195]
    s_add_u32 s17, s16, 114688
    ds_read_b64_tr_b16 a[104:105], v22 offset:33024
    v_mfma_f32_16x16x32_bf16 v[196:199], a[96:99], a[156:159], v[196:199]
    s_waitcnt lgkmcnt(1)
    ds_read_b64_tr_b16 a[106:107], v22 offset:35072
    v_xor_b32 v61, 4, v60
    v_mfma_f32_16x16x32_bf16 v[200:203], a[100:103], a[152:155], v[200:203]
    s_lshl_b32 s30, s30, 12
    ds_read_b64_tr_b16 a[108:109], v23 offset:33024
    v_mfma_f32_16x16x32_bf16 v[204:207], a[100:103], a[156:159], v[204:207]
    s_waitcnt lgkmcnt(1)
    ds_read_b64_tr_b16 a[110:111], v23 offset:35072
    buffer_load_dwordx4 v40, s[32:35], s69 offen offset:2048 lds
    v_mfma_f32_16x16x32_bf16 v[208:211], a[104:107], a[152:155], v[208:211]
    s_add_u32 s92, s30, s76
    ds_read_b64_tr_b16 a[112:113], v24 offset:33024
    v_mfma_f32_16x16x32_bf16 v[212:215], a[104:107], a[156:159], v[212:215]
    s_waitcnt lgkmcnt(1)
    ds_read_b64_tr_b16 a[114:115], v24 offset:35072
    v_lshl_add_u32 v9, v61, 4, v59
    v_mfma_f32_16x16x32_bf16 v[216:219], a[108:111], a[152:155], v[216:219]
    s_mov_b32 s3, s64
    ds_read_b64_tr_b16 a[116:117], v25 offset:33024
    v_xor_b32 v61, 8, v60
    v_mfma_f32_16x16x32_bf16 v[220:223], a[108:111], a[156:159], v[220:223]
    s_waitcnt vmcnt(15) lgkmcnt(1)
    ds_read_b64_tr_b16 a[118:119], v25 offset:35072
    buffer_load_dwordx4 v41, s[32:35], s69 offen offset:3072 lds
    v_mfma_f32_16x16x32_bf16 v[224:227], a[112:115], a[152:155], v[224:227]
    s_barrier
    s_add_u32 m0, s60, 16384
    ds_read_b64_tr_b16 a[120:121], v26 offset:33024
    v_mfma_f32_16x16x32_bf16 v[228:231], a[112:115], a[156:159], v[228:231]
    s_waitcnt lgkmcnt(1)
    ds_read_b64_tr_b16 a[122:123], v26 offset:35072
    ds_read_b128 a[128:131], v28 offset:0
    v_mfma_f32_16x16x32_bf16 v[232:235], a[116:119], a[152:155], v[232:235]
    s_lshr_b32 s30, s3, 2
    ds_read_b64_tr_b16 a[124:125], v27 offset:33024
    ds_read_b64_tr_b16 a[126:127], v27 offset:35072
    v_mfma_f32_16x16x32_bf16 v[236:239], a[116:119], a[156:159], v[236:239]
    s_waitcnt lgkmcnt(3)
    ds_read_b128 a[132:135], v28 offset:2048
    buffer_load_dwordx4 v30, s[36:39], s66 offen offset:0 nt lds
    v_mfma_f32_16x16x32_bf16 v[240:243], a[120:123], a[152:155], v[240:243]
    s_add_u32 s30, s30, s74
    ds_read_b128 a[136:139], v29 offset:0
    ds_read_b64_tr_b16 a[64:65], v12 offset:16384
    v_mfma_f32_16x16x32_bf16 v[244:247], a[120:123], a[156:159], v[244:247]
    s_waitcnt lgkmcnt(3)
    ds_read_b64_tr_b16 a[66:67], v12 offset:18432
    v_mfma_f32_16x16x32_bf16 v[248:251], a[124:127], a[152:155], v[248:251]
    s_add_u32 s30, s30, 0
    ds_read_b128 a[140:143], v29 offset:2048
    ds_read_b64_tr_b16 a[68:69], v13 offset:16384
    v_mfma_f32_16x16x32_bf16 v[252:255], a[124:127], a[156:159], v[252:255]
    s_waitcnt lgkmcnt(2)
    ds_read_b64_tr_b16 a[70:71], v13 offset:18432
    buffer_load_dwordx4 v31, s[36:39], s66 offen offset:1024 nt lds
    v_mfma_f32_16x16x32_bf16 v[128:131], a[64:67], a[128:131], v[128:131]
    s_sub_u32 s31, s30, 7
    ds_read_b64_tr_b16 a[72:73], v14 offset:16384
    v_mfma_f32_16x16x32_bf16 v[132:135], a[64:67], a[132:135], v[132:135]
    s_waitcnt lgkmcnt(1)
    ds_read_b64_tr_b16 a[74:75], v14 offset:18432
    v_lshl_add_u32 v10, v61, 4, v59
    v_mfma_f32_16x16x32_bf16 v[136:139], a[68:71], a[128:131], v[136:139]
    s_min_u32 s30, s30, s31
    ds_read_b64_tr_b16 a[76:77], v15 offset:16384
    v_xor_b32 v61, 12, v60
    v_mfma_f32_16x16x32_bf16 v[140:143], a[68:71], a[132:135], v[140:143]
    s_waitcnt lgkmcnt(1)
    ds_read_b64_tr_b16 a[78:79], v15 offset:18432
    buffer_load_dwordx4 v30, s[36:39], s66 offen offset:2048 nt lds
    v_mfma_f32_16x16x32_bf16 v[144:147], a[72:75], a[128:131], v[144:147]
    s_lshl_b32 s31, s30, 2
    ds_read_b64_tr_b16 a[80:81], v16 offset:16384
    v_mfma_f32_16x16x32_bf16 v[148:151], a[72:75], a[132:135], v[148:151]
    s_waitcnt lgkmcnt(1)
    ds_read_b64_tr_b16 a[82:83], v16 offset:18432
    v_mfma_f32_16x16x32_bf16 v[152:155], a[76:79], a[128:131], v[152:155]
    s_and_b32 s71, s3, 3
    ds_read_b64_tr_b16 a[84:85], v17 offset:16384
    v_lshl_add_u32 v11, v61, 4, v59
    v_mfma_f32_16x16x32_bf16 v[156:159], a[76:79], a[132:135], v[156:159]
    s_waitcnt lgkmcnt(1)
    ds_read_b64_tr_b16 a[86:87], v17 offset:18432
    buffer_load_dwordx4 v31, s[36:39], s66 offen offset:3072 nt lds
    v_mfma_f32_16x16x32_bf16 v[160:163], a[80:83], a[128:131], v[160:163]
    s_add_u32 s66, s66, 32768
    s_lshl_b32 s70, s68, 19
    s_add_u32 m0, s60, 65536
    v_mfma_f32_16x16x32_bf16 v[164:167], a[80:83], a[132:135], v[164:167]
    s_waitcnt lgkmcnt(0)
    ds_read_b64_tr_b16 a[88:89], v18 offset:16384
    ds_read_b64_tr_b16 a[90:91], v18 offset:18432
    v_mfma_f32_16x16x32_bf16 v[168:171], a[84:87], a[128:131], v[168:171]
    s_and_b32 s66, s66, 0x7ffff
    ds_read_b64_tr_b16 a[92:93], v19 offset:16384
    v_mfma_f32_16x16x32_bf16 v[172:175], a[84:87], a[132:135], v[172:175]
    s_waitcnt lgkmcnt(1)
    ds_read_b64_tr_b16 a[94:95], v19 offset:18432
    buffer_load_dwordx4 v34, s[44:47], s70 offen offset:0 lds
    v_mfma_f32_16x16x32_bf16 v[176:179], a[88:91], a[128:131], v[176:179]
    s_add_u32 s31, s31, s71
    ds_read_b64_tr_b16 a[96:97], v12 offset:16640
    v_mfma_f32_16x16x32_bf16 v[180:183], a[88:91], a[132:135], v[180:183]
    s_waitcnt lgkmcnt(1)
    ds_read_b64_tr_b16 a[98:99], v12 offset:18688
    v_lshl_add_u32 v59, v7, 2, v5
    v_mfma_f32_16x16x32_bf16 v[184:187], a[92:95], a[128:131], v[184:187]
    s_lshl_b32 s31, s31, 10
    ds_read_b64_tr_b16 a[100:101], v13 offset:16640
    v_bfe_u32 v60, v59, 1, 2
    v_mfma_f32_16x16x32_bf16 v[188:191], a[92:95], a[132:135], v[188:191]
    s_waitcnt lgkmcnt(1)
    ds_read_b64_tr_b16 a[102:103], v13 offset:18688
    buffer_load_dwordx4 v35, s[44:47], s70 offen offset:1024 lds
    v_mfma_f32_16x16x32_bf16 v[192:195], a[96:99], a[128:131], v[192:195]
    s_mul_i32 s94, s61, 28672
    ds_read_b64_tr_b16 a[104:105], v14 offset:16640
    v_mfma_f32_16x16x32_bf16 v[196:199], a[96:99], a[132:135], v[196:199]
    s_waitcnt lgkmcnt(1)
    ds_read_b64_tr_b16 a[106:107], v14 offset:18688
    v_mfma_f32_16x16x32_bf16 v[200:203], a[100:103], a[128:131], v[200:203]
    s_add_u32 s94, s94, s31
    ds_read_b64_tr_b16 a[108:109], v15 offset:16640
    v_lshlrev_b32 v59, 7, v59
    v_mfma_f32_16x16x32_bf16 v[204:207], a[100:103], a[132:135], v[204:207]
    s_waitcnt lgkmcnt(1)
    ds_read_b64_tr_b16 a[110:111], v15 offset:18688
    buffer_load_dwordx4 v36, s[44:47], s70 offen offset:2048 lds
    v_mfma_f32_16x16x32_bf16 v[208:211], a[104:107], a[128:131], v[208:211]
    s_lshl_b32 s31, s63, 2
    ds_read_b64_tr_b16 a[112:113], v16 offset:16640
    v_mfma_f32_16x16x32_bf16 v[212:215], a[104:107], a[132:135], v[212:215]
    s_waitcnt lgkmcnt(1)
    ds_read_b64_tr_b16 a[114:115], v16 offset:18688
    v_lshl_add_u32 v59, v6, 3, v59
    v_mfma_f32_16x16x32_bf16 v[216:219], a[108:111], a[128:131], v[216:219]
    s_add_u32 s31, s31, s61
    ds_read_b64_tr_b16 a[116:117], v17 offset:16640
    v_mfma_f32_16x16x32_bf16 v[220:223], a[108:111], a[132:135], v[220:223]
    s_waitcnt lgkmcnt(1)
    ds_read_b64_tr_b16 a[118:119], v17 offset:18688
    buffer_load_dwordx4 v37, s[44:47], s70 offen offset:3072 lds
    v_mfma_f32_16x16x32_bf16 v[224:227], a[112:115], a[128:131], v[224:227]
    s_barrier
    s_lshl_b32 s69, s68, 7
    s_add_u32 s70, s70, 0x40000
    s_add_u32 m0, s60, 32768
    v_mfma_f32_16x16x32_bf16 v[228:231], a[112:115], a[132:135], v[228:231]
    s_waitcnt lgkmcnt(0)
    ds_read_b64_tr_b16 a[120:121], v18 offset:16640
    ds_read_b64_tr_b16 a[122:123], v18 offset:18688
    v_mfma_f32_16x16x32_bf16 v[232:235], a[116:119], a[128:131], v[232:235]
    s_lshl_b32 s31, s31, 1
    ds_read_b64_tr_b16 a[124:125], v19 offset:16640
    v_xor_b32 v61, 0, v60
    v_mfma_f32_16x16x32_bf16 v[236:239], a[116:119], a[132:135], v[236:239]
    s_waitcnt lgkmcnt(1)
    ds_read_b64_tr_b16 a[126:127], v19 offset:18688
    buffer_load_dwordx4 v34, s[44:47], s70 offen offset:0 lds
    v_mfma_f32_16x16x32_bf16 v[240:243], a[120:123], a[128:131], v[240:243]
    s_bfe_u32 s71, s3, 0x10001
    ds_read_b64_tr_b16 a[64:65], v20 offset:49152
    v_mfma_f32_16x16x32_bf16 v[244:247], a[120:123], a[132:135], v[244:247]
    s_waitcnt lgkmcnt(1)
    ds_read_b64_tr_b16 a[66:67], v20 offset:51200
    v_mfma_f32_16x16x32_bf16 v[248:251], a[124:127], a[128:131], v[248:251]
    s_add_u32 s31, s31, s71
    ds_read_b64_tr_b16 a[68:69], v21 offset:49152
    v_lshl_add_u32 v46, v61, 5, v59
    v_mfma_f32_16x16x32_bf16 v[252:255], a[124:127], a[132:135], v[252:255]
    s_waitcnt lgkmcnt(1)
    ds_read_b64_tr_b16 a[70:71], v21 offset:51200
    buffer_load_dwordx4 v35, s[44:47], s70 offen offset:1024 lds
    v_mfma_f32_16x16x32_bf16 v[128:131], a[64:67], a[136:139], v[128:131]
    s_mul_i32 s31, s31, 28672
    ds_read_b64_tr_b16 a[72:73], v22 offset:49152
    v_mfma_f32_16x16x32_bf16 v[132:135], a[64:67], a[140:143], v[132:135]
    s_waitcnt lgkmcnt(1)
    ds_read_b64_tr_b16 a[74:75], v22 offset:51200
    v_xor_b32 v61, 1, v60
    v_mfma_f32_16x16x32_bf16 v[136:139], a[68:71], a[136:139], v[136:139]
    s_lshl_b32 s30, s30, 1
    ds_read_b64_tr_b16 a[76:77], v23 offset:49152
    v_mfma_f32_16x16x32_bf16 v[140:143], a[68:71], a[140:143], v[140:143]
    s_waitcnt lgkmcnt(1)
    ds_read_b64_tr_b16 a[78:79], v23 offset:51200
    buffer_load_dwordx4 v36, s[44:47], s70 offen offset:2048 lds
    v_mfma_f32_16x16x32_bf16 v[144:147], a[72:75], a[136:139], v[144:147]
    s_and_b32 s71, s3, 1
    ds_read_b64_tr_b16 a[80:81], v24 offset:49152
    v_mfma_f32_16x16x32_bf16 v[148:151], a[72:75], a[140:143], v[148:151]
    s_waitcnt lgkmcnt(1)
    ds_read_b64_tr_b16 a[82:83], v24 offset:51200
    v_lshl_add_u32 v47, v61, 5, v59
    v_mfma_f32_16x16x32_bf16 v[152:155], a[76:79], a[136:139], v[152:155]
    s_add_u32 s30, s30, s71
    ds_read_b64_tr_b16 a[84:85], v25 offset:49152
    v_mfma_f32_16x16x32_bf16 v[156:159], a[76:79], a[140:143], v[156:159]
    s_waitcnt lgkmcnt(1)
    ds_read_b64_tr_b16 a[86:87], v25 offset:51200
    buffer_load_dwordx4 v37, s[44:47], s70 offen offset:3072 lds
    v_mfma_f32_16x16x32_bf16 v[160:163], a[80:83], a[136:139], v[160:163]
    s_add_u32 s68, s68, 1
    s_cmp_eq_u32 s68, 7
    s_cselect_b32 s68, 0, s68
    s_add_u32 m0, s60, 131072
    v_mfma_f32_16x16x32_bf16 v[164:167], a[80:83], a[140:143], v[164:167]
    s_waitcnt lgkmcnt(0)
    ds_read_b64_tr_b16 a[88:89], v26 offset:49152
    ds_read_b64_tr_b16 a[90:91], v26 offset:51200
    v_mfma_f32_16x16x32_bf16 v[168:171], a[84:87], a[136:139], v[168:171]
    s_lshl_b32 s30, s30, 6
    ds_read_b64_tr_b16 a[92:93], v27 offset:49152
    v_xor_b32 v61, 2, v60
    v_mfma_f32_16x16x32_bf16 v[172:175], a[84:87], a[140:143], v[172:175]
    s_waitcnt lgkmcnt(1)
    ds_read_b64_tr_b16 a[94:95], v27 offset:51200
    buffer_load_dwordx4 v38, s[32:35], s69 offen offset:0 lds
    v_mfma_f32_16x16x32_bf16 v[176:179], a[88:91], a[136:139], v[176:179]
    s_add_u32 s31, s31, s30
    ds_read_b64_tr_b16 a[96:97], v20 offset:49408
    v_mfma_f32_16x16x32_bf16 v[180:183], a[88:91], a[140:143], v[180:183]
    s_waitcnt lgkmcnt(1)
    ds_read_b64_tr_b16 a[98:99], v20 offset:51456
    v_lshl_add_u32 v48, v61, 5, v59
    v_mfma_f32_16x16x32_bf16 v[184:187], a[92:95], a[136:139], v[184:187]
    s_mul_i32 s30, s62, 896
    ds_read_b64_tr_b16 a[100:101], v21 offset:49408
    v_mfma_f32_16x16x32_bf16 v[188:191], a[92:95], a[140:143], v[188:191]
    s_waitcnt lgkmcnt(1)
    ds_read_b64_tr_b16 a[102:103], v21 offset:51456
    buffer_load_dwordx4 v39, s[32:35], s69 offen offset:1024 lds
    v_mfma_f32_16x16x32_bf16 v[192:195], a[96:99], a[136:139], v[192:195]
    s_add_u32 s96, s31, s30
    ds_read_b64_tr_b16 a[104:105], v22 offset:49408
    v_mfma_f32_16x16x32_bf16 v[196:199], a[96:99], a[140:143], v[196:199]
    s_waitcnt lgkmcnt(1)
    ds_read_b64_tr_b16 a[106:107], v22 offset:51456
    v_xor_b32 v61, 3, v60
    v_mfma_f32_16x16x32_bf16 v[200:203], a[100:103], a[136:139], v[200:203]
    s_lshr_b32 s98, s3, 2
    ds_read_b64_tr_b16 a[108:109], v23 offset:49408
    v_lshl_add_u32 v49, v61, 5, v59
    v_mfma_f32_16x16x32_bf16 v[204:207], a[100:103], a[140:143], v[204:207]
    s_waitcnt lgkmcnt(1)
    ds_read_b64_tr_b16 a[110:111], v23 offset:51456
    buffer_load_dwordx4 v40, s[32:35], s69 offen offset:2048 lds
    v_mfma_f32_16x16x32_bf16 v[208:211], a[104:107], a[136:139], v[208:211]
    s_xor_b32 s98, s98, 4
    ds_read_b64_tr_b16 a[112:113], v24 offset:49408
    v_mfma_f32_16x16x32_bf16 v[212:215], a[104:107], a[140:143], v[212:215]
    s_waitcnt lgkmcnt(1)
    ds_read_b64_tr_b16 a[114:115], v24 offset:51456
    v_mfma_f32_16x16x32_bf16 v[216:219], a[108:111], a[136:139], v[216:219]
    s_lshl_b32 s3, s61, 2
    ds_read_b64_tr_b16 a[116:117], v25 offset:49408
    v_xor_b32 v61, 0, v58
    v_mfma_f32_16x16x32_bf16 v[220:223], a[108:111], a[140:143], v[220:223]
    s_waitcnt vmcnt(15) lgkmcnt(1)
    ds_read_b64_tr_b16 a[118:119], v25 offset:51456
    buffer_load_dwordx4 v41, s[32:35], s69 offen offset:3072 lds
    v_mfma_f32_16x16x32_bf16 v[224:227], a[112:115], a[136:139], v[224:227]
    s_barrier
    ds_read_b64_tr_b16 a[120:121], v26 offset:49408
    ds_read_b64_tr_b16 a[122:123], v26 offset:51456
    v_mfma_f32_16x16x32_bf16 v[228:231], a[112:115], a[140:143], v[228:231]
    s_waitcnt lgkmcnt(2)
    ds_read_b128 a[144:147], v28 offset:16384
    v_mfma_f32_16x16x32_bf16 v[232:235], a[116:119], a[136:139], v[232:235]
    s_lshl_b32 s70, s68, 19
    s_add_u32 m0, s60, 81920
    ds_read_b64_tr_b16 a[124:125], v27 offset:49408
    ds_read_b64_tr_b16 a[126:127], v27 offset:51456
    v_mfma_f32_16x16x32_bf16 v[236:239], a[116:119], a[140:143], v[236:239]
    s_waitcnt lgkmcnt(3)
    ds_read_b128 a[148:151], v28 offset:18432
    ds_read_b64_tr_b16 a[64:65], v12 offset:32768
    ds_read_b64_tr_b16 a[66:67], v12 offset:34816
    v_mfma_f32_16x16x32_bf16 v[240:243], a[120:123], a[136:139], v[240:243]
    s_add_u32 s3, s3, s64
    ds_read_b128 a[152:155], v29 offset:16384
    ds_read_b64_tr_b16 a[68:69], v13 offset:32768
    v_mfma_f32_16x16x32_bf16 v[244:247], a[120:123], a[140:143], v[244:247]
    s_waitcnt lgkmcnt(5)
    ds_read_b64_tr_b16 a[70:71], v13 offset:34816
    buffer_load_dwordx4 v34, s[44:47], s70 offen offset:0 lds
    v_mfma_f32_16x16x32_bf16 v[248:251], a[124:127], a[136:139], v[248:251]
    s_and_b32 s3, s3, 15
    ds_read_b128 a[156:159], v29 offset:18432
    ds_read_b64_tr_b16 a[72:73], v14 offset:32768
    v_mfma_f32_16x16x32_bf16 v[252:255], a[124:127], a[140:143], v[252:255]
    s_waitcnt lgkmcnt(5)
    ds_read_b64_tr_b16 a[74:75], v14 offset:34816
    v_min_u32 v61, 1, v61
    v_mfma_f32_16x16x32_bf16 v[128:131], a[64:67], a[144:147], v[128:131]
    s_lshr_b32 s30, s3, 2
    ds_read_b64_tr_b16 a[76:77], v15 offset:32768
    v_mfma_f32_16x16x32_bf16 v[132:135], a[64:67], a[148:151], v[132:135]
    s_waitcnt lgkmcnt(4)
    ds_read_b64_tr_b16 a[78:79], v15 offset:34816
    v_add_u32 v61, -1, v61
    v_mfma_f32_16x16x32_bf16 v[136:139], a[68:71], a[144:147], v[136:139]
    s_add_u32 s30, s30, s74
    ds_read_b64_tr_b16 a[80:81], v16 offset:32768
    v_mfma_f32_16x16x32_bf16 v[140:143], a[68:71], a[148:151], v[140:143]
    s_waitcnt lgkmcnt(3)
    ds_read_b64_tr_b16 a[82:83], v16 offset:34816
    v_mfma_f32_16x16x32_bf16 v[144:147], a[72:75], a[144:147], v[144:147]
    s_add_u32 s30, s30, 4
    ds_read_b64_tr_b16 a[84:85], v17 offset:32768
    v_and_b32 v61, 0x3f803f80, v61
    v_mfma_f32_16x16x32_bf16 v[148:151], a[72:75], a[148:151], v[148:151]
    s_waitcnt lgkmcnt(3)
    ds_read_b64_tr_b16 a[86:87], v17 offset:34816
    buffer_load_dwordx4 v35, s[44:47], s70 offen offset:1024 lds
    v_mfma_f32_16x16x32_bf16 v[152:155], a[76:79], a[144:147], v[152:155]
    s_sub_u32 s31, s30, 7
    ds_read_b64_tr_b16 a[88:89], v18 offset:32768
    v_mfma_f32_16x16x32_bf16 v[156:159], a[76:79], a[148:151], v[156:159]
    s_waitcnt lgkmcnt(3)
    ds_read_b64_tr_b16 a[90:91], v18 offset:34816
    v_accvgpr_write_b32 a160, v61
    v_mfma_f32_16x16x32_bf16 v[160:163], a[80:83], a[144:147], v[160:163]
    s_min_u32 s30, s30, s31
    ds_read_b64_tr_b16 a[92:93], v19 offset:32768
    v_mfma_f32_16x16x32_bf16 v[164:167], a[80:83], a[148:151], v[164:167]
    s_waitcnt lgkmcnt(3)
    ds_read_b64_tr_b16 a[94:95], v19 offset:34816
    v_accvgpr_write_b32 a161, v61
    v_mfma_f32_16x16x32_bf16 v[168:171], a[84:87], a[144:147], v[168:171]
    s_lshl_b32 s31, s30, 2
    ds_read_b64_tr_b16 a[96:97], v12 offset:33024
    v_mfma_f32_16x16x32_bf16 v[172:175], a[84:87], a[148:151], v[172:175]
    s_waitcnt lgkmcnt(3)
    ds_read_b64_tr_b16 a[98:99], v12 offset:35072
    v_mfma_f32_16x16x32_bf16 v[176:179], a[88:91], a[144:147], v[176:179]
    s_and_b32 s71, s3, 3
    ds_read_b64_tr_b16 a[100:101], v13 offset:33024
    v_accvgpr_write_b32 a162, v61
    v_mfma_f32_16x16x32_bf16 v[180:183], a[88:91], a[148:151], v[180:183]
    s_waitcnt lgkmcnt(3)
    ds_read_b64_tr_b16 a[102:103], v13 offset:35072
    buffer_load_dwordx4 v36, s[44:47], s70 offen offset:2048 lds
    v_mfma_f32_16x16x32_bf16 v[184:187], a[92:95], a[144:147], v[184:187]
    s_add_u32 s31, s31, s71
    ds_read_b64_tr_b16 a[104:105], v14 offset:33024
    v_mfma_f32_16x16x32_bf16 v[188:191], a[92:95], a[148:151], v[188:191]
    s_waitcnt lgkmcnt(3)
    ds_read_b64_tr_b16 a[106:107], v14 offset:35072
    v_accvgpr_write_b32 a163, v61
    v_mfma_f32_16x16x32_bf16 v[192:195], a[96:99], a[144:147], v[192:195]
    s_lshl_b32 s31, s31, 10
    ds_read_b64_tr_b16 a[108:109], v15 offset:33024
    v_mfma_f32_16x16x32_bf16 v[196:199], a[96:99], a[148:151], v[196:199]
    s_waitcnt lgkmcnt(3)
    ds_read_b64_tr_b16 a[110:111], v15 offset:35072
    v_xor_b32 v61, 4, v58
    v_mfma_f32_16x16x32_bf16 v[200:203], a[100:103], a[144:147], v[200:203]
    s_mul_i32 s95, s61, 28672
    ds_read_b64_tr_b16 a[112:113], v16 offset:33024
    v_mfma_f32_16x16x32_bf16 v[204:207], a[100:103], a[148:151], v[204:207]
    s_waitcnt lgkmcnt(3)
    ds_read_b64_tr_b16 a[114:115], v16 offset:35072
    v_mfma_f32_16x16x32_bf16 v[208:211], a[104:107], a[144:147], v[208:211]
    s_add_u32 s95, s95, s31
    ds_read_b64_tr_b16 a[116:117], v17 offset:33024
    v_min_u32 v61, 1, v61
    v_mfma_f32_16x16x32_bf16 v[212:215], a[104:107], a[148:151], v[212:215]
    s_waitcnt lgkmcnt(3)
    ds_read_b64_tr_b16 a[118:119], v17 offset:35072
    buffer_load_dwordx4 v37, s[44:47], s70 offen offset:3072 lds
    v_mfma_f32_16x16x32_bf16 v[216:219], a[108:111], a[144:147], v[216:219]
    s_lshl_b32 s31, s63, 2
    ds_read_b64_tr_b16 a[120:121], v18 offset:33024
    v_mfma_f32_16x16x32_bf16 v[220:223], a[108:111], a[148:151], v[220:223]
    s_waitcnt lgkmcnt(3)
    ds_read_b64_tr_b16 a[122:123], v18 offset:35072
    v_add_u32 v61, -1, v61
    v_mfma_f32_16x16x32_bf16 v[224:227], a[112:115], a[144:147], v[224:227]
    s_barrier
    s_lshl_b32 s69, s68, 7
    s_add_u32 s70, s70, 0x40000
    s_add_u32 m0, s60, 49152
    v_mfma_f32_16x16x32_bf16 v[228:231], a[112:115], a[148:151], v[228:231]
    s_waitcnt lgkmcnt(2)
    ds_read_b64_tr_b16 a[124:125], v19 offset:33024
    ds_read_b64_tr_b16 a[126:127], v19 offset:35072
    v_mfma_f32_16x16x32_bf16 v[232:235], a[116:119], a[144:147], v[232:235]
    s_add_u32 s31, s31, s61
    ds_read_b64_tr_b16 a[64:65], v12 offset:49152
    v_mfma_f32_16x16x32_bf16 v[236:239], a[116:119], a[148:151], v[236:239]
    s_waitcnt lgkmcnt(3)
    ds_read_b64_tr_b16 a[66:67], v12 offset:51200
    buffer_load_dwordx4 v34, s[44:47], s70 offen offset:0 lds
    v_mfma_f32_16x16x32_bf16 v[240:243], a[120:123], a[144:147], v[240:243]
    s_lshl_b32 s31, s31, 1
    ds_read_b64_tr_b16 a[68:69], v13 offset:49152
    v_mfma_f32_16x16x32_bf16 v[244:247], a[120:123], a[148:151], v[244:247]
    s_waitcnt lgkmcnt(3)
    ds_read_b64_tr_b16 a[70:71], v13 offset:51200
    v_and_b32 v61, 0x3f803f80, v61
    v_mfma_f32_16x16x32_bf16 v[248:251], a[124:127], a[144:147], v[248:251]
    s_bfe_u32 s71, s3, 0x10001
    ds_read_b64_tr_b16 a[72:73], v14 offset:49152
    v_accvgpr_write_b32 a164, v61
    v_mfma_f32_16x16x32_bf16 v[252:255], a[124:127], a[148:151], v[252:255]
    s_waitcnt lgkmcnt(3)
    ds_read_b64_tr_b16 a[74:75], v14 offset:51200
    buffer_load_dwordx4 v35, s[44:47], s70 offen offset:1024 lds
    v_mfma_f32_16x16x32_bf16 v[128:131], a[64:67], a[152:155], v[128:131]
    s_add_u32 s31, s31, s71
    ds_read_b64_tr_b16 a[76:77], v15 offset:49152
    v_mfma_f32_16x16x32_bf16 v[132:135], a[64:67], a[156:159], v[132:135]
    s_waitcnt lgkmcnt(3)
    ds_read_b64_tr_b16 a[78:79], v15 offset:51200
    v_mfma_f32_16x16x32_bf16 v[136:139], a[68:71], a[152:155], v[136:139]
    s_mul_i32 s31, s31, 28672
    ds_read_b64_tr_b16 a[80:81], v16 offset:49152
    v_accvgpr_write_b32 a165, v61
    v_mfma_f32_16x16x32_bf16 v[140:143], a[68:71], a[156:159], v[140:143]
    s_waitcnt lgkmcnt(3)
    ds_read_b64_tr_b16 a[82:83], v16 offset:51200
    buffer_load_dwordx4 v36, s[44:47], s70 offen offset:2048 lds
    v_mfma_f32_16x16x32_bf16 v[144:147], a[72:75], a[152:155], v[144:147]
    s_lshl_b32 s30, s30, 1
    ds_read_b64_tr_b16 a[84:85], v17 offset:49152
    v_mfma_f32_16x16x32_bf16 v[148:151], a[72:75], a[156:159], v[148:151]
    s_waitcnt lgkmcnt(3)
    ds_read_b64_tr_b16 a[86:87], v17 offset:51200
    v_accvgpr_write_b32 a166, v61
    v_mfma_f32_16x16x32_bf16 v[152:155], a[76:79], a[152:155], v[152:155]
    s_and_b32 s71, s3, 1
    ds_read_b64_tr_b16 a[88:89], v18 offset:49152
    v_mfma_f32_16x16x32_bf16 v[156:159], a[76:79], a[156:159], v[156:159]
    s_waitcnt lgkmcnt(3)
    ds_read_b64_tr_b16 a[90:91], v18 offset:51200
    buffer_load_dwordx4 v37, s[44:47], s70 offen offset:3072 lds
    v_mfma_f32_16x16x32_bf16 v[160:163], a[80:83], a[152:155], v[160:163]
    s_add_u32 s68, s68, 1
    s_cmp_eq_u32 s68, 7
    s_cselect_b32 s68, 0, s68
    s_add_u32 m0, s60, 147456
    v_mfma_f32_16x16x32_bf16 v[164:167], a[80:83], a[156:159], v[164:167]
    s_waitcnt lgkmcnt(2)
    ds_read_b64_tr_b16 a[92:93], v19 offset:49152
    ds_read_b64_tr_b16 a[94:95], v19 offset:51200
    v_mfma_f32_16x16x32_bf16 v[168:171], a[84:87], a[152:155], v[168:171]
    s_add_u32 s30, s30, s71
    ds_read_b64_tr_b16 a[96:97], v12 offset:49408
    v_accvgpr_write_b32 a167, v61
    v_mfma_f32_16x16x32_bf16 v[172:175], a[84:87], a[156:159], v[172:175]
    s_waitcnt lgkmcnt(3)
    ds_read_b64_tr_b16 a[98:99], v12 offset:51456
    buffer_load_dwordx4 v38, s[32:35], s69 offen offset:0 lds
    v_mfma_f32_16x16x32_bf16 v[176:179], a[88:91], a[152:155], v[176:179]
    s_lshl_b32 s30, s30, 6
    ds_read_b64_tr_b16 a[100:101], v13 offset:49408
    v_mfma_f32_16x16x32_bf16 v[180:183], a[88:91], a[156:159], v[180:183]
    s_waitcnt lgkmcnt(3)
    ds_read_b64_tr_b16 a[102:103], v13 offset:51456
    v_mfma_f32_16x16x32_bf16 v[184:187], a[92:95], a[152:155], v[184:187]
    s_add_u32 s31, s31, s30
    ds_read_b64_tr_b16 a[104:105], v14 offset:49408
    v_mov_b32 v68, 0
    v_mfma_f32_16x16x32_bf16 v[188:191], a[92:95], a[156:159], v[188:191]
    s_waitcnt lgkmcnt(3)
    ds_read_b64_tr_b16 a[106:107], v14 offset:51456
    buffer_load_dwordx4 v39, s[32:35], s69 offen offset:1024 lds
    v_mfma_f32_16x16x32_bf16 v[192:195], a[96:99], a[152:155], v[192:195]
    s_mul_i32 s30, s62, 896
    ds_read_b64_tr_b16 a[108:109], v15 offset:49408
    v_mfma_f32_16x16x32_bf16 v[196:199], a[96:99], a[156:159], v[196:199]
    s_waitcnt lgkmcnt(3)
    ds_read_b64_tr_b16 a[110:111], v15 offset:51456
    v_mov_b32 v69, 0
    v_mfma_f32_16x16x32_bf16 v[200:203], a[100:103], a[152:155], v[200:203]
    s_add_u32 s97, s31, s30
    ds_read_b64_tr_b16 a[112:113], v16 offset:49408
    v_mfma_f32_16x16x32_bf16 v[204:207], a[100:103], a[156:159], v[204:207]
    s_waitcnt lgkmcnt(3)
    ds_read_b64_tr_b16 a[114:115], v16 offset:51456
    buffer_load_dwordx4 v40, s[32:35], s69 offen offset:2048 lds
    v_mfma_f32_16x16x32_bf16 v[208:211], a[104:107], a[152:155], v[208:211]
    s_lshr_b32 s99, s3, 2
    ds_read_b64_tr_b16 a[116:117], v17 offset:49408
    v_mfma_f32_16x16x32_bf16 v[212:215], a[104:107], a[156:159], v[212:215]
    s_waitcnt lgkmcnt(3)
    ds_read_b64_tr_b16 a[118:119], v17 offset:51456
    v_mov_b32 v70, 0
    v_mfma_f32_16x16x32_bf16 v[216:219], a[108:111], a[152:155], v[216:219]
    s_xor_b32 s99, s99, 3
    ds_read_b64_tr_b16 a[120:121], v18 offset:49408
    v_mfma_f32_16x16x32_bf16 v[220:223], a[108:111], a[156:159], v[220:223]
    s_waitcnt vmcnt(11) lgkmcnt(3)
    ds_read_b64_tr_b16 a[122:123], v18 offset:51456
    buffer_load_dwordx4 v41, s[32:35], s69 offen offset:3072 lds
    v_mfma_f32_16x16x32_bf16 v[224:227], a[112:115], a[152:155], v[224:227]
    s_barrier
    ds_read_b64_tr_b16 a[124:125], v19 offset:49408
    ds_read_b64_tr_b16 a[126:127], v19 offset:51456
    v_mfma_f32_16x16x32_bf16 v[228:231], a[112:115], a[156:159], v[228:231]
    s_waitcnt lgkmcnt(4)
    ds_read_b128 a[128:131], v28 offset:0
    v_mov_b32 v71, 0
    v_mfma_f32_16x16x32_bf16 v[232:235], a[116:119], a[152:155], v[232:235]
    s_lshl_b32 s70, s68, 19
    s_add_u32 m0, s60, 98304
    ds_read_b128 a[132:135], v28 offset:2048
    v_mfma_f32_16x16x32_bf16 v[236:239], a[116:119], a[156:159], v[236:239]
    s_waitcnt lgkmcnt(4)
    ds_read_b64_tr_b16 a[64:65], v12 offset:0
    ds_read_b64_tr_b16 a[66:67], v12 offset:2048
    v_mfma_f32_16x16x32_bf16 v[240:243], a[120:123], a[152:155], v[240:243]
    ds_read_b128 a[136:139], v29 offset:0
    ds_read_b64_tr_b16 a[68:69], v13 offset:0
    v_mfma_f32_16x16x32_bf16 v[244:247], a[120:123], a[156:159], v[244:247]
    s_waitcnt lgkmcnt(6)
    ds_read_b64_tr_b16 a[70:71], v13 offset:2048
    buffer_load_dwordx4 v34, s[44:47], s70 offen offset:0 lds
    v_mfma_f32_16x16x32_bf16 v[248:251], a[124:127], a[152:155], v[248:251]
    ds_read_b128 a[140:143], v29 offset:2048
    ds_read_b64_tr_b16 a[72:73], v14 offset:0
    v_mfma_f32_16x16x32_bf16 v[252:255], a[124:127], a[156:159], v[252:255]
    s_waitcnt lgkmcnt(5)
    ds_read_b64_tr_b16 a[74:75], v14 offset:2048
    v_mfma_f32_16x16x32_bf16 v[128:131], a[64:67], a[128:131], v[128:131]
    ds_read_b64_tr_b16 a[76:77], v15 offset:0
    v_mfma_f32_16x16x32_bf16 v[132:135], a[64:67], a[132:135], v[132:135]
    s_waitcnt lgkmcnt(4)
    ds_read_b64_tr_b16 a[78:79], v15 offset:2048
    v_mul_u32_u24 v59, 1792, v58
    s_cmp_lg_u32 s61, 0
    s_cbranch_scc1 L_noann
    s_atomic_add s89, s[26:27], s88
L_noann:
    v_mfma_f32_16x16x32_bf16 v[136:139], a[68:71], a[128:131], v[136:139]
    ds_read_b64_tr_b16 a[80:81], v16 offset:0
    v_mfma_f32_16x16x32_bf16 v[140:143], a[68:71], a[132:135], v[140:143]
    s_waitcnt lgkmcnt(3)
    ds_read_b64_tr_b16 a[82:83], v16 offset:2048
    v_lshl_add_u32 v51, v51, 4, v59
    v_mfma_f32_16x16x32_bf16 v[144:147], a[72:75], a[128:131], v[144:147]
    ds_read_b64_tr_b16 a[84:85], v17 offset:0
    v_mfma_f32_16x16x32_bf16 v[148:151], a[72:75], a[132:135], v[148:151]
    s_waitcnt lgkmcnt(3)
    ds_read_b64_tr_b16 a[86:87], v17 offset:2048
    buffer_load_dwordx4 v35, s[44:47], s70 offen offset:1024 lds
    v_mfma_f32_16x16x32_bf16 v[152:155], a[76:79], a[128:131], v[152:155]
    ds_read_b64_tr_b16 a[88:89], v18 offset:0
    v_mfma_f32_16x16x32_bf16 v[156:159], a[76:79], a[132:135], v[156:159]
    s_waitcnt lgkmcnt(3)
    ds_read_b64_tr_b16 a[90:91], v18 offset:2048
    v_mfma_f32_16x16x32_bf16 v[160:163], a[80:83], a[128:131], v[160:163]
    ds_read_b64_tr_b16 a[92:93], v19 offset:0
    v_mfma_f32_16x16x32_bf16 v[164:167], a[80:83], a[132:135], v[164:167]
    s_waitcnt lgkmcnt(3)
    ds_read_b64_tr_b16 a[94:95], v19 offset:2048
    v_mfma_f32_16x16x32_bf16 v[168:171], a[84:87], a[128:131], v[168:171]
    ds_read_b64_tr_b16 a[96:97], v12 offset:256
    v_mfma_f32_16x16x32_bf16 v[172:175], a[84:87], a[132:135], v[172:175]
    s_waitcnt lgkmcnt(3)
    ds_read_b64_tr_b16 a[98:99], v12 offset:2304
    v_mfma_f32_16x16x32_bf16 v[176:179], a[88:91], a[128:131], v[176:179]
    ds_read_b64_tr_b16 a[100:101], v13 offset:256
    v_mfma_f32_16x16x32_bf16 v[180:183], a[88:91], a[132:135], v[180:183]
    s_waitcnt lgkmcnt(3)
    ds_read_b64_tr_b16 a[102:103], v13 offset:2304
    buffer_load_dwordx4 v36, s[44:47], s70 offen offset:2048 lds
    v_mfma_f32_16x16x32_bf16 v[184:187], a[92:95], a[128:131], v[184:187]
    ds_read_b64_tr_b16 a[104:105], v14 offset:256
    v_mfma_f32_16x16x32_bf16 v[188:191], a[92:95], a[132:135], v[188:191]
    s_waitcnt lgkmcnt(3)
    ds_read_b64_tr_b16 a[106:107], v14 offset:2304
    v_mfma_f32_16x16x32_bf16 v[192:195], a[96:99], a[128:131], v[192:195]
    ds_read_b64_tr_b16 a[108:109], v15 offset:256
    v_mfma_f32_16x16x32_bf16 v[196:199], a[96:99], a[132:135], v[196:199]
    s_waitcnt lgkmcnt(3)
    ds_read_b64_tr_b16 a[110:111], v15 offset:2304
    v_mfma_f32_16x16x32_bf16 v[200:203], a[100:103], a[128:131], v[200:203]
    ds_read_b64_tr_b16 a[112:113], v16 offset:256
    v_mfma_f32_16x16x32_bf16 v[204:207], a[100:103], a[132:135], v[204:207]
    s_waitcnt lgkmcnt(3)
    ds_read_b64_tr_b16 a[114:115], v16 offset:2304
    v_mfma_f32_16x16x32_bf16 v[208:211], a[104:107], a[128:131], v[208:211]
    ds_read_b64_tr_b16 a[116:117], v17 offset:256
    v_mfma_f32_16x16x32_bf16 v[212:215], a[104:107], a[132:135], v[212:215]
    s_waitcnt lgkmcnt(3)
    ds_read_b64_tr_b16 a[118:119], v17 offset:2304
    buffer_load_dwordx4 v37, s[44:47], s70 offen offset:3072 lds
    v_mfma_f32_16x16x32_bf16 v[216:219], a[108:111], a[128:131], v[216:219]
    ds_read_b64_tr_b16 a[120:121], v18 offset:256
    v_mfma_f32_16x16x32_bf16 v[220:223], a[108:111], a[132:135], v[220:223]
    s_waitcnt lgkmcnt(3)
    ds_read_b64_tr_b16 a[122:123], v18 offset:2304
    v_mfma_f32_16x16x32_bf16 v[224:227], a[112:115], a[128:131], v[224:227]
    s_barrier
    s_lshl_b32 s69, s68, 7
    s_add_u32 s70, s70, 0x40000
    s_add_u32 m0, s60, 114688
    v_mfma_f32_16x16x32_bf16 v[228:231], a[112:115], a[132:135], v[228:231]
    s_waitcnt lgkmcnt(2)
    ds_read_b64_tr_b16 a[124:125], v19 offset:256
    ds_read_b64_tr_b16 a[126:127], v19 offset:2304
    v_mfma_f32_16x16x32_bf16 v[232:235], a[116:119], a[128:131], v[232:235]
    ds_read_b64_tr_b16 a[64:65], v20 offset:32768
    v_mfma_f32_16x16x32_bf16 v[236:239], a[116:119], a[132:135], v[236:239]
    s_waitcnt lgkmcnt(3)
    ds_read_b64_tr_b16 a[66:67], v20 offset:34816
    buffer_load_dwordx4 v34, s[44:47], s70 offen offset:0 lds
    v_mfma_f32_16x16x32_bf16 v[240:243], a[120:123], a[128:131], v[240:243]
    ds_read_b64_tr_b16 a[68:69], v21 offset:32768
    v_mfma_f32_16x16x32_bf16 v[244:247], a[120:123], a[132:135], v[244:247]
    s_waitcnt lgkmcnt(3)
    ds_read_b64_tr_b16 a[70:71], v21 offset:34816
    v_mfma_f32_16x16x32_bf16 v[248:251], a[124:127], a[128:131], v[248:251]
    ds_read_b64_tr_b16 a[72:73], v22 offset:32768
    v_mfma_f32_16x16x32_bf16 v[252:255], a[124:127], a[132:135], v[252:255]
    s_waitcnt lgkmcnt(3)
    ds_read_b64_tr_b16 a[74:75], v22 offset:34816
    buffer_load_dwordx4 v35, s[44:47], s70 offen offset:1024 lds
    v_mfma_f32_16x16x32_bf16 v[128:131], a[64:67], a[136:139], v[128:131]
    ds_read_b64_tr_b16 a[76:77], v23 offset:32768
    v_mfma_f32_16x16x32_bf16 v[132:135], a[64:67], a[140:143], v[132:135]
    s_waitcnt lgkmcnt(3)
    ds_read_b64_tr_b16 a[78:79], v23 offset:34816
    v_mfma_f32_16x16x32_bf16 v[136:139], a[68:71], a[136:139], v[136:139]
    ds_read_b64_tr_b16 a[80:81], v24 offset:32768
    v_mfma_f32_16x16x32_bf16 v[140:143], a[68:71], a[140:143], v[140:143]
    s_waitcnt lgkmcnt(3)
    ds_read_b64_tr_b16 a[82:83], v24 offset:34816
    buffer_load_dwordx4 v36, s[44:47], s70 offen offset:2048 lds
    v_mfma_f32_16x16x32_bf16 v[144:147], a[72:75], a[136:139], v[144:147]
    ds_read_b64_tr_b16 a[84:85], v25 offset:32768
    v_mfma_f32_16x16x32_bf16 v[148:151], a[72:75], a[140:143], v[148:151]
    s_waitcnt lgkmcnt(3)
    ds_read_b64_tr_b16 a[86:87], v25 offset:34816
    v_mfma_f32_16x16x32_bf16 v[152:155], a[76:79], a[136:139], v[152:155]
    ds_read_b64_tr_b16 a[88:89], v26 offset:32768
    v_mfma_f32_16x16x32_bf16 v[156:159], a[76:79], a[140:143], v[156:159]
    s_waitcnt lgkmcnt(3)
    ds_read_b64_tr_b16 a[90:91], v26 offset:34816
    buffer_load_dwordx4 v37, s[44:47], s70 offen offset:3072 lds
    v_mfma_f32_16x16x32_bf16 v[160:163], a[80:83], a[136:139], v[160:163]
    s_add_u32 s68, s68, 1
    s_cmp_eq_u32 s68, 7
    s_cselect_b32 s68, 0, s68
    s_add_u32 m0, s60, 131072
    v_mfma_f32_16x16x32_bf16 v[164:167], a[80:83], a[140:143], v[164:167]
    s_waitcnt lgkmcnt(2)
    ds_read_b64_tr_b16 a[92:93], v27 offset:32768
    ds_read_b64_tr_b16 a[94:95], v27 offset:34816
    v_mfma_f32_16x16x32_bf16 v[168:171], a[84:87], a[136:139], v[168:171]
    ds_read_b64_tr_b16 a[96:97], v20 offset:33024
    v_mfma_f32_16x16x32_bf16 v[172:175], a[84:87], a[140:143], v[172:175]
    s_waitcnt lgkmcnt(3)
    ds_read_b64_tr_b16 a[98:99], v20 offset:35072
    buffer_load_dwordx4 v38, s[32:35], s69 offen offset:0 lds
    v_mfma_f32_16x16x32_bf16 v[176:179], a[88:91], a[136:139], v[176:179]
    ds_read_b64_tr_b16 a[100:101], v21 offset:33024
    v_mfma_f32_16x16x32_bf16 v[180:183], a[88:91], a[140:143], v[180:183]
    s_waitcnt lgkmcnt(3)
    ds_read_b64_tr_b16 a[102:103], v21 offset:35072
    v_mfma_f32_16x16x32_bf16 v[184:187], a[92:95], a[136:139], v[184:187]
    ds_read_b64_tr_b16 a[104:105], v22 offset:33024
    v_mfma_f32_16x16x32_bf16 v[188:191], a[92:95], a[140:143], v[188:191]
    s_waitcnt lgkmcnt(3)
    ds_read_b64_tr_b16 a[106:107], v22 offset:35072
    buffer_load_dwordx4 v39, s[32:35], s69 offen offset:1024 lds
    v_mfma_f32_16x16x32_bf16 v[192:195], a[96:99], a[136:139], v[192:195]
    ds_read_b64_tr_b16 a[108:109], v23 offset:33024
    v_mfma_f32_16x16x32_bf16 v[196:199], a[96:99], a[140:143], v[196:199]
    s_waitcnt lgkmcnt(3)
    ds_read_b64_tr_b16 a[110:111], v23 offset:35072
    v_mfma_f32_16x16x32_bf16 v[200:203], a[100:103], a[136:139], v[200:203]
    ds_read_b64_tr_b16 a[112:113], v24 offset:33024
    v_mfma_f32_16x16x32_bf16 v[204:207], a[100:103], a[140:143], v[204:207]
    s_waitcnt lgkmcnt(3)
    ds_read_b64_tr_b16 a[114:115], v24 offset:35072
    buffer_load_dwordx4 v40, s[32:35], s69 offen offset:2048 lds
    v_mfma_f32_16x16x32_bf16 v[208:211], a[104:107], a[136:139], v[208:211]
    ds_read_b64_tr_b16 a[116:117], v25 offset:33024
    v_mfma_f32_16x16x32_bf16 v[212:215], a[104:107], a[140:143], v[212:215]
    s_waitcnt lgkmcnt(3)
    ds_read_b64_tr_b16 a[118:119], v25 offset:35072
    v_mfma_f32_16x16x32_bf16 v[216:219], a[108:111], a[136:139], v[216:219]
    ds_read_b64_tr_b16 a[120:121], v26 offset:33024
    v_mfma_f32_16x16x32_bf16 v[220:223], a[108:111], a[140:143], v[220:223]
    s_waitcnt vmcnt(11) lgkmcnt(3)
    ds_read_b64_tr_b16 a[122:123], v26 offset:35072
    buffer_load_dwordx4 v41, s[32:35], s69 offen offset:3072 lds
    v_mfma_f32_16x16x32_bf16 v[224:227], a[112:115], a[136:139], v[224:227]
    s_barrier
    ds_read_b64_tr_b16 a[124:125], v27 offset:33024
    ds_read_b64_tr_b16 a[126:127], v27 offset:35072
    ds_read_b128 a[144:147], v28 offset:16384
    v_mfma_f32_16x16x32_bf16 v[228:231], a[112:115], a[140:143], v[228:231]
    s_waitcnt lgkmcnt(5)
    ds_read_b64_tr_b16 a[64:65], v12 offset:16384
    ds_read_b64_tr_b16 a[66:67], v12 offset:18432
    v_mfma_f32_16x16x32_bf16 v[232:235], a[116:119], a[136:139], v[232:235]
    s_add_u32 m0, s60, 65536
    ds_read_b128 a[148:151], v28 offset:18432
    ds_read_b64_tr_b16 a[68:69], v13 offset:16384
    v_mfma_f32_16x16x32_bf16 v[236:239], a[116:119], a[140:143], v[236:239]
    s_waitcnt lgkmcnt(7)
    ds_read_b64_tr_b16 a[70:71], v13 offset:18432
    v_mfma_f32_16x16x32_bf16 v[240:243], a[120:123], a[136:139], v[240:243]
    ds_read_b128 a[152:155], v29 offset:16384
    ds_read_b64_tr_b16 a[72:73], v14 offset:16384
    v_mfma_f32_16x16x32_bf16 v[244:247], a[120:123], a[140:143], v[244:247]
    s_waitcnt lgkmcnt(8)
    ds_read_b64_tr_b16 a[74:75], v14 offset:18432
    buffer_load_dwordx4 v32, s[40:43], s67 offen offset:0 nt lds
    v_mfma_f32_16x16x32_bf16 v[248:251], a[124:127], a[136:139], v[248:251]
    ds_read_b128 a[156:159], v29 offset:18432
    ds_read_b64_tr_b16 a[76:77], v15 offset:16384
    v_mfma_f32_16x16x32_bf16 v[252:255], a[124:127], a[140:143], v[252:255]
    s_waitcnt lgkmcnt(7)
    ds_read_b64_tr_b16 a[78:79], v15 offset:18432
    v_mfma_f32_16x16x32_bf16 v[128:131], a[64:67], a[144:147], v[128:131]
    ds_read_b64_tr_b16 a[80:81], v16 offset:16384
    v_mfma_f32_16x16x32_bf16 v[132:135], a[64:67], a[148:151], v[132:135]
    s_waitcnt lgkmcnt(7)
    ds_read_b64_tr_b16 a[82:83], v16 offset:18432
    v_mfma_f32_16x16x32_bf16 v[136:139], a[68:71], a[144:147], v[136:139]
    ds_read_b64_tr_b16 a[84:85], v17 offset:16384
    v_mfma_f32_16x16x32_bf16 v[140:143], a[68:71], a[148:151], v[140:143]
    s_waitcnt lgkmcnt(6)
    ds_read_b64_tr_b16 a[86:87], v17 offset:18432
    buffer_load_dwordx4 v33, s[40:43], s67 offen offset:1024 nt lds
    v_mfma_f32_16x16x32_bf16 v[144:147], a[72:75], a[144:147], v[144:147]
    ds_read_b64_tr_b16 a[88:89], v18 offset:16384
    v_mfma_f32_16x16x32_bf16 v[148:151], a[72:75], a[148:151], v[148:151]
    s_waitcnt lgkmcnt(5)
    ds_read_b64_tr_b16 a[90:91], v18 offset:18432
    v_mfma_f32_16x16x32_bf16 v[152:155], a[76:79], a[144:147], v[152:155]
    ds_read_b64_tr_b16 a[92:93], v19 offset:16384
    v_mfma_f32_16x16x32_bf16 v[156:159], a[76:79], a[148:151], v[156:159]
    s_waitcnt lgkmcnt(5)
    ds_read_b64_tr_b16 a[94:95], v19 offset:18432
    v_mfma_f32_16x16x32_bf16 v[160:163], a[80:83], a[144:147], v[160:163]
    ds_read_b64_tr_b16 a[96:97], v12 offset:16640
    v_mfma_f32_16x16x32_bf16 v[164:167], a[80:83], a[148:151], v[164:167]
    s_waitcnt lgkmcnt(5)
    ds_read_b64_tr_b16 a[98:99], v12 offset:18688
    v_mfma_f32_16x16x32_bf16 v[168:171], a[84:87], a[144:147], v[168:171]
    ds_read_b64_tr_b16 a[100:101], v13 offset:16640
    v_mfma_f32_16x16x32_bf16 v[172:175], a[84:87], a[148:151], v[172:175]
    s_waitcnt lgkmcnt(5)
    ds_read_b64_tr_b16 a[102:103], v13 offset:18688
    buffer_load_dwordx4 v32, s[40:43], s67 offen offset:2048 nt lds
    v_mfma_f32_16x16x32_bf16 v[176:179], a[88:91], a[144:147], v[176:179]
    ds_read_b64_tr_b16 a[104:105], v14 offset:16640
    v_mfma_f32_16x16x32_bf16 v[180:183], a[88:91], a[148:151], v[180:183]
    s_waitcnt lgkmcnt(5)
    ds_read_b64_tr_b16 a[106:107], v14 offset:18688
    v_mfma_f32_16x16x32_bf16 v[184:187], a[92:95], a[144:147], v[184:187]
    ds_read_b64_tr_b16 a[108:109], v15 offset:16640
    v_mfma_f32_16x16x32_bf16 v[188:191], a[92:95], a[148:151], v[188:191]
    s_waitcnt lgkmcnt(5)
    ds_read_b64_tr_b16 a[110:111], v15 offset:18688
    v_mfma_f32_16x16x32_bf16 v[192:195], a[96:99], a[144:147], v[192:195]
    ds_read_b64_tr_b16 a[112:113], v16 offset:16640
    v_mfma_f32_16x16x32_bf16 v[196:199], a[96:99], a[148:151], v[196:199]
    s_waitcnt lgkmcnt(5)
    ds_read_b64_tr_b16 a[114:115], v16 offset:18688
    v_mfma_f32_16x16x32_bf16 v[200:203], a[100:103], a[144:147], v[200:203]
    ds_read_b64_tr_b16 a[116:117], v17 offset:16640
    v_mfma_f32_16x16x32_bf16 v[204:207], a[100:103], a[148:151], v[204:207]
    s_waitcnt lgkmcnt(5)
    ds_read_b64_tr_b16 a[118:119], v17 offset:18688
    buffer_load_dwordx4 v33, s[40:43], s67 offen offset:3072 nt lds
    v_mfma_f32_16x16x32_bf16 v[208:211], a[104:107], a[144:147], v[208:211]
    s_add_u32 s67, s67, 16384
    ds_read_b64_tr_b16 a[120:121], v18 offset:16640
    v_mfma_f32_16x16x32_bf16 v[212:215], a[104:107], a[148:151], v[212:215]
    s_waitcnt lgkmcnt(5)
    ds_read_b64_tr_b16 a[122:123], v18 offset:18688
    v_mfma_f32_16x16x32_bf16 v[216:219], a[108:111], a[144:147], v[216:219]
    s_and_b32 s67, s67, 0x7ffff
    ds_read_b64_tr_b16 a[124:125], v19 offset:16640
    v_mfma_f32_16x16x32_bf16 v[220:223], a[108:111], a[148:151], v[220:223]
    s_waitcnt lgkmcnt(5)
    ds_read_b64_tr_b16 a[126:127], v19 offset:18688
    v_mfma_f32_16x16x32_bf16 v[224:227], a[112:115], a[144:147], v[224:227]
    s_barrier
    s_add_u32 m0, s60, 32768
    ds_read_b64_tr_b16 a[64:65], v20 offset:49152
    v_mfma_f32_16x16x32_bf16 v[228:231], a[112:115], a[148:151], v[228:231]
    s_waitcnt lgkmcnt(5)
    ds_read_b64_tr_b16 a[66:67], v20 offset:51200
    v_mfma_f32_16x16x32_bf16 v[232:235], a[116:119], a[144:147], v[232:235]
    ds_read_b64_tr_b16 a[68:69], v21 offset:49152
    v_mfma_f32_16x16x32_bf16 v[236:239], a[116:119], a[148:151], v[236:239]
    s_waitcnt lgkmcnt(5)
    ds_read_b64_tr_b16 a[70:71], v21 offset:51200
    buffer_load_dwordx4 v30, s[36:39], s66 offen offset:0 nt lds
    v_mfma_f32_16x16x32_bf16 v[240:243], a[120:123], a[144:147], v[240:243]
    ds_read_b64_tr_b16 a[72:73], v22 offset:49152
    v_mfma_f32_16x16x32_bf16 v[244:247], a[120:123], a[148:151], v[244:247]
    s_waitcnt lgkmcnt(5)
    ds_read_b64_tr_b16 a[74:75], v22 offset:51200
    v_mfma_f32_16x16x32_bf16 v[248:251], a[124:127], a[144:147], v[248:251]
    ds_read_b64_tr_b16 a[76:77], v23 offset:49152
    v_mfma_f32_16x16x32_bf16 v[252:255], a[124:127], a[148:151], v[252:255]
    s_waitcnt lgkmcnt(5)
    ds_read_b64_tr_b16 a[78:79], v23 offset:51200
    v_mfma_f32_16x16x32_bf16 v[128:131], a[64:67], a[152:155], v[128:131]
    ds_read_b64_tr_b16 a[80:81], v24 offset:49152
    v_mfma_f32_16x16x32_bf16 v[132:135], a[64:67], a[156:159], v[132:135]
    s_waitcnt lgkmcnt(5)
    ds_read_b64_tr_b16 a[82:83], v24 offset:51200
    buffer_load_dwordx4 v31, s[36:39], s66 offen offset:1024 nt lds
    v_mfma_f32_16x16x32_bf16 v[136:139], a[68:71], a[152:155], v[136:139]
    ds_read_b64_tr_b16 a[84:85], v25 offset:49152
    v_mfma_f32_16x16x32_bf16 v[140:143], a[68:71], a[156:159], v[140:143]
    s_waitcnt lgkmcnt(5)
    ds_read_b64_tr_b16 a[86:87], v25 offset:51200
    v_mfma_f32_16x16x32_bf16 v[144:147], a[72:75], a[152:155], v[144:147]
    ds_read_b64_tr_b16 a[88:89], v26 offset:49152
    v_mfma_f32_16x16x32_bf16 v[148:151], a[72:75], a[156:159], v[148:151]
    s_waitcnt lgkmcnt(5)
    ds_read_b64_tr_b16 a[90:91], v26 offset:51200
    v_mfma_f32_16x16x32_bf16 v[152:155], a[76:79], a[152:155], v[152:155]
    ds_read_b64_tr_b16 a[92:93], v27 offset:49152
    v_mfma_f32_16x16x32_bf16 v[156:159], a[76:79], a[156:159], v[156:159]
    s_waitcnt lgkmcnt(5)
    ds_read_b64_tr_b16 a[94:95], v27 offset:51200
    v_mfma_f32_16x16x32_bf16 v[160:163], a[80:83], a[152:155], v[160:163]
    ds_read_b64_tr_b16 a[96:97], v20 offset:49408
    v_mfma_f32_16x16x32_bf16 v[164:167], a[80:83], a[156:159], v[164:167]
    s_waitcnt lgkmcnt(5)
    ds_read_b64_tr_b16 a[98:99], v20 offset:51456
    buffer_load_dwordx4 v30, s[36:39], s66 offen offset:2048 nt lds
    v_mfma_f32_16x16x32_bf16 v[168:171], a[84:87], a[152:155], v[168:171]
    ds_read_b64_tr_b16 a[100:101], v21 offset:49408
    v_mfma_f32_16x16x32_bf16 v[172:175], a[84:87], a[156:159], v[172:175]
    s_waitcnt lgkmcnt(5)
    ds_read_b64_tr_b16 a[102:103], v21 offset:51456
    v_mfma_f32_16x16x32_bf16 v[176:179], a[88:91], a[152:155], v[176:179]
    ds_read_b64_tr_b16 a[104:105], v22 offset:49408
    v_mfma_f32_16x16x32_bf16 v[180:183], a[88:91], a[156:159], v[180:183]
    s_waitcnt lgkmcnt(5)
    ds_read_b64_tr_b16 a[106:107], v22 offset:51456
    v_mfma_f32_16x16x32_bf16 v[184:187], a[92:95], a[152:155], v[184:187]
    ds_read_b64_tr_b16 a[108:109], v23 offset:49408
    v_mfma_f32_16x16x32_bf16 v[188:191], a[92:95], a[156:159], v[188:191]
    s_waitcnt lgkmcnt(5)
    ds_read_b64_tr_b16 a[110:111], v23 offset:51456
    v_mfma_f32_16x16x32_bf16 v[192:195], a[96:99], a[152:155], v[192:195]
    ds_read_b64_tr_b16 a[112:113], v24 offset:49408
    v_mfma_f32_16x16x32_bf16 v[196:199], a[96:99], a[156:159], v[196:199]
    s_waitcnt lgkmcnt(5)
    ds_read_b64_tr_b16 a[114:115], v24 offset:51456
    buffer_load_dwordx4 v31, s[36:39], s66 offen offset:3072 nt lds
    v_mfma_f32_16x16x32_bf16 v[200:203], a[100:103], a[152:155], v[200:203]
    s_add_u32 s66, s66, 507904
    ds_read_b64_tr_b16 a[116:117], v25 offset:49408
    v_mfma_f32_16x16x32_bf16 v[204:207], a[100:103], a[156:159], v[204:207]
    s_waitcnt lgkmcnt(5)
    ds_read_b64_tr_b16 a[118:119], v25 offset:51456
    v_mfma_f32_16x16x32_bf16 v[208:211], a[104:107], a[152:155], v[208:211]
    s_and_b32 s66, s66, 0x7ffff
    ds_read_b64_tr_b16 a[120:121], v26 offset:49408
    v_mfma_f32_16x16x32_bf16 v[212:215], a[104:107], a[156:159], v[212:215]
    s_waitcnt lgkmcnt(5)
    ds_read_b64_tr_b16 a[122:123], v26 offset:51456
    v_mfma_f32_16x16x32_bf16 v[216:219], a[108:111], a[152:155], v[216:219]
    ds_read_b64_tr_b16 a[124:125], v27 offset:49408
    v_mfma_f32_16x16x32_bf16 v[220:223], a[108:111], a[156:159], v[220:223]
    s_waitcnt vmcnt(8) lgkmcnt(5)
    ds_read_b64_tr_b16 a[126:127], v27 offset:51456
    v_mfma_f32_16x16x32_bf16 v[224:227], a[112:115], a[152:155], v[224:227]
    s_barrier
    ds_read_b128 a[128:131], v28 offset:0
    ds_read_b128 a[132:135], v28 offset:2048
    v_mfma_f32_16x16x32_bf16 v[228:231], a[112:115], a[156:159], v[228:231]
    s_waitcnt lgkmcnt(6)
    ds_read_b64_tr_b16 a[64:65], v12 offset:32768
    ds_read_b64_tr_b16 a[66:67], v12 offset:34816
    v_mfma_f32_16x16x32_bf16 v[232:235], a[116:119], a[152:155], v[232:235]
    ds_read_b128 a[136:139], v29 offset:0
    ds_read_b128 a[140:143], v29 offset:2048
    v_mfma_f32_16x16x32_bf16 v[236:239], a[116:119], a[156:159], v[236:239]
    s_waitcnt lgkmcnt(8)
    ds_read_b64_tr_b16 a[68:69], v12 offset:49152
    ds_read_b64_tr_b16 a[70:71], v12 offset:51200
    v_mfma_f32_16x16x32_bf16 v[240:243], a[120:123], a[152:155], v[240:243]
    ds_read_b64_tr_b16 a[72:73], v13 offset:32768
    v_mfma_f32_16x16x32_bf16 v[244:247], a[120:123], a[156:159], v[244:247]
    s_waitcnt lgkmcnt(9)
    ds_read_b64_tr_b16 a[74:75], v13 offset:34816
    v_mfma_f32_16x16x32_bf16 v[248:251], a[124:127], a[152:155], v[248:251]
    ds_read_b64_tr_b16 a[76:77], v13 offset:49152
    v_mfma_f32_16x16x32_bf16 v[252:255], a[124:127], a[156:159], v[252:255]
    s_waitcnt lgkmcnt(7)
    ds_read_b64_tr_b16 a[78:79], v13 offset:51200
    v_mfma_f32_16x16x32_bf16 v[128:131], a[64:67], a[128:131], v[128:131]
    s_add_u32 m0, s60, 81920
    ds_read_b64_tr_b16 a[80:81], v14 offset:32768
    v_mfma_f32_16x16x32_bf16 v[132:135], a[64:67], a[132:135], v[132:135]
    s_waitcnt lgkmcnt(5)
    ds_read_b64_tr_b16 a[82:83], v14 offset:34816
    v_mfma_f32_16x16x32_bf16 v[128:131], a[68:71], a[136:139], v[128:131]
    ds_read_b64_tr_b16 a[84:85], v14 offset:49152
    v_mfma_f32_16x16x32_bf16 v[132:135], a[68:71], a[140:143], v[132:135]
    s_waitcnt lgkmcnt(5)
    ds_read_b64_tr_b16 a[86:87], v14 offset:51200
    buffer_load_dwordx4 v32, s[40:43], s67 offen offset:0 nt lds
    v_mfma_f32_16x16x32_bf16 v[136:139], a[72:75], a[128:131], v[136:139]
    ds_read_b64_tr_b16 a[88:89], v15 offset:32768
    v_mfma_f32_16x16x32_bf16 v[140:143], a[72:75], a[132:135], v[140:143]
    s_waitcnt lgkmcnt(5)
    ds_read_b64_tr_b16 a[90:91], v15 offset:34816
    v_mfma_f32_16x16x32_bf16 v[136:139], a[76:79], a[136:139], v[136:139]
    ds_read_b64_tr_b16 a[92:93], v15 offset:49152
    v_mfma_f32_16x16x32_bf16 v[140:143], a[76:79], a[140:143], v[140:143]
    s_waitcnt lgkmcnt(5)
    ds_read_b64_tr_b16 a[94:95], v15 offset:51200
    v_mfma_f32_16x16x32_bf16 v[144:147], a[80:83], a[128:131], v[144:147]
    ds_read_b128 a[96:99], v8 offset:0
    v_mfma_f32_16x16x32_bf16 v[148:151], a[80:83], a[132:135], v[148:151]
    s_waitcnt lgkmcnt(5)
    buffer_load_dwordx4 v33, s[40:43], s67 offen offset:1024 nt lds
    v_pk_mul_f32 v[128:129], v[128:129], s[82:83]
    v_pk_mul_f32 v[130:131], v[130:131], s[82:83]
    v_pk_mul_f32 v[136:137], v[136:137], s[82:83]
    v_pk_mul_f32 v[138:139], v[138:139], s[82:83]
    v_pk_mul_f32 v[132:133], v[132:133], s[82:83]
    v_pk_mul_f32 v[134:135], v[134:135], s[82:83]
    v_pk_mul_f32 v[140:141], v[140:141], s[82:83]
    v_pk_mul_f32 v[142:143], v[142:143], s[82:83]
    v_mfma_f32_16x16x32_bf16 v[144:147], a[84:87], a[136:139], v[144:147]
    ds_read_b128 a[100:103], v8 offset:2048
    v_cvt_pk_bf16_f32 v128, v128, v129
    v_cvt_pk_bf16_f32 v136, v136, v137
    v_cvt_pk_bf16_f32 v129, v130, v131
    v_mfma_f32_16x16x32_bf16 v[148:151], a[84:87], a[140:143], v[148:151]
    s_waitcnt lgkmcnt(4)
    v_cvt_pk_bf16_f32 v137, v138, v139
    v_cvt_pk_bf16_f32 v132, v132, v133
    v_cvt_pk_bf16_f32 v140, v140, v141
    v_cvt_pk_bf16_f32 v133, v134, v135
    v_cvt_pk_bf16_f32 v141, v142, v143
    v_mfma_f32_16x16x32_bf16 v[152:155], a[88:91], a[128:131], v[152:155]
    ds_read_b64_tr_b16 a[104:105], v16 offset:32768
    v_permlane16_swap_b32 v128, v136
    v_permlane16_swap_b32 v129, v137
    v_mfma_f32_16x16x32_bf16 v[156:159], a[88:91], a[132:135], v[156:159]
    s_waitcnt lgkmcnt(3)
    ds_read_b64_tr_b16 a[106:107], v16 offset:34816
    v_permlane16_swap_b32 v132, v140
    v_permlane16_swap_b32 v133, v141
    v_mfma_f32_16x16x32_bf16 v[152:155], a[92:95], a[136:139], v[152:155]
    ds_read_b64_tr_b16 a[108:109], v16 offset:49152
    v_accvgpr_write_b32 a0, v128
    v_accvgpr_write_b32 a1, v129
    v_accvgpr_write_b32 a2, v136
    v_accvgpr_write_b32 a3, v137
    v_mfma_f32_16x16x32_bf16 v[156:159], a[92:95], a[140:143], v[156:159]
    s_waitcnt lgkmcnt(4)
    ds_read_b64_tr_b16 a[110:111], v16 offset:51200
    v_accvgpr_write_b32 a4, v132
    v_accvgpr_write_b32 a5, v133
    v_accvgpr_write_b32 a6, v140
    v_accvgpr_write_b32 a7, v141
    v_mfma_f32_16x16x32_bf16 v[96:99], a[96:99], a[0:3], 0
    ds_read_b64_tr_b16 a[112:113], v17 offset:32768
    v_mfma_f32_16x16x32_bf16 v[104:107], a[96:99], a[4:7], 0
    s_waitcnt lgkmcnt(5)
    ds_read_b64_tr_b16 a[114:115], v17 offset:34816
    buffer_load_dwordx4 v32, s[40:43], s67 offen offset:2048 nt lds
    v_pk_mul_f32 v[144:145], v[144:145], s[82:83]
    v_pk_mul_f32 v[146:147], v[146:147], s[82:83]
    v_pk_mul_f32 v[152:153], v[152:153], s[82:83]
    v_pk_mul_f32 v[154:155], v[154:155], s[82:83]
    v_pk_mul_f32 v[148:149], v[148:149], s[82:83]
    v_pk_mul_f32 v[150:151], v[150:151], s[82:83]
    v_pk_mul_f32 v[156:157], v[156:157], s[82:83]
    v_pk_mul_f32 v[158:159], v[158:159], s[82:83]
    v_mfma_f32_16x16x32_bf16 v[100:103], a[100:103], a[0:3], 0
    ds_read_b64_tr_b16 a[116:117], v17 offset:49152
    v_cvt_pk_bf16_f32 v144, v144, v145
    v_cvt_pk_bf16_f32 v152, v152, v153
    v_mfma_f32_16x16x32_bf16 v[108:111], a[100:103], a[4:7], 0
    s_waitcnt lgkmcnt(5)
    ds_read_b64_tr_b16 a[118:119], v17 offset:51200
    v_cvt_pk_bf16_f32 v145, v146, v147
    v_cvt_pk_bf16_f32 v153, v154, v155
    v_cvt_pk_bf16_f32 v148, v148, v149
    v_mfma_f32_16x16x32_bf16 v[160:163], a[104:107], a[128:131], v[160:163]
    ds_read_b128 a[120:123], v9 offset:0
    v_cvt_pk_bf16_f32 v156, v156, v157
    v_cvt_pk_bf16_f32 v149, v150, v151
    v_mfma_f32_16x16x32_bf16 v[164:167], a[104:107], a[132:135], v[164:167]
    s_waitcnt lgkmcnt(5)
    v_cvt_pk_bf16_f32 v157, v158, v159
    v_permlane16_swap_b32 v144, v152
    v_mfma_f32_16x16x32_bf16 v[160:163], a[108:111], a[136:139], v[160:163]
    ds_read_b128 a[124:127], v9 offset:2048
    v_permlane16_swap_b32 v145, v153
    v_mfma_f32_16x16x32_bf16 v[164:167], a[108:111], a[140:143], v[164:167]
    s_waitcnt lgkmcnt(4)
    v_permlane16_swap_b32 v148, v156
    v_permlane16_swap_b32 v149, v157
    v_mfma_f32_16x16x32_bf16 v[168:171], a[112:115], a[128:131], v[168:171]
    ds_read_b64_tr_b16 a[64:65], v18 offset:32768
    v_accvgpr_write_b32 a8, v144
    v_accvgpr_write_b32 a9, v145
    v_mfma_f32_16x16x32_bf16 v[172:175], a[112:115], a[132:135], v[172:175]
    s_waitcnt lgkmcnt(3)
    ds_read_b64_tr_b16 a[66:67], v18 offset:34816
    buffer_load_dwordx4 v33, s[40:43], s67 offen offset:3072 nt lds
    v_accvgpr_write_b32 a10, v152
    v_accvgpr_write_b32 a11, v153
    v_mfma_f32_16x16x32_bf16 v[168:171], a[116:119], a[136:139], v[168:171]
    s_add_u32 s67, s67, 32768
    ds_read_b64_tr_b16 a[68:69], v18 offset:49152
    v_accvgpr_write_b32 a12, v148
    v_accvgpr_write_b32 a13, v149
    v_mfma_f32_16x16x32_bf16 v[172:175], a[116:119], a[140:143], v[172:175]
    s_waitcnt lgkmcnt(4)
    ds_read_b64_tr_b16 a[70:71], v18 offset:51200
    v_accvgpr_write_b32 a14, v156
    v_accvgpr_write_b32 a15, v157
    v_mfma_f32_16x16x32_bf16 v[96:99], a[120:123], a[8:11], v[96:99]
    s_and_b32 s67, s67, 0x7ffff
    s_add_u32 m0, s60, 131072
    ds_read_b64_tr_b16 a[72:73], v19 offset:32768
    v_mfma_f32_16x16x32_bf16 v[104:107], a[120:123], a[12:15], v[104:107]
    s_waitcnt lgkmcnt(5)
    ds_read_b64_tr_b16 a[74:75], v19 offset:34816
    v_pk_mul_f32 v[160:161], v[160:161], s[82:83]
    v_pk_mul_f32 v[162:163], v[162:163], s[82:83]
    v_pk_mul_f32 v[168:169], v[168:169], s[82:83]
    v_pk_mul_f32 v[170:171], v[170:171], s[82:83]
    v_pk_mul_f32 v[164:165], v[164:165], s[82:83]
    v_pk_mul_f32 v[166:167], v[166:167], s[82:83]
    v_pk_mul_f32 v[172:173], v[172:173], s[82:83]
    v_pk_mul_f32 v[174:175], v[174:175], s[82:83]
    v_mfma_f32_16x16x32_bf16 v[100:103], a[124:127], a[8:11], v[100:103]
    ds_read_b64_tr_b16 a[76:77], v19 offset:49152
    v_cvt_pk_bf16_f32 v160, v160, v161
    v_cvt_pk_bf16_f32 v168, v168, v169
    v_cvt_pk_bf16_f32 v161, v162, v163
    v_mfma_f32_16x16x32_bf16 v[108:111], a[124:127], a[12:15], v[108:111]
    s_waitcnt lgkmcnt(5)
    ds_read_b64_tr_b16 a[78:79], v19 offset:51200
    buffer_load_dwordx4 v42, s[48:51], s4 offen offset:0 lds
    v_cvt_pk_bf16_f32 v169, v170, v171
    v_cvt_pk_bf16_f32 v164, v164, v165
    v_mfma_f32_16x16x32_bf16 v[176:179], a[64:67], a[128:131], v[176:179]
    ds_read_b128 a[80:83], v10 offset:0
    v_cvt_pk_bf16_f32 v172, v172, v173
    v_cvt_pk_bf16_f32 v165, v166, v167
    v_mfma_f32_16x16x32_bf16 v[180:183], a[64:67], a[132:135], v[180:183]
    s_waitcnt lgkmcnt(5)
    v_cvt_pk_bf16_f32 v173, v174, v175
    v_permlane16_swap_b32 v160, v168
    v_mfma_f32_16x16x32_bf16 v[176:179], a[68:71], a[136:139], v[176:179]
    ds_read_b128 a[84:87], v10 offset:2048
    v_permlane16_swap_b32 v161, v169
    v_mfma_f32_16x16x32_bf16 v[180:183], a[68:71], a[140:143], v[180:183]
    s_waitcnt lgkmcnt(4)
    v_permlane16_swap_b32 v164, v172
    v_permlane16_swap_b32 v165, v173
    v_mfma_f32_16x16x32_bf16 v[184:187], a[72:75], a[128:131], v[184:187]
    ds_read_b64_tr_b16 a[88:89], v12 offset:33024
    v_accvgpr_write_b32 a16, v160
    v_accvgpr_write_b32 a17, v161
    v_mfma_f32_16x16x32_bf16 v[188:191], a[72:75], a[132:135], v[188:191]
    s_waitcnt lgkmcnt(3)
    ds_read_b64_tr_b16 a[90:91], v12 offset:35072
    v_accvgpr_write_b32 a18, v168
    v_accvgpr_write_b32 a19, v169
    v_mfma_f32_16x16x32_bf16 v[184:187], a[76:79], a[136:139], v[184:187]
    ds_read_b64_tr_b16 a[92:93], v12 offset:49408
    v_accvgpr_write_b32 a20, v164
    v_accvgpr_write_b32 a21, v165
    v_mfma_f32_16x16x32_bf16 v[188:191], a[76:79], a[140:143], v[188:191]
    s_waitcnt lgkmcnt(4)
    ds_read_b64_tr_b16 a[94:95], v12 offset:51456
    buffer_load_dwordx4 v43, s[48:51], s4 offen offset:1024 lds
    v_accvgpr_write_b32 a22, v172
    v_accvgpr_write_b32 a23, v173
    v_mfma_f32_16x16x32_bf16 v[96:99], a[80:83], a[16:19], v[96:99]
    ds_read_b64_tr_b16 a[96:97], v13 offset:33024
    v_mfma_f32_16x16x32_bf16 v[104:107], a[80:83], a[20:23], v[104:107]
    s_waitcnt lgkmcnt(5)
    ds_read_b64_tr_b16 a[98:99], v13 offset:35072
    v_pk_mul_f32 v[176:177], v[176:177], s[82:83]
    v_pk_mul_f32 v[178:179], v[178:179], s[82:83]
    v_pk_mul_f32 v[184:185], v[184:185], s[82:83]
    v_pk_mul_f32 v[186:187], v[186:187], s[82:83]
    v_pk_mul_f32 v[180:181], v[180:181], s[82:83]
    v_pk_mul_f32 v[182:183], v[182:183], s[82:83]
    v_pk_mul_f32 v[188:189], v[188:189], s[82:83]
    v_pk_mul_f32 v[190:191], v[190:191], s[82:83]
    v_mfma_f32_16x16x32_bf16 v[100:103], a[84:87], a[16:19], v[100:103]
    ds_read_b64_tr_b16 a[100:101], v13 offset:49408
    v_cvt_pk_bf16_f32 v176, v176, v177
    v_cvt_pk_bf16_f32 v184, v184, v185
    v_mfma_f32_16x16x32_bf16 v[108:111], a[84:87], a[20:23], v[108:111]
    s_waitcnt lgkmcnt(5)
    ds_read_b64_tr_b16 a[102:103], v13 offset:51456
    v_cvt_pk_bf16_f32 v177, v178, v179
    v_cvt_pk_bf16_f32 v185, v186, v187
    v_cvt_pk_bf16_f32 v180, v180, v181
    v_mfma_f32_16x16x32_bf16 v[192:195], a[88:91], a[128:131], v[192:195]
    ds_read_b128 a[104:107], v11 offset:0
    v_cvt_pk_bf16_f32 v188, v188, v189
    v_cvt_pk_bf16_f32 v181, v182, v183
    v_mfma_f32_16x16x32_bf16 v[196:199], a[88:91], a[132:135], v[196:199]
    s_waitcnt lgkmcnt(5)
    v_cvt_pk_bf16_f32 v189, v190, v191
    v_permlane16_swap_b32 v176, v184
    v_mfma_f32_16x16x32_bf16 v[192:195], a[92:95], a[136:139], v[192:195]
    ds_read_b128 a[108:111], v11 offset:2048
    buffer_load_dwordx4 v44, s[48:51], s4 offen offset:2048 lds
    v_permlane16_swap_b32 v177, v185
    v_mfma_f32_16x16x32_bf16 v[196:199], a[92:95], a[140:143], v[196:199]
    s_waitcnt lgkmcnt(4)
    v_permlane16_swap_b32 v180, v188
    v_permlane16_swap_b32 v181, v189
    v_mfma_f32_16x16x32_bf16 v[200:203], a[96:99], a[128:131], v[200:203]
    ds_read_b64_tr_b16 a[112:113], v14 offset:33024
    v_accvgpr_write_b32 a24, v176
    v_accvgpr_write_b32 a25, v177
    v_mfma_f32_16x16x32_bf16 v[204:207], a[96:99], a[132:135], v[204:207]
    s_waitcnt lgkmcnt(3)
    ds_read_b64_tr_b16 a[114:115], v14 offset:35072
    v_accvgpr_write_b32 a26, v184
    v_accvgpr_write_b32 a27, v185
    v_mfma_f32_16x16x32_bf16 v[200:203], a[100:103], a[136:139], v[200:203]
    ds_read_b64_tr_b16 a[116:117], v14 offset:49408
    v_accvgpr_write_b32 a28, v180
    v_accvgpr_write_b32 a29, v181
    v_mfma_f32_16x16x32_bf16 v[204:207], a[100:103], a[140:143], v[204:207]
    s_waitcnt lgkmcnt(4)
    ds_read_b64_tr_b16 a[118:119], v14 offset:51456
    v_accvgpr_write_b32 a30, v188
    v_accvgpr_write_b32 a31, v189
    v_mfma_f32_16x16x32_bf16 v[96:99], a[104:107], a[24:27], v[96:99]
    ds_read_b64_tr_b16 a[120:121], v15 offset:33024
    v_mfma_f32_16x16x32_bf16 v[104:107], a[104:107], a[28:31], v[104:107]
    s_waitcnt lgkmcnt(5)
    ds_read_b64_tr_b16 a[122:123], v15 offset:35072
    buffer_load_dwordx4 v45, s[48:51], s4 offen offset:3072 lds
    v_pk_mul_f32 v[192:193], v[192:193], s[82:83]
    v_pk_mul_f32 v[194:195], v[194:195], s[82:83]
    v_pk_mul_f32 v[200:201], v[200:201], s[82:83]
    v_pk_mul_f32 v[202:203], v[202:203], s[82:83]
    v_pk_mul_f32 v[196:197], v[196:197], s[82:83]
    v_pk_mul_f32 v[198:199], v[198:199], s[82:83]
    v_pk_mul_f32 v[204:205], v[204:205], s[82:83]
    v_pk_mul_f32 v[206:207], v[206:207], s[82:83]
    v_mfma_f32_16x16x32_bf16 v[100:103], a[108:111], a[24:27], v[100:103]
    ds_read_b64_tr_b16 a[124:125], v15 offset:49408
    v_cvt_pk_bf16_f32 v192, v192, v193
    v_cvt_pk_bf16_f32 v200, v200, v201
    v_mfma_f32_16x16x32_bf16 v[108:111], a[108:111], a[28:31], v[108:111]
    s_waitcnt lgkmcnt(5)
    ds_read_b64_tr_b16 a[126:127], v15 offset:51456
    v_cvt_pk_bf16_f32 v193, v194, v195
    v_cvt_pk_bf16_f32 v201, v202, v203
    v_cvt_pk_bf16_f32 v196, v196, v197
    v_mfma_f32_16x16x32_bf16 v[208:211], a[112:115], a[128:131], v[208:211]
    ds_read_b128 a[64:67], v8 offset:256
    v_cvt_pk_bf16_f32 v204, v204, v205
    v_cvt_pk_bf16_f32 v197, v198, v199
    v_mfma_f32_16x16x32_bf16 v[212:215], a[112:115], a[132:135], v[212:215]
    s_waitcnt lgkmcnt(5)
    v_cvt_pk_bf16_f32 v205, v206, v207
    v_permlane16_swap_b32 v192, v200
    v_mfma_f32_16x16x32_bf16 v[208:211], a[116:119], a[136:139], v[208:211]
    s_add_u32 m0, s60, 147456
    ds_read_b128 a[68:71], v8 offset:2304
    v_permlane16_swap_b32 v193, v201
    v_mfma_f32_16x16x32_bf16 v[212:215], a[116:119], a[140:143], v[212:215]
    s_waitcnt lgkmcnt(4)
    v_permlane16_swap_b32 v196, v204
    v_permlane16_swap_b32 v197, v205
    v_mfma_f32_16x16x32_bf16 v[216:219], a[120:123], a[128:131], v[216:219]
    ds_read_b64_tr_b16 a[72:73], v16 offset:33024
    v_accvgpr_write_b32 a32, v192
    v_accvgpr_write_b32 a33, v193
    v_mfma_f32_16x16x32_bf16 v[220:223], a[120:123], a[132:135], v[220:223]
    s_waitcnt lgkmcnt(3)
    ds_read_b64_tr_b16 a[74:75], v16 offset:35072
    buffer_load_dwordx4 v42, s[48:51], s5 offen offset:0 lds
    v_accvgpr_write_b32 a34, v200
    v_accvgpr_write_b32 a35, v201
    v_mfma_f32_16x16x32_bf16 v[216:219], a[124:127], a[136:139], v[216:219]
    ds_read_b64_tr_b16 a[76:77], v16 offset:49408
    v_accvgpr_write_b32 a36, v196
    v_accvgpr_write_b32 a37, v197
    v_mfma_f32_16x16x32_bf16 v[220:223], a[124:127], a[140:143], v[220:223]
    s_waitcnt lgkmcnt(4)
    ds_read_b64_tr_b16 a[78:79], v16 offset:51456
    v_accvgpr_write_b32 a38, v204
    v_accvgpr_write_b32 a39, v205
    v_mfma_f32_16x16x32_bf16 v[96:99], a[64:67], a[32:35], v[96:99]
    ds_read_b64_tr_b16 a[80:81], v17 offset:33024
    v_mfma_f32_16x16x32_bf16 v[104:107], a[64:67], a[36:39], v[104:107]
    s_waitcnt lgkmcnt(5)
    ds_read_b64_tr_b16 a[82:83], v17 offset:35072
    v_pk_mul_f32 v[208:209], v[208:209], s[82:83]
    v_pk_mul_f32 v[210:211], v[210:211], s[82:83]
    v_pk_mul_f32 v[216:217], v[216:217], s[82:83]
    v_pk_mul_f32 v[218:219], v[218:219], s[82:83]
    v_pk_mul_f32 v[212:213], v[212:213], s[82:83]
    v_pk_mul_f32 v[214:215], v[214:215], s[82:83]
    v_pk_mul_f32 v[220:221], v[220:221], s[82:83]
    v_pk_mul_f32 v[222:223], v[222:223], s[82:83]
    v_mfma_f32_16x16x32_bf16 v[100:103], a[68:71], a[32:35], v[100:103]
    ds_read_b64_tr_b16 a[84:85], v17 offset:49408
    v_cvt_pk_bf16_f32 v208, v208, v209
    v_cvt_pk_bf16_f32 v216, v216, v217
    v_mfma_f32_16x16x32_bf16 v[108:111], a[68:71], a[36:39], v[108:111]
    s_waitcnt lgkmcnt(5)
    ds_read_b64_tr_b16 a[86:87], v17 offset:51456
    v_cvt_pk_bf16_f32 v209, v210, v211
    v_cvt_pk_bf16_f32 v217, v218, v219
    v_cvt_pk_bf16_f32 v212, v212, v213
    v_mfma_f32_16x16x32_bf16 v[224:227], a[72:75], a[128:131], v[224:227]
    ds_read_b128 a[88:91], v9 offset:256
    buffer_load_dwordx4 v43, s[48:51], s5 offen offset:1024 lds
    v_cvt_pk_bf16_f32 v220, v220, v221
    v_mfma_f32_16x16x32_bf16 v[228:231], a[72:75], a[132:135], v[228:231]
    s_waitcnt lgkmcnt(5)
    v_cvt_pk_bf16_f32 v213, v214, v215
    v_cvt_pk_bf16_f32 v221, v222, v223
    v_permlane16_swap_b32 v208, v216
    v_mfma_f32_16x16x32_bf16 v[224:227], a[76:79], a[136:139], v[224:227]
    ds_read_b128 a[92:95], v9 offset:2304
    v_permlane16_swap_b32 v209, v217
    v_mfma_f32_16x16x32_bf16 v[228:231], a[76:79], a[140:143], v[228:231]
    s_waitcnt lgkmcnt(4)
    v_permlane16_swap_b32 v212, v220
    v_permlane16_swap_b32 v213, v221
    v_mfma_f32_16x16x32_bf16 v[232:235], a[80:83], a[128:131], v[232:235]
    ds_read_b64_tr_b16 a[96:97], v18 offset:33024
    v_accvgpr_write_b32 a40, v208
    v_accvgpr_write_b32 a41, v209
    v_mfma_f32_16x16x32_bf16 v[236:239], a[80:83], a[132:135], v[236:239]
    s_waitcnt lgkmcnt(3)
    ds_read_b64_tr_b16 a[98:99], v18 offset:35072
    v_accvgpr_write_b32 a42, v216
    v_accvgpr_write_b32 a43, v217
    v_mfma_f32_16x16x32_bf16 v[232:235], a[84:87], a[136:139], v[232:235]
    ds_read_b64_tr_b16 a[100:101], v18 offset:49408
    v_accvgpr_write_b32 a44, v212
    v_accvgpr_write_b32 a45, v213
    v_mfma_f32_16x16x32_bf16 v[236:239], a[84:87], a[140:143], v[236:239]
    s_waitcnt lgkmcnt(4)
    ds_read_b64_tr_b16 a[102:103], v18 offset:51456
    buffer_load_dwordx4 v44, s[48:51], s5 offen offset:2048 lds
    v_accvgpr_write_b32 a46, v220
    v_accvgpr_write_b32 a47, v221
    v_mfma_f32_16x16x32_bf16 v[96:99], a[88:91], a[40:43], v[96:99]
    ds_read_b64_tr_b16 a[104:105], v19 offset:33024
    v_mfma_f32_16x16x32_bf16 v[104:107], a[88:91], a[44:47], v[104:107]
    s_waitcnt lgkmcnt(5)
    ds_read_b64_tr_b16 a[106:107], v19 offset:35072
    v_pk_mul_f32 v[224:225], v[224:225], s[82:83]
    v_pk_mul_f32 v[226:227], v[226:227], s[82:83]
    v_pk_mul_f32 v[232:233], v[232:233], s[82:83]
    v_pk_mul_f32 v[234:235], v[234:235], s[82:83]
    v_pk_mul_f32 v[228:229], v[228:229], s[82:83]
    v_pk_mul_f32 v[230:231], v[230:231], s[82:83]
    v_pk_mul_f32 v[236:237], v[236:237], s[82:83]
    v_pk_mul_f32 v[238:239], v[238:239], s[82:83]
    v_mfma_f32_16x16x32_bf16 v[100:103], a[92:95], a[40:43], v[100:103]
    ds_read_b64_tr_b16 a[108:109], v19 offset:49408
    v_cvt_pk_bf16_f32 v224, v224, v225
    v_cvt_pk_bf16_f32 v232, v232, v233
    v_mfma_f32_16x16x32_bf16 v[108:111], a[92:95], a[44:47], v[108:111]
    s_waitcnt lgkmcnt(5)
    ds_read_b64_tr_b16 a[110:111], v19 offset:51456
    v_cvt_pk_bf16_f32 v225, v226, v227
    v_cvt_pk_bf16_f32 v233, v234, v235
    v_cvt_pk_bf16_f32 v228, v228, v229
    v_mfma_f32_16x16x32_bf16 v[240:243], a[96:99], a[128:131], v[240:243]
    ds_read_b128 a[112:115], v10 offset:256
    v_cvt_pk_bf16_f32 v236, v236, v237
    v_cvt_pk_bf16_f32 v229, v230, v231
    v_mfma_f32_16x16x32_bf16 v[244:247], a[96:99], a[132:135], v[244:247]
    s_waitcnt lgkmcnt(5)
    v_cvt_pk_bf16_f32 v237, v238, v239
    v_permlane16_swap_b32 v224, v232
    v_mfma_f32_16x16x32_bf16 v[240:243], a[100:103], a[136:139], v[240:243]
    ds_read_b128 a[116:119], v10 offset:2304
    buffer_load_dwordx4 v45, s[48:51], s5 offen offset:3072 lds
    v_permlane16_swap_b32 v225, v233
    v_mfma_f32_16x16x32_bf16 v[244:247], a[100:103], a[140:143], v[244:247]
    s_waitcnt lgkmcnt(4)
    v_permlane16_swap_b32 v228, v236
    v_permlane16_swap_b32 v229, v237
    v_mfma_f32_16x16x32_bf16 v[248:251], a[104:107], a[128:131], v[248:251]
    ds_read_b128 a[120:123], v11 offset:256
    v_accvgpr_write_b32 a48, v224
    v_mfma_f32_16x16x32_bf16 v[252:255], a[104:107], a[132:135], v[252:255]
    s_waitcnt lgkmcnt(3)
    v_accvgpr_write_b32 a49, v225
    v_accvgpr_write_b32 a50, v232
    v_accvgpr_write_b32 a51, v233
    v_mfma_f32_16x16x32_bf16 v[248:251], a[108:111], a[136:139], v[248:251]
    ds_read_b128 a[124:127], v11 offset:2304
    v_accvgpr_write_b32 a52, v228
    v_mfma_f32_16x16x32_bf16 v[252:255], a[108:111], a[140:143], v[252:255]
    s_waitcnt lgkmcnt(3)
    v_accvgpr_write_b32 a53, v229
    v_accvgpr_write_b32 a54, v236
    v_accvgpr_write_b32 a55, v237
    v_mfma_f32_16x16x32_bf16 v[96:99], a[112:115], a[48:51], v[96:99]
    s_nop 0
    v_mfma_f32_16x16x32_bf16 v[104:107], a[112:115], a[52:55], v[104:107]
    s_waitcnt lgkmcnt(2)
    v_pk_mul_f32 v[240:241], v[240:241], s[82:83]
    v_pk_mul_f32 v[242:243], v[242:243], s[82:83]
    v_pk_mul_f32 v[248:249], v[248:249], s[82:83]
    v_pk_mul_f32 v[250:251], v[250:251], s[82:83]
    v_pk_mul_f32 v[244:245], v[244:245], s[82:83]
    v_pk_mul_f32 v[246:247], v[246:247], s[82:83]
    v_pk_mul_f32 v[252:253], v[252:253], s[82:83]
    v_pk_mul_f32 v[254:255], v[254:255], s[82:83]
    v_mfma_f32_16x16x32_bf16 v[100:103], a[116:119], a[48:51], v[100:103]
    v_cvt_pk_bf16_f32 v240, v240, v241
    v_cvt_pk_bf16_f32 v248, v248, v249
    v_cvt_pk_bf16_f32 v241, v242, v243
    v_cvt_pk_bf16_f32 v249, v250, v251
    v_cvt_pk_bf16_f32 v244, v244, v245
    v_cvt_pk_bf16_f32 v252, v252, v253
    v_cvt_pk_bf16_f32 v245, v246, v247
    v_cvt_pk_bf16_f32 v253, v254, v255
    v_permlane16_swap_b32 v240, v248
    v_permlane16_swap_b32 v241, v249
    v_mfma_f32_16x16x32_bf16 v[108:111], a[116:119], a[52:55], v[108:111]
    s_waitcnt lgkmcnt(1)
    v_permlane16_swap_b32 v244, v252
    v_permlane16_swap_b32 v245, v253
    v_accvgpr_write_b32 a56, v240
    v_accvgpr_write_b32 a57, v241
    v_accvgpr_write_b32 a58, v248
    v_accvgpr_write_b32 a59, v249
    v_accvgpr_write_b32 a60, v244
    v_accvgpr_write_b32 a61, v245
    v_accvgpr_write_b32 a62, v252
    v_accvgpr_write_b32 a63, v253
    v_mfma_f32_16x16x32_bf16 v[96:99], a[120:123], a[56:59], v[96:99]
    s_nop 0
    v_mfma_f32_16x16x32_bf16 v[104:107], a[120:123], a[60:63], v[104:107]
    s_waitcnt lgkmcnt(0)
    v_mfma_f32_16x16x32_bf16 v[100:103], a[124:127], a[56:59], v[100:103]
    v_mfma_f32_16x16x32_bf16 v[108:111], a[124:127], a[60:63], v[108:111]
    s_waitcnt vmcnt(16)
    s_barrier
    ds_read_b128 a[64:67], v8 offset:16384
    ds_read_b128 a[68:71], v8 offset:18432
    ds_read_b128 a[72:75], v9 offset:16384
    ds_read_b128 a[76:79], v9 offset:18432
    v_max3_f32 v62, v96, v97, v98
    v_max3_f32 v63, v104, v105, v106
    v_max3_f32 v62, v62, v99, v100
    v_max3_f32 v63, v63, v107, v108
    v_max3_f32 v62, v62, v101, v102
    v_max3_f32 v63, v63, v109, v110
    v_max_f32 v62, v62, v103
    v_max_f32 v63, v63, v111
    v_mov_b32 v0, v62
    v_mov_b32 v1, v63
    s_nop 0
    v_permlane32_swap_b32 v62, v0
    v_permlane32_swap_b32 v63, v1
    v_max_f32 v62, v62, v0
    v_max_f32 v63, v63, v1
    v_mov_b32 v0, v62
    v_mov_b32 v1, v63
    s_nop 0
    v_permlane16_swap_b32 v62, v0
    v_permlane16_swap_b32 v63, v1
    v_max_f32 v62, v62, v0
    v_max_f32 v63, v63, v1
    v_sub_f32 v72, 0, v62
    v_sub_f32 v73, 0, v62
    v_sub_f32 v74, 0, v62
    v_sub_f32 v75, 0, v62
    v_sub_f32 v76, 0, v63
    v_sub_f32 v77, 0, v63
    v_sub_f32 v78, 0, v63
    v_sub_f32 v79, 0, v63
    v_sub_f32 v96, v96, v62
    v_sub_f32 v97, v97, v62
    v_sub_f32 v98, v98, v62
    v_sub_f32 v99, v99, v62
    v_sub_f32 v100, v100, v62
    v_sub_f32 v101, v101, v62
    v_sub_f32 v102, v102, v62
    v_sub_f32 v103, v103, v62
    v_sub_f32 v104, v104, v63
    v_sub_f32 v105, v105, v63
    v_sub_f32 v106, v106, v63
    v_sub_f32 v107, v107, v63
    v_sub_f32 v108, v108, v63
    v_sub_f32 v109, v109, v63
    v_sub_f32 v110, v110, v63
    v_sub_f32 v111, v111, v63
    v_exp_f32 v0, v96
    v_exp_f32 v1, v97
    v_exp_f32 v2, v98
    v_cvt_pk_bf16_f32 v80, v0, v1
    v_exp_f32 v3, v99
    v_exp_f32 v4, v100
    v_cvt_pk_bf16_f32 v81, v2, v3
    v_exp_f32 v5, v101
    v_exp_f32 v6, v102
    v_cvt_pk_bf16_f32 v82, v4, v5
    v_exp_f32 v7, v103
    v_exp_f32 v0, v104
    s_waitcnt lgkmcnt(3)
    v_mfma_f32_16x16x32_bf16 v[112:115], a[64:67], a[0:3], v[72:75]
    ds_read_b128 a[80:83], v10 offset:16384
    v_cvt_pk_bf16_f32 v83, v6, v7
    v_mfma_f32_16x16x32_bf16 v[120:123], a[64:67], a[4:7], v[76:79]
    s_waitcnt lgkmcnt(3)
    v_exp_f32 v1, v105
    v_mfma_f32_16x16x32_bf16 v[116:119], a[68:71], a[0:3], v[72:75]
    v_exp_f32 v2, v106
    v_mfma_f32_16x16x32_bf16 v[124:127], a[68:71], a[4:7], v[76:79]
    s_waitcnt lgkmcnt(2)
    ds_read_b128 a[84:87], v10 offset:18432
    v_add_u32 v20, 65536, v46
    v_mfma_f32_16x16x32_bf16 v[112:115], a[72:75], a[8:11], v[112:115]
    ds_read_b128 a[88:91], v11 offset:16384
    v_cvt_pk_bf16_f32 v84, v0, v1
    v_mfma_f32_16x16x32_bf16 v[120:123], a[72:75], a[12:15], v[120:123]
    s_waitcnt lgkmcnt(3)
    v_add_u32 v21, 65536, v47
    v_add_u32 v22, 65536, v48
    v_mfma_f32_16x16x32_bf16 v[116:119], a[76:79], a[8:11], v[116:119]
    v_exp_f32 v3, v107
    v_mfma_f32_16x16x32_bf16 v[124:127], a[76:79], a[12:15], v[124:127]
    s_waitcnt lgkmcnt(2)
    ds_read_b128 a[92:95], v11 offset:18432
    v_add_u32 v23, 65536, v49
    v_mfma_f32_16x16x32_bf16 v[112:115], a[80:83], a[16:19], v[112:115]
    v_exp_f32 v4, v108
    v_mfma_f32_16x16x32_bf16 v[120:123], a[80:83], a[20:23], v[120:123]
    s_waitcnt lgkmcnt(2)
    ds_read_b128 a[96:99], v8 offset:16640
    v_add_u32 v24, 131072, v46
    v_mfma_f32_16x16x32_bf16 v[116:119], a[84:87], a[16:19], v[116:119]
    ds_read_b128 a[100:103], v8 offset:18688
    v_cvt_pk_bf16_f32 v85, v2, v3
    v_mfma_f32_16x16x32_bf16 v[124:127], a[84:87], a[20:23], v[124:127]
    s_waitcnt lgkmcnt(3)
    v_add_u32 v25, 131072, v47
    v_add_u32 v26, 131072, v48
    v_mfma_f32_16x16x32_bf16 v[112:115], a[88:91], a[24:27], v[112:115]
    v_exp_f32 v5, v109
    v_mfma_f32_16x16x32_bf16 v[120:123], a[88:91], a[28:31], v[120:123]
    s_waitcnt lgkmcnt(2)
    ds_read_b128 a[104:107], v9 offset:16640
    v_add_u32 v27, 131072, v49
    v_mfma_f32_16x16x32_bf16 v[116:119], a[92:95], a[24:27], v[116:119]
    s_add_u32 m0, s60, 98304
    ds_read_b128 a[108:111], v9 offset:18688
    v_mfma_f32_16x16x32_bf16 v[124:127], a[92:95], a[28:31], v[124:127]
    s_waitcnt lgkmcnt(3)
    v_exp_f32 v6, v110
    v_mfma_f32_16x16x32_bf16 v[112:115], a[96:99], a[32:35], v[112:115]
    ds_read_b128 a[112:115], v10 offset:16640
    buffer_load_dwordx4 v32, s[40:43], s67 offen offset:0 nt lds
    v_mfma_f32_16x16x32_bf16 v[120:123], a[96:99], a[36:39], v[120:123]
    s_waitcnt lgkmcnt(3)
    v_cvt_pk_bf16_f32 v86, v4, v5
    v_mfma_f32_16x16x32_bf16 v[116:119], a[100:103], a[32:35], v[116:119]
    ds_read_b128 a[116:119], v10 offset:18688
    v_mfma_f32_16x16x32_bf16 v[124:127], a[100:103], a[36:39], v[124:127]
    s_waitcnt lgkmcnt(3)
    v_exp_f32 v7, v111
    v_mfma_f32_16x16x32_bf16 v[112:115], a[104:107], a[40:43], v[112:115]
    ds_read_b128 a[120:123], v11 offset:16640
    buffer_load_dwordx4 v33, s[40:43], s67 offen offset:1024 nt lds
    v_mfma_f32_16x16x32_bf16 v[120:123], a[104:107], a[44:47], v[120:123]
    s_waitcnt lgkmcnt(3)
    v_cvt_pk_bf16_f32 v87, v6, v7
    v_mfma_f32_16x16x32_bf16 v[116:119], a[108:111], a[40:43], v[116:119]
    ds_read_b128 a[124:127], v11 offset:18688
    v_mfma_f32_16x16x32_bf16 v[124:127], a[108:111], a[44:47], v[124:127]
    s_waitcnt lgkmcnt(3)
    v_mfma_f32_16x16x32_bf16 v[64:67], a[160:163], v[80:83], v[68:71]
    v_mfma_f32_16x16x32_bf16 v[64:67], a[164:167], v[84:87], v[64:67]
    v_mfma_f32_16x16x32_bf16 v[112:115], a[112:115], a[48:51], v[112:115]
    ds_read_b64_tr_b16 a[64:65], v12 offset:0
    v_mfma_f32_16x16x32_bf16 v[120:123], a[112:115], a[52:55], v[120:123]
    s_waitcnt lgkmcnt(3)
    ds_read_b64_tr_b16 a[66:67], v12 offset:2048
    buffer_load_dwordx4 v32, s[40:43], s67 offen offset:2048 nt lds
    v_mfma_f32_16x16x32_bf16 v[116:119], a[116:119], a[48:51], v[116:119]
    ds_read_b64_tr_b16 a[68:69], v13 offset:0
    v_mfma_f32_16x16x32_bf16 v[124:127], a[116:119], a[52:55], v[124:127]
    s_waitcnt lgkmcnt(4)
    ds_read_b64_tr_b16 a[70:71], v13 offset:2048
    v_mfma_f32_16x16x32_bf16 v[112:115], a[120:123], a[56:59], v[112:115]
    ds_read_b64_tr_b16 a[72:73], v14 offset:0
    v_cmp_nge_f32 vcc, s72, v64
    v_mfma_f32_16x16x32_bf16 v[120:123], a[120:123], a[60:63], v[120:123]
    s_waitcnt lgkmcnt(5)
    ds_read_b64_tr_b16 a[74:75], v14 offset:2048
    buffer_load_dwordx4 v33, s[40:43], s67 offen offset:3072 nt lds
    v_mfma_f32_16x16x32_bf16 v[116:119], a[124:127], a[56:59], v[116:119]
    s_add_u32 s67, s67, 507904
    s_add_u32 m0, s60, 49152
    s_cbranch_vccnz L_fixp0
L_retp0:
    v_mfma_f32_16x16x32_bf16 v[124:127], a[124:127], a[60:63], v[124:127]
    s_waitcnt lgkmcnt(4)
    ds_read_b64_tr_b16 a[76:77], v15 offset:0
    ds_read_b64_tr_b16 a[78:79], v15 offset:2048
    v_mfma_f32_16x16x32_bf16 v[128:131], a[64:67], v[80:83], 0
    s_and_b32 s67, s67, 0x7ffff
    ds_read_b64_tr_b16 a[80:81], v16 offset:0
    v_mfma_f32_16x16x32_bf16 v[132:135], a[64:67], v[84:87], 0
    s_waitcnt lgkmcnt(5)
    ds_read_b64_tr_b16 a[82:83], v16 offset:2048
    buffer_load_dwordx4 v30, s[36:39], s66 offen offset:0 nt lds
    v_mfma_f32_16x16x32_bf16 v[136:139], a[68:71], v[80:83], 0
    ds_read_b64_tr_b16 a[84:85], v17 offset:0
    v_mfma_f32_16x16x32_bf16 v[140:143], a[68:71], v[84:87], 0
    s_waitcnt lgkmcnt(5)
    ds_read_b64_tr_b16 a[86:87], v17 offset:2048
    v_mfma_f32_16x16x32_bf16 v[144:147], a[72:75], v[80:83], 0
    ds_read_b64_tr_b16 a[88:89], v18 offset:0
    v_mfma_f32_16x16x32_bf16 v[148:151], a[72:75], v[84:87], 0
    s_waitcnt lgkmcnt(5)
    ds_read_b64_tr_b16 a[90:91], v18 offset:2048
    buffer_load_dwordx4 v31, s[36:39], s66 offen offset:1024 nt lds
    v_mfma_f32_16x16x32_bf16 v[152:155], a[76:79], v[80:83], 0
    ds_read_b64_tr_b16 a[92:93], v19 offset:0
    ds_read_b64_tr_b16 a[94:95], v19 offset:2048
    v_mfma_f32_16x16x32_bf16 v[156:159], a[76:79], v[84:87], 0
    s_waitcnt lgkmcnt(6)
    v_exp_f32 v0, v112
    v_mfma_f32_16x16x32_bf16 v[160:163], a[80:83], v[80:83], 0
    ds_read_b64_tr_b16 a[96:97], v12 offset:256
    ds_read_b64_tr_b16 a[98:99], v12 offset:2304
    v_mfma_f32_16x16x32_bf16 v[164:167], a[80:83], v[84:87], 0
    s_waitcnt lgkmcnt(6)
    v_exp_f32 v1, v113
    v_mfma_f32_16x16x32_bf16 v[168:171], a[84:87], v[80:83], 0
    ds_read_b64_tr_b16 a[100:101], v13 offset:256
    ds_read_b64_tr_b16 a[102:103], v13 offset:2304
    v_mfma_f32_16x16x32_bf16 v[172:175], a[84:87], v[84:87], 0
    s_waitcnt lgkmcnt(6)
    v_exp_f32 v2, v114
    v_mfma_f32_16x16x32_bf16 v[176:179], a[88:91], v[80:83], 0
    ds_read_b64_tr_b16 a[104:105], v14 offset:256
    v_mfma_f32_16x16x32_bf16 v[180:183], a[88:91], v[84:87], 0
    s_waitcnt lgkmcnt(5)
    ds_read_b64_tr_b16 a[106:107], v14 offset:2304
    v_cvt_pk_bf16_f32 v88, v0, v1
    v_mfma_f32_16x16x32_bf16 v[184:187], a[92:95], v[80:83], 0
    ds_read_b64_tr_b16 a[108:109], v15 offset:256
    ds_read_b64_tr_b16 a[110:111], v15 offset:2304
    v_mfma_f32_16x16x32_bf16 v[188:191], a[92:95], v[84:87], 0
    s_waitcnt lgkmcnt(6)
    v_exp_f32 v3, v115
    v_mfma_f32_16x16x32_bf16 v[192:195], a[96:99], v[80:83], 0
    ds_read_b64_tr_b16 a[112:113], v16 offset:256
    v_mfma_f32_16x16x32_bf16 v[196:199], a[96:99], v[84:87], 0
    s_waitcnt lgkmcnt(5)
    ds_read_b64_tr_b16 a[114:115], v16 offset:2304
    v_mfma_f32_16x16x32_bf16 v[200:203], a[100:103], v[80:83], 0
    ds_read_b64_tr_b16 a[116:117], v17 offset:256
    ds_read_b64_tr_b16 a[118:119], v17 offset:2304
    v_mfma_f32_16x16x32_bf16 v[204:207], a[100:103], v[84:87], 0
    s_waitcnt lgkmcnt(6)
    v_exp_f32 v4, v116
    v_mfma_f32_16x16x32_bf16 v[208:211], a[104:107], v[80:83], 0
    ds_read_b64_tr_b16 a[120:121], v18 offset:256
    v_mfma_f32_16x16x32_bf16 v[212:215], a[104:107], v[84:87], 0
    s_waitcnt lgkmcnt(5)
    ds_read_b64_tr_b16 a[122:123], v18 offset:2304
    v_cvt_pk_bf16_f32 v89, v2, v3
    v_mfma_f32_16x16x32_bf16 v[216:219], a[108:111], v[80:83], 0
    ds_read_b64_tr_b16 a[124:125], v19 offset:256
    ds_read_b64_tr_b16 a[126:127], v19 offset:2304
    v_mfma_f32_16x16x32_bf16 v[220:223], a[108:111], v[84:87], 0
    s_waitcnt vmcnt(14) lgkmcnt(6)
    v_exp_f32 v5, v117
    v_mfma_f32_16x16x32_bf16 v[224:227], a[112:115], v[80:83], 0
    s_barrier
    ds_read_b128 a[64:67], v8 offset:32768
    v_mfma_f32_16x16x32_bf16 v[228:231], a[112:115], v[84:87], 0
    s_waitcnt lgkmcnt(5)
    v_exp_f32 v6, v118
    v_mfma_f32_16x16x32_bf16 v[232:235], a[116:119], v[80:83], 0
    ds_read_b128 a[68:71], v8 offset:34816
    v_mfma_f32_16x16x32_bf16 v[236:239], a[116:119], v[84:87], 0
    s_waitcnt lgkmcnt(4)
    v_cvt_pk_bf16_f32 v90, v4, v5
    v_mfma_f32_16x16x32_bf16 v[240:243], a[120:123], v[80:83], 0
    s_mov_b32 s73, -7
    ds_read_b128 a[72:75], v9 offset:32768
    v_mfma_f32_16x16x32_bf16 v[244:247], a[120:123], v[84:87], 0
    s_waitcnt lgkmcnt(3)
    v_exp_f32 v7, v119
    v_mfma_f32_16x16x32_bf16 v[248:251], a[124:127], v[80:83], 0
    ds_read_b128 a[76:79], v9 offset:34816
    v_mfma_f32_16x16x32_bf16 v[252:255], a[124:127], v[84:87], 0
    s_waitcnt lgkmcnt(3)
    v_exp_f32 v0, v120
.p2align 3
L_loop:
    v_mfma_f32_16x16x32_bf16 v[96:99], a[64:67], a[0:3], v[72:75]
    ds_read_b128 a[80:83], v10 offset:32768
    v_cvt_pk_bf16_f32 v91, v6, v7
    v_mfma_f32_16x16x32_bf16 v[104:107], a[64:67], a[4:7], v[76:79]
    s_waitcnt lgkmcnt(3)
    v_exp_f32 v1, v121
    v_mfma_f32_16x16x32_bf16 v[100:103], a[68:71], a[0:3], v[72:75]
    ds_read_b128 a[84:87], v10 offset:34816
    v_mfma_f32_16x16x32_bf16 v[108:111], a[68:71], a[4:7], v[76:79]
    s_waitcnt lgkmcnt(3)
    v_exp_f32 v2, v122
    v_mfma_f32_16x16x32_bf16 v[96:99], a[72:75], a[8:11], v[96:99]
    ds_read_b128 a[88:91], v11 offset:32768
    buffer_load_dwordx4 v30, s[36:39], s66 offen offset:2048 nt lds
    v_mfma_f32_16x16x32_bf16 v[104:107], a[72:75], a[12:15], v[104:107]
    s_waitcnt lgkmcnt(3)
    v_cvt_pk_bf16_f32 v92, v0, v1
    v_mfma_f32_16x16x32_bf16 v[100:103], a[76:79], a[8:11], v[100:103]
    ds_read_b128 a[92:95], v11 offset:34816
    v_mfma_f32_16x16x32_bf16 v[108:111], a[76:79], a[12:15], v[108:111]
    s_waitcnt lgkmcnt(3)
    v_exp_f32 v3, v123
    v_mfma_f32_16x16x32_bf16 v[96:99], a[80:83], a[16:19], v[96:99]
    ds_read_b128 a[96:99], v8 offset:33024
    buffer_load_dwordx4 v31, s[36:39], s66 offen offset:3072 nt lds
    v_mfma_f32_16x16x32_bf16 v[104:107], a[80:83], a[20:23], v[104:107]
    s_waitcnt lgkmcnt(3)
    v_exp_f32 v4, v124
    v_mfma_f32_16x16x32_bf16 v[100:103], a[84:87], a[16:19], v[100:103]
    s_add_u32 s66, s66, 32768
    ds_read_b128 a[100:103], v8 offset:35072
    v_mfma_f32_16x16x32_bf16 v[108:111], a[84:87], a[20:23], v[108:111]
    s_waitcnt lgkmcnt(3)
    v_cvt_pk_bf16_f32 v93, v2, v3
    v_mfma_f32_16x16x32_bf16 v[96:99], a[88:91], a[24:27], v[96:99]
    s_and_b32 s66, s66, 0x7ffff
    ds_read_b128 a[104:107], v9 offset:33024
    v_mfma_f32_16x16x32_bf16 v[104:107], a[88:91], a[28:31], v[104:107]
    s_waitcnt lgkmcnt(3)
    v_exp_f32 v5, v125
    v_mfma_f32_16x16x32_bf16 v[100:103], a[92:95], a[24:27], v[100:103]
    s_add_u32 m0, s60, 0
    ds_read_b128 a[108:111], v9 offset:35072
    v_mfma_f32_16x16x32_bf16 v[108:111], a[92:95], a[28:31], v[108:111]
    s_waitcnt lgkmcnt(3)
    v_exp_f32 v6, v126
    v_mfma_f32_16x16x32_bf16 v[96:99], a[96:99], a[32:35], v[96:99]
    ds_read_b128 a[112:115], v10 offset:33024
    buffer_load_dwordx4 v30, s[36:39], s66 offen offset:0 nt lds
    v_mfma_f32_16x16x32_bf16 v[104:107], a[96:99], a[36:39], v[104:107]
    s_waitcnt lgkmcnt(3)
    v_cvt_pk_bf16_f32 v94, v4, v5
    v_mfma_f32_16x16x32_bf16 v[100:103], a[100:103], a[32:35], v[100:103]
    ds_read_b128 a[116:119], v10 offset:35072
    v_mfma_f32_16x16x32_bf16 v[108:111], a[100:103], a[36:39], v[108:111]
    s_waitcnt lgkmcnt(3)
    v_exp_f32 v7, v127
    v_mfma_f32_16x16x32_bf16 v[96:99], a[104:107], a[40:43], v[96:99]
    ds_read_b128 a[120:123], v11 offset:33024
    buffer_load_dwordx4 v31, s[36:39], s66 offen offset:1024 nt lds
    v_mfma_f32_16x16x32_bf16 v[104:107], a[104:107], a[44:47], v[104:107]
    s_waitcnt lgkmcnt(3)
    v_cvt_pk_bf16_f32 v95, v6, v7
    v_mfma_f32_16x16x32_bf16 v[100:103], a[108:111], a[40:43], v[100:103]
    ds_read_b128 a[124:127], v11 offset:35072
    v_mfma_f32_16x16x32_bf16 v[108:111], a[108:111], a[44:47], v[108:111]
    s_waitcnt lgkmcnt(3)
    v_mfma_f32_16x16x32_bf16 v[68:71], a[160:163], v[88:91], v[64:67]
    v_mfma_f32_16x16x32_bf16 v[68:71], a[164:167], v[92:95], v[68:71]
    v_mfma_f32_16x16x32_bf16 v[96:99], a[112:115], a[48:51], v[96:99]
    ds_read_b64_tr_b16 a[64:65], v12 offset:16384
    v_mfma_f32_16x16x32_bf16 v[104:107], a[112:115], a[52:55], v[104:107]
    s_waitcnt lgkmcnt(3)
    ds_read_b64_tr_b16 a[66:67], v12 offset:18432
    buffer_load_dwordx4 v30, s[36:39], s66 offen offset:2048 nt lds
    v_mfma_f32_16x16x32_bf16 v[100:103], a[116:119], a[48:51], v[100:103]
    ds_read_b64_tr_b16 a[68:69], v13 offset:16384
    v_mfma_f32_16x16x32_bf16 v[108:111], a[116:119], a[52:55], v[108:111]
    s_waitcnt lgkmcnt(4)
    ds_read_b64_tr_b16 a[70:71], v13 offset:18432
    v_mfma_f32_16x16x32_bf16 v[96:99], a[120:123], a[56:59], v[96:99]
    ds_read_b64_tr_b16 a[72:73], v14 offset:16384
    v_cmp_nge_f32 vcc, s72, v68
    v_mfma_f32_16x16x32_bf16 v[104:107], a[120:123], a[60:63], v[104:107]
    s_waitcnt lgkmcnt(5)
    ds_read_b64_tr_b16 a[74:75], v14 offset:18432
    buffer_load_dwordx4 v31, s[36:39], s66 offen offset:3072 nt lds
    v_mfma_f32_16x16x32_bf16 v[100:103], a[124:127], a[56:59], v[100:103]
    s_add_u32 s66, s66, 16384
    s_add_u32 m0, s60, 114688
    s_cbranch_vccnz L_fix1
L_ret1:
    v_mfma_f32_16x16x32_bf16 v[108:111], a[124:127], a[60:63], v[108:111]
    s_waitcnt lgkmcnt(4)
    ds_read_b64_tr_b16 a[76:77], v15 offset:16384
    ds_read_b64_tr_b16 a[78:79], v15 offset:18432
    v_mfma_f32_16x16x32_bf16 v[128:131], a[64:67], v[88:91], v[128:131]
    s_and_b32 s66, s66, 0x7ffff
    ds_read_b64_tr_b16 a[80:81], v16 offset:16384
    v_mfma_f32_16x16x32_bf16 v[132:135], a[64:67], v[92:95], v[132:135]
    s_waitcnt lgkmcnt(5)
    ds_read_b64_tr_b16 a[82:83], v16 offset:18432
    buffer_load_dwordx4 v32, s[40:43], s67 offen offset:0 nt lds
    v_mfma_f32_16x16x32_bf16 v[136:139], a[68:71], v[88:91], v[136:139]
    ds_read_b64_tr_b16 a[84:85], v17 offset:16384
    v_mfma_f32_16x16x32_bf16 v[140:143], a[68:71], v[92:95], v[140:143]
    s_waitcnt lgkmcnt(5)
    ds_read_b64_tr_b16 a[86:87], v17 offset:18432
    v_mfma_f32_16x16x32_bf16 v[144:147], a[72:75], v[88:91], v[144:147]
    ds_read_b64_tr_b16 a[88:89], v18 offset:16384
    v_mfma_f32_16x16x32_bf16 v[148:151], a[72:75], v[92:95], v[148:151]
    s_waitcnt lgkmcnt(5)
    ds_read_b64_tr_b16 a[90:91], v18 offset:18432
    buffer_load_dwordx4 v33, s[40:43], s67 offen offset:1024 nt lds
    v_mfma_f32_16x16x32_bf16 v[152:155], a[76:79], v[88:91], v[152:155]
    ds_read_b64_tr_b16 a[92:93], v19 offset:16384
    ds_read_b64_tr_b16 a[94:95], v19 offset:18432
    v_mfma_f32_16x16x32_bf16 v[156:159], a[76:79], v[92:95], v[156:159]
    s_waitcnt lgkmcnt(6)
    v_exp_f32 v0, v96
    v_mfma_f32_16x16x32_bf16 v[160:163], a[80:83], v[88:91], v[160:163]
    ds_read_b64_tr_b16 a[96:97], v12 offset:16640
    ds_read_b64_tr_b16 a[98:99], v12 offset:18688
    v_mfma_f32_16x16x32_bf16 v[164:167], a[80:83], v[92:95], v[164:167]
    s_waitcnt lgkmcnt(6)
    v_exp_f32 v1, v97
    v_mfma_f32_16x16x32_bf16 v[168:171], a[84:87], v[88:91], v[168:171]
    ds_read_b64_tr_b16 a[100:101], v13 offset:16640
    ds_read_b64_tr_b16 a[102:103], v13 offset:18688
    v_mfma_f32_16x16x32_bf16 v[172:175], a[84:87], v[92:95], v[172:175]
    s_waitcnt lgkmcnt(6)
    v_exp_f32 v2, v98
    v_mfma_f32_16x16x32_bf16 v[176:179], a[88:91], v[88:91], v[176:179]
    ds_read_b64_tr_b16 a[104:105], v14 offset:16640
    v_mfma_f32_16x16x32_bf16 v[180:183], a[88:91], v[92:95], v[180:183]
    s_waitcnt lgkmcnt(5)
    ds_read_b64_tr_b16 a[106:107], v14 offset:18688
    v_cvt_pk_bf16_f32 v80, v0, v1
    v_mfma_f32_16x16x32_bf16 v[184:187], a[92:95], v[88:91], v[184:187]
    ds_read_b64_tr_b16 a[108:109], v15 offset:16640
    ds_read_b64_tr_b16 a[110:111], v15 offset:18688
    v_mfma_f32_16x16x32_bf16 v[188:191], a[92:95], v[92:95], v[188:191]
    s_waitcnt lgkmcnt(6)
    v_exp_f32 v3, v99
    v_mfma_f32_16x16x32_bf16 v[192:195], a[96:99], v[88:91], v[192:195]
    ds_read_b64_tr_b16 a[112:113], v16 offset:16640
    v_mfma_f32_16x16x32_bf16 v[196:199], a[96:99], v[92:95], v[196:199]
    s_waitcnt lgkmcnt(5)
    ds_read_b64_tr_b16 a[114:115], v16 offset:18688
    v_mfma_f32_16x16x32_bf16 v[200:203], a[100:103], v[88:91], v[200:203]
    ds_read_b64_tr_b16 a[116:117], v17 offset:16640
    ds_read_b64_tr_b16 a[118:119], v17 offset:18688
    v_mfma_f32_16x16x32_bf16 v[204:207], a[100:103], v[92:95], v[204:207]
    s_waitcnt lgkmcnt(6)
    v_exp_f32 v4, v100
    v_mfma_f32_16x16x32_bf16 v[208:211], a[104:107], v[88:91], v[208:211]
    ds_read_b64_tr_b16 a[120:121], v18 offset:16640
    v_mfma_f32_16x16x32_bf16 v[212:215], a[104:107], v[92:95], v[212:215]
    s_waitcnt lgkmcnt(5)
    ds_read_b64_tr_b16 a[122:123], v18 offset:18688
    v_cvt_pk_bf16_f32 v81, v2, v3
    v_mfma_f32_16x16x32_bf16 v[216:219], a[108:111], v[88:91], v[216:219]
    ds_read_b64_tr_b16 a[124:125], v19 offset:16640
    ds_read_b64_tr_b16 a[126:127], v19 offset:18688
    v_mfma_f32_16x16x32_bf16 v[220:223], a[108:111], v[92:95], v[220:223]
    s_waitcnt vmcnt(6) lgkmcnt(6)
    v_exp_f32 v5, v101
    v_mfma_f32_16x16x32_bf16 v[224:227], a[112:115], v[88:91], v[224:227]
    s_barrier
    ds_read_b128 a[64:67], v8 offset:49152
    v_mfma_f32_16x16x32_bf16 v[228:231], a[112:115], v[92:95], v[228:231]
    s_waitcnt lgkmcnt(5)
    v_exp_f32 v6, v102
    v_mfma_f32_16x16x32_bf16 v[232:235], a[116:119], v[88:91], v[232:235]
    ds_read_b128 a[68:71], v8 offset:51200
    v_mfma_f32_16x16x32_bf16 v[236:239], a[116:119], v[92:95], v[236:239]
    s_waitcnt lgkmcnt(4)
    v_cvt_pk_bf16_f32 v82, v4, v5
    v_mfma_f32_16x16x32_bf16 v[240:243], a[120:123], v[88:91], v[240:243]
    ds_read_b128 a[72:75], v9 offset:49152
    v_mfma_f32_16x16x32_bf16 v[244:247], a[120:123], v[92:95], v[244:247]
    s_waitcnt lgkmcnt(3)
    v_exp_f32 v7, v103
    v_mfma_f32_16x16x32_bf16 v[248:251], a[124:127], v[88:91], v[248:251]
    ds_read_b128 a[76:79], v9 offset:51200
    v_mfma_f32_16x16x32_bf16 v[252:255], a[124:127], v[92:95], v[252:255]
    s_waitcnt lgkmcnt(3)
    v_exp_f32 v0, v104
    v_mfma_f32_16x16x32_bf16 v[112:115], a[64:67], a[0:3], v[72:75]
    ds_read_b128 a[80:83], v10 offset:49152
    v_cvt_pk_bf16_f32 v83, v6, v7
    v_mfma_f32_16x16x32_bf16 v[120:123], a[64:67], a[4:7], v[76:79]
    s_waitcnt lgkmcnt(3)
    v_exp_f32 v1, v105
    v_mfma_f32_16x16x32_bf16 v[116:119], a[68:71], a[0:3], v[72:75]
    ds_read_b128 a[84:87], v10 offset:51200
    v_mfma_f32_16x16x32_bf16 v[124:127], a[68:71], a[4:7], v[76:79]
    s_waitcnt lgkmcnt(3)
    v_exp_f32 v2, v106
    v_mfma_f32_16x16x32_bf16 v[112:115], a[72:75], a[8:11], v[112:115]
    ds_read_b128 a[88:91], v11 offset:49152
    buffer_load_dwordx4 v32, s[40:43], s67 offen offset:2048 nt lds
    v_mfma_f32_16x16x32_bf16 v[120:123], a[72:75], a[12:15], v[120:123]
    s_waitcnt lgkmcnt(3)
    v_cvt_pk_bf16_f32 v84, v0, v1
    v_mfma_f32_16x16x32_bf16 v[116:119], a[76:79], a[8:11], v[116:119]
    ds_read_b128 a[92:95], v11 offset:51200
    v_mfma_f32_16x16x32_bf16 v[124:127], a[76:79], a[12:15], v[124:127]
    s_waitcnt lgkmcnt(3)
    v_exp_f32 v3, v107
    v_mfma_f32_16x16x32_bf16 v[112:115], a[80:83], a[16:19], v[112:115]
    ds_read_b128 a[96:99], v8 offset:49408
    buffer_load_dwordx4 v33, s[40:43], s67 offen offset:3072 nt lds
    v_mfma_f32_16x16x32_bf16 v[120:123], a[80:83], a[20:23], v[120:123]
    s_waitcnt lgkmcnt(3)
    v_exp_f32 v4, v108
    v_mfma_f32_16x16x32_bf16 v[116:119], a[84:87], a[16:19], v[116:119]
    s_add_u32 s67, s67, 32768
    ds_read_b128 a[100:103], v8 offset:51456
    v_mfma_f32_16x16x32_bf16 v[124:127], a[84:87], a[20:23], v[124:127]
    s_waitcnt lgkmcnt(3)
    v_cvt_pk_bf16_f32 v85, v2, v3
    v_mfma_f32_16x16x32_bf16 v[112:115], a[88:91], a[24:27], v[112:115]
    s_and_b32 s67, s67, 0x7ffff
    ds_read_b128 a[104:107], v9 offset:49408
    v_mfma_f32_16x16x32_bf16 v[120:123], a[88:91], a[28:31], v[120:123]
    s_waitcnt lgkmcnt(3)
    v_exp_f32 v5, v109
    v_mfma_f32_16x16x32_bf16 v[116:119], a[92:95], a[24:27], v[116:119]
    s_add_u32 m0, s60, 65536
    ds_read_b128 a[108:111], v9 offset:51456
    v_mfma_f32_16x16x32_bf16 v[124:127], a[92:95], a[28:31], v[124:127]
    s_waitcnt lgkmcnt(3)
    v_exp_f32 v6, v110
    v_mfma_f32_16x16x32_bf16 v[112:115], a[96:99], a[32:35], v[112:115]
    ds_read_b128 a[112:115], v10 offset:49408
    buffer_load_dwordx4 v32, s[40:43], s67 offen offset:0 nt lds
    v_mfma_f32_16x16x32_bf16 v[120:123], a[96:99], a[36:39], v[120:123]
    s_waitcnt lgkmcnt(3)
    v_cvt_pk_bf16_f32 v86, v4, v5
    v_mfma_f32_16x16x32_bf16 v[116:119], a[100:103], a[32:35], v[116:119]
    ds_read_b128 a[116:119], v10 offset:51456
    v_mfma_f32_16x16x32_bf16 v[124:127], a[100:103], a[36:39], v[124:127]
    s_waitcnt lgkmcnt(3)
    v_exp_f32 v7, v111
    v_mfma_f32_16x16x32_bf16 v[112:115], a[104:107], a[40:43], v[112:115]
    ds_read_b128 a[120:123], v11 offset:49408
    buffer_load_dwordx4 v33, s[40:43], s67 offen offset:1024 nt lds
    v_mfma_f32_16x16x32_bf16 v[120:123], a[104:107], a[44:47], v[120:123]
    s_waitcnt lgkmcnt(3)
    v_cvt_pk_bf16_f32 v87, v6, v7
    v_mfma_f32_16x16x32_bf16 v[116:119], a[108:111], a[40:43], v[116:119]
    ds_read_b128 a[124:127], v11 offset:51456
    v_mfma_f32_16x16x32_bf16 v[124:127], a[108:111], a[44:47], v[124:127]
    s_waitcnt lgkmcnt(3)
    v_mfma_f32_16x16x32_bf16 v[64:67], a[160:163], v[80:83], v[68:71]
    v_mfma_f32_16x16x32_bf16 v[64:67], a[164:167], v[84:87], v[64:67]
    v_mfma_f32_16x16x32_bf16 v[112:115], a[112:115], a[48:51], v[112:115]
    ds_read_b64_tr_b16 a[64:65], v12 offset:32768
    v_mfma_f32_16x16x32_bf16 v[120:123], a[112:115], a[52:55], v[120:123]
    s_waitcnt lgkmcnt(3)
    ds_read_b64_tr_b16 a[66:67], v12 offset:34816
    buffer_load_dwordx4 v32, s[40:43], s67 offen offset:2048 nt lds
    v_mfma_f32_16x16x32_bf16 v[116:119], a[116:119], a[48:51], v[116:119]
    ds_read_b64_tr_b16 a[68:69], v13 offset:32768
    v_mfma_f32_16x16x32_bf16 v[124:127], a[116:119], a[52:55], v[124:127]
    s_waitcnt lgkmcnt(4)
    ds_read_b64_tr_b16 a[70:71], v13 offset:34816
    v_mfma_f32_16x16x32_bf16 v[112:115], a[120:123], a[56:59], v[112:115]
    ds_read_b64_tr_b16 a[72:73], v14 offset:32768
    v_cmp_nge_f32 vcc, s72, v64
    v_mfma_f32_16x16x32_bf16 v[120:123], a[120:123], a[60:63], v[120:123]
    s_waitcnt lgkmcnt(5)
    ds_read_b64_tr_b16 a[74:75], v14 offset:34816
    buffer_load_dwordx4 v33, s[40:43], s67 offen offset:3072 nt lds
    v_mfma_f32_16x16x32_bf16 v[116:119], a[124:127], a[56:59], v[116:119]
    s_add_u32 s67, s67, 16384
    s_add_u32 m0, s60, 16384
    s_cbranch_vccnz L_fix2
L_ret2:
    v_mfma_f32_16x16x32_bf16 v[124:127], a[124:127], a[60:63], v[124:127]
    s_waitcnt lgkmcnt(4)
    ds_read_b64_tr_b16 a[76:77], v15 offset:32768
    ds_read_b64_tr_b16 a[78:79], v15 offset:34816
    v_mfma_f32_16x16x32_bf16 v[128:131], a[64:67], v[80:83], v[128:131]
    s_and_b32 s67, s67, 0x7ffff
    ds_read_b64_tr_b16 a[80:81], v16 offset:32768
    v_mfma_f32_16x16x32_bf16 v[132:135], a[64:67], v[84:87], v[132:135]
    s_waitcnt lgkmcnt(5)
    ds_read_b64_tr_b16 a[82:83], v16 offset:34816
    buffer_load_dwordx4 v30, s[36:39], s66 offen offset:0 nt lds
    v_mfma_f32_16x16x32_bf16 v[136:139], a[68:71], v[80:83], v[136:139]
    ds_read_b64_tr_b16 a[84:85], v17 offset:32768
    v_mfma_f32_16x16x32_bf16 v[140:143], a[68:71], v[84:87], v[140:143]
    s_waitcnt lgkmcnt(5)
    ds_read_b64_tr_b16 a[86:87], v17 offset:34816
    v_mfma_f32_16x16x32_bf16 v[144:147], a[72:75], v[80:83], v[144:147]
    ds_read_b64_tr_b16 a[88:89], v18 offset:32768
    v_mfma_f32_16x16x32_bf16 v[148:151], a[72:75], v[84:87], v[148:151]
    s_waitcnt lgkmcnt(5)
    ds_read_b64_tr_b16 a[90:91], v18 offset:34816
    buffer_load_dwordx4 v31, s[36:39], s66 offen offset:1024 nt lds
    v_mfma_f32_16x16x32_bf16 v[152:155], a[76:79], v[80:83], v[152:155]
    ds_read_b64_tr_b16 a[92:93], v19 offset:32768
    ds_read_b64_tr_b16 a[94:95], v19 offset:34816
    v_mfma_f32_16x16x32_bf16 v[156:159], a[76:79], v[84:87], v[156:159]
    s_waitcnt lgkmcnt(6)
    v_exp_f32 v0, v112
    v_mfma_f32_16x16x32_bf16 v[160:163], a[80:83], v[80:83], v[160:163]
    ds_read_b64_tr_b16 a[96:97], v12 offset:33024
    ds_read_b64_tr_b16 a[98:99], v12 offset:35072
    v_mfma_f32_16x16x32_bf16 v[164:167], a[80:83], v[84:87], v[164:167]
    s_waitcnt lgkmcnt(6)
    v_exp_f32 v1, v113
    v_mfma_f32_16x16x32_bf16 v[168:171], a[84:87], v[80:83], v[168:171]
    ds_read_b64_tr_b16 a[100:101], v13 offset:33024
    ds_read_b64_tr_b16 a[102:103], v13 offset:35072
    v_mfma_f32_16x16x32_bf16 v[172:175], a[84:87], v[84:87], v[172:175]
    s_waitcnt lgkmcnt(6)
    v_exp_f32 v2, v114
    v_mfma_f32_16x16x32_bf16 v[176:179], a[88:91], v[80:83], v[176:179]
    ds_read_b64_tr_b16 a[104:105], v14 offset:33024
    v_mfma_f32_16x16x32_bf16 v[180:183], a[88:91], v[84:87], v[180:183]
    s_waitcnt lgkmcnt(5)
    ds_read_b64_tr_b16 a[106:107], v14 offset:35072
    v_cvt_pk_bf16_f32 v88, v0, v1
    v_mfma_f32_16x16x32_bf16 v[184:187], a[92:95], v[80:83], v[184:187]
    ds_read_b64_tr_b16 a[108:109], v15 offset:33024
    ds_read_b64_tr_b16 a[110:111], v15 offset:35072
    v_mfma_f32_16x16x32_bf16 v[188:191], a[92:95], v[84:87], v[188:191]
    s_waitcnt lgkmcnt(6)
    v_exp_f32 v3, v115
    v_mfma_f32_16x16x32_bf16 v[192:195], a[96:99], v[80:83], v[192:195]
    ds_read_b64_tr_b16 a[112:113], v16 offset:33024
    v_mfma_f32_16x16x32_bf16 v[196:199], a[96:99], v[84:87], v[196:199]
    s_waitcnt lgkmcnt(5)
    ds_read_b64_tr_b16 a[114:115], v16 offset:35072
    v_mfma_f32_16x16x32_bf16 v[200:203], a[100:103], v[80:83], v[200:203]
    ds_read_b64_tr_b16 a[116:117], v17 offset:33024
    ds_read_b64_tr_b16 a[118:119], v17 offset:35072
    v_mfma_f32_16x16x32_bf16 v[204:207], a[100:103], v[84:87], v[204:207]
    s_waitcnt lgkmcnt(6)
    v_exp_f32 v4, v116
    v_mfma_f32_16x16x32_bf16 v[208:211], a[104:107], v[80:83], v[208:211]
    ds_read_b64_tr_b16 a[120:121], v18 offset:33024
    v_mfma_f32_16x16x32_bf16 v[212:215], a[104:107], v[84:87], v[212:215]
    s_waitcnt lgkmcnt(5)
    ds_read_b64_tr_b16 a[122:123], v18 offset:35072
    v_cvt_pk_bf16_f32 v89, v2, v3
    v_mfma_f32_16x16x32_bf16 v[216:219], a[108:111], v[80:83], v[216:219]
    ds_read_b64_tr_b16 a[124:125], v19 offset:33024
    ds_read_b64_tr_b16 a[126:127], v19 offset:35072
    v_mfma_f32_16x16x32_bf16 v[220:223], a[108:111], v[84:87], v[220:223]
    s_waitcnt vmcnt(6) lgkmcnt(6)
    v_exp_f32 v5, v117
    v_mfma_f32_16x16x32_bf16 v[224:227], a[112:115], v[80:83], v[224:227]
    s_barrier
    ds_read_b128 a[64:67], v8 offset:0
    v_mfma_f32_16x16x32_bf16 v[228:231], a[112:115], v[84:87], v[228:231]
    s_waitcnt lgkmcnt(5)
    v_exp_f32 v6, v118
    v_mfma_f32_16x16x32_bf16 v[232:235], a[116:119], v[80:83], v[232:235]
    ds_read_b128 a[68:71], v8 offset:2048
    v_mfma_f32_16x16x32_bf16 v[236:239], a[116:119], v[84:87], v[236:239]
    s_waitcnt lgkmcnt(4)
    v_cvt_pk_bf16_f32 v90, v4, v5
    v_mfma_f32_16x16x32_bf16 v[240:243], a[120:123], v[80:83], v[240:243]
    ds_read_b128 a[72:75], v9 offset:0
    v_mfma_f32_16x16x32_bf16 v[244:247], a[120:123], v[84:87], v[244:247]
    s_waitcnt lgkmcnt(3)
    v_exp_f32 v7, v119
    v_mfma_f32_16x16x32_bf16 v[248:251], a[124:127], v[80:83], v[248:251]
    ds_read_b128 a[76:79], v9 offset:2048
    v_mfma_f32_16x16x32_bf16 v[252:255], a[124:127], v[84:87], v[252:255]
    s_waitcnt lgkmcnt(3)
    v_exp_f32 v0, v120
    v_mfma_f32_16x16x32_bf16 v[96:99], a[64:67], a[0:3], v[72:75]
    ds_read_b128 a[80:83], v10 offset:0
    v_cvt_pk_bf16_f32 v91, v6, v7
    v_mfma_f32_16x16x32_bf16 v[104:107], a[64:67], a[4:7], v[76:79]
    s_waitcnt lgkmcnt(3)
    v_exp_f32 v1, v121
    v_mfma_f32_16x16x32_bf16 v[100:103], a[68:71], a[0:3], v[72:75]
    ds_read_b128 a[84:87], v10 offset:2048
    v_mfma_f32_16x16x32_bf16 v[108:111], a[68:71], a[4:7], v[76:79]
    s_waitcnt lgkmcnt(3)
    v_exp_f32 v2, v122
    v_mfma_f32_16x16x32_bf16 v[96:99], a[72:75], a[8:11], v[96:99]
    ds_read_b128 a[88:91], v11 offset:0
    buffer_load_dwordx4 v30, s[36:39], s66 offen offset:2048 nt lds
    v_mfma_f32_16x16x32_bf16 v[104:107], a[72:75], a[12:15], v[104:107]
    s_waitcnt lgkmcnt(3)
    v_cvt_pk_bf16_f32 v92, v0, v1
    v_mfma_f32_16x16x32_bf16 v[100:103], a[76:79], a[8:11], v[100:103]
    ds_read_b128 a[92:95], v11 offset:2048
    v_mfma_f32_16x16x32_bf16 v[108:111], a[76:79], a[12:15], v[108:111]
    s_waitcnt lgkmcnt(3)
    v_exp_f32 v3, v123
    v_mfma_f32_16x16x32_bf16 v[96:99], a[80:83], a[16:19], v[96:99]
    ds_read_b128 a[96:99], v8 offset:256
    buffer_load_dwordx4 v31, s[36:39], s66 offen offset:3072 nt lds
    v_mfma_f32_16x16x32_bf16 v[104:107], a[80:83], a[20:23], v[104:107]
    s_waitcnt lgkmcnt(3)
    v_exp_f32 v4, v124
    v_mfma_f32_16x16x32_bf16 v[100:103], a[84:87], a[16:19], v[100:103]
    s_add_u32 s66, s66, 32768
    ds_read_b128 a[100:103], v8 offset:2304
    v_mfma_f32_16x16x32_bf16 v[108:111], a[84:87], a[20:23], v[108:111]
    s_waitcnt lgkmcnt(3)
    v_cvt_pk_bf16_f32 v93, v2, v3
    v_mfma_f32_16x16x32_bf16 v[96:99], a[88:91], a[24:27], v[96:99]
    s_and_b32 s66, s66, 0x7ffff
    ds_read_b128 a[104:107], v9 offset:256
    v_mfma_f32_16x16x32_bf16 v[104:107], a[88:91], a[28:31], v[104:107]
    s_waitcnt lgkmcnt(3)
    v_exp_f32 v5, v125
    v_mfma_f32_16x16x32_bf16 v[100:103], a[92:95], a[24:27], v[100:103]
    s_add_u32 m0, s60, 32768
    ds_read_b128 a[108:111], v9 offset:2304
    v_mfma_f32_16x16x32_bf16 v[108:111], a[92:95], a[28:31], v[108:111]
    s_waitcnt lgkmcnt(3)
    v_exp_f32 v6, v126
    v_mfma_f32_16x16x32_bf16 v[96:99], a[96:99], a[32:35], v[96:99]
    ds_read_b128 a[112:115], v10 offset:256
    buffer_load_dwordx4 v30, s[36:39], s66 offen offset:0 nt lds
    v_mfma_f32_16x16x32_bf16 v[104:107], a[96:99], a[36:39], v[104:107]
    s_waitcnt lgkmcnt(3)
    v_cvt_pk_bf16_f32 v94, v4, v5
    v_mfma_f32_16x16x32_bf16 v[100:103], a[100:103], a[32:35], v[100:103]
    ds_read_b128 a[116:119], v10 offset:2304
    v_mfma_f32_16x16x32_bf16 v[108:111], a[100:103], a[36:39], v[108:111]
    s_waitcnt lgkmcnt(3)
    v_exp_f32 v7, v127
    v_mfma_f32_16x16x32_bf16 v[96:99], a[104:107], a[40:43], v[96:99]
    ds_read_b128 a[120:123], v11 offset:256
    buffer_load_dwordx4 v31, s[36:39], s66 offen offset:1024 nt lds
    v_mfma_f32_16x16x32_bf16 v[104:107], a[104:107], a[44:47], v[104:107]
    s_waitcnt lgkmcnt(3)
    v_cvt_pk_bf16_f32 v95, v6, v7
    v_mfma_f32_16x16x32_bf16 v[100:103], a[108:111], a[40:43], v[100:103]
    ds_read_b128 a[124:127], v11 offset:2304
    v_mfma_f32_16x16x32_bf16 v[108:111], a[108:111], a[44:47], v[108:111]
    s_waitcnt lgkmcnt(3)
    v_mfma_f32_16x16x32_bf16 v[68:71], a[160:163], v[88:91], v[64:67]
    v_mfma_f32_16x16x32_bf16 v[68:71], a[164:167], v[92:95], v[68:71]
    v_mfma_f32_16x16x32_bf16 v[96:99], a[112:115], a[48:51], v[96:99]
    ds_read_b64_tr_b16 a[64:65], v12 offset:49152
    v_mfma_f32_16x16x32_bf16 v[104:107], a[112:115], a[52:55], v[104:107]
    s_waitcnt lgkmcnt(3)
    ds_read_b64_tr_b16 a[66:67], v12 offset:51200
    buffer_load_dwordx4 v30, s[36:39], s66 offen offset:2048 nt lds
    v_mfma_f32_16x16x32_bf16 v[100:103], a[116:119], a[48:51], v[100:103]
    ds_read_b64_tr_b16 a[68:69], v13 offset:49152
    v_mfma_f32_16x16x32_bf16 v[108:111], a[116:119], a[52:55], v[108:111]
    s_waitcnt lgkmcnt(4)
    ds_read_b64_tr_b16 a[70:71], v13 offset:51200
    v_mfma_f32_16x16x32_bf16 v[96:99], a[120:123], a[56:59], v[96:99]
    ds_read_b64_tr_b16 a[72:73], v14 offset:49152
    v_cmp_nge_f32 vcc, s72, v68
    v_mfma_f32_16x16x32_bf16 v[104:107], a[120:123], a[60:63], v[104:107]
    s_waitcnt lgkmcnt(5)
    ds_read_b64_tr_b16 a[74:75], v14 offset:51200
    buffer_load_dwordx4 v31, s[36:39], s66 offen offset:3072 nt lds
    v_mfma_f32_16x16x32_bf16 v[100:103], a[124:127], a[56:59], v[100:103]
    s_add_u32 s66, s66, 507904
    s_add_u32 m0, s60, 81920
    s_cbranch_vccnz L_fix3
L_ret3:
    v_mfma_f32_16x16x32_bf16 v[108:111], a[124:127], a[60:63], v[108:111]
    s_waitcnt lgkmcnt(4)
    ds_read_b64_tr_b16 a[76:77], v15 offset:49152
    ds_read_b64_tr_b16 a[78:79], v15 offset:51200
    v_mfma_f32_16x16x32_bf16 v[128:131], a[64:67], v[88:91], v[128:131]
    s_and_b32 s66, s66, 0x7ffff
    ds_read_b64_tr_b16 a[80:81], v16 offset:49152
    v_mfma_f32_16x16x32_bf16 v[132:135], a[64:67], v[92:95], v[132:135]
    s_waitcnt lgkmcnt(5)
    ds_read_b64_tr_b16 a[82:83], v16 offset:51200
    buffer_load_dwordx4 v32, s[40:43], s67 offen offset:0 nt lds
    v_mfma_f32_16x16x32_bf16 v[136:139], a[68:71], v[88:91], v[136:139]
    ds_read_b64_tr_b16 a[84:85], v17 offset:49152
    v_mfma_f32_16x16x32_bf16 v[140:143], a[68:71], v[92:95], v[140:143]
    s_waitcnt lgkmcnt(5)
    ds_read_b64_tr_b16 a[86:87], v17 offset:51200
    v_mfma_f32_16x16x32_bf16 v[144:147], a[72:75], v[88:91], v[144:147]
    ds_read_b64_tr_b16 a[88:89], v18 offset:49152
    v_mfma_f32_16x16x32_bf16 v[148:151], a[72:75], v[92:95], v[148:151]
    s_waitcnt lgkmcnt(5)
    ds_read_b64_tr_b16 a[90:91], v18 offset:51200
    buffer_load_dwordx4 v33, s[40:43], s67 offen offset:1024 nt lds
    v_mfma_f32_16x16x32_bf16 v[152:155], a[76:79], v[88:91], v[152:155]
    ds_read_b64_tr_b16 a[92:93], v19 offset:49152
    ds_read_b64_tr_b16 a[94:95], v19 offset:51200
    v_mfma_f32_16x16x32_bf16 v[156:159], a[76:79], v[92:95], v[156:159]
    s_waitcnt lgkmcnt(6)
    v_exp_f32 v0, v96
    v_mfma_f32_16x16x32_bf16 v[160:163], a[80:83], v[88:91], v[160:163]
    ds_read_b64_tr_b16 a[96:97], v12 offset:49408
    ds_read_b64_tr_b16 a[98:99], v12 offset:51456
    v_mfma_f32_16x16x32_bf16 v[164:167], a[80:83], v[92:95], v[164:167]
    s_waitcnt lgkmcnt(6)
    v_exp_f32 v1, v97
    v_mfma_f32_16x16x32_bf16 v[168:171], a[84:87], v[88:91], v[168:171]
    ds_read_b64_tr_b16 a[100:101], v13 offset:49408
    ds_read_b64_tr_b16 a[102:103], v13 offset:51456
    v_mfma_f32_16x16x32_bf16 v[172:175], a[84:87], v[92:95], v[172:175]
    s_waitcnt lgkmcnt(6)
    v_exp_f32 v2, v98
    v_mfma_f32_16x16x32_bf16 v[176:179], a[88:91], v[88:91], v[176:179]
    ds_read_b64_tr_b16 a[104:105], v14 offset:49408
    v_mfma_f32_16x16x32_bf16 v[180:183], a[88:91], v[92:95], v[180:183]
    s_waitcnt lgkmcnt(5)
    ds_read_b64_tr_b16 a[106:107], v14 offset:51456
    v_cvt_pk_bf16_f32 v80, v0, v1
    v_mfma_f32_16x16x32_bf16 v[184:187], a[92:95], v[88:91], v[184:187]
    ds_read_b64_tr_b16 a[108:109], v15 offset:49408
    ds_read_b64_tr_b16 a[110:111], v15 offset:51456
    v_mfma_f32_16x16x32_bf16 v[188:191], a[92:95], v[92:95], v[188:191]
    s_waitcnt lgkmcnt(6)
    v_exp_f32 v3, v99
    v_mfma_f32_16x16x32_bf16 v[192:195], a[96:99], v[88:91], v[192:195]
    ds_read_b64_tr_b16 a[112:113], v16 offset:49408
    v_mfma_f32_16x16x32_bf16 v[196:199], a[96:99], v[92:95], v[196:199]
    s_waitcnt lgkmcnt(5)
    ds_read_b64_tr_b16 a[114:115], v16 offset:51456
    v_mfma_f32_16x16x32_bf16 v[200:203], a[100:103], v[88:91], v[200:203]
    ds_read_b64_tr_b16 a[116:117], v17 offset:49408
    ds_read_b64_tr_b16 a[118:119], v17 offset:51456
    v_mfma_f32_16x16x32_bf16 v[204:207], a[100:103], v[92:95], v[204:207]
    s_waitcnt lgkmcnt(6)
    v_exp_f32 v4, v100
    v_mfma_f32_16x16x32_bf16 v[208:211], a[104:107], v[88:91], v[208:211]
    ds_read_b64_tr_b16 a[120:121], v18 offset:49408
    v_mfma_f32_16x16x32_bf16 v[212:215], a[104:107], v[92:95], v[212:215]
    s_waitcnt lgkmcnt(5)
    ds_read_b64_tr_b16 a[122:123], v18 offset:51456
    v_cvt_pk_bf16_f32 v81, v2, v3
    v_mfma_f32_16x16x32_bf16 v[216:219], a[108:111], v[88:91], v[216:219]
    ds_read_b64_tr_b16 a[124:125], v19 offset:49408
    ds_read_b64_tr_b16 a[126:127], v19 offset:51456
    v_mfma_f32_16x16x32_bf16 v[220:223], a[108:111], v[92:95], v[220:223]
    s_waitcnt vmcnt(6) lgkmcnt(6)
    v_exp_f32 v5, v101
    v_mfma_f32_16x16x32_bf16 v[224:227], a[112:115], v[88:91], v[224:227]
    s_barrier
    ds_read_b128 a[64:67], v8 offset:16384
    v_mfma_f32_16x16x32_bf16 v[228:231], a[112:115], v[92:95], v[228:231]
    s_waitcnt lgkmcnt(5)
    v_exp_f32 v6, v102
    v_mfma_f32_16x16x32_bf16 v[232:235], a[116:119], v[88:91], v[232:235]
    ds_read_b128 a[68:71], v8 offset:18432
    v_mfma_f32_16x16x32_bf16 v[236:239], a[116:119], v[92:95], v[236:239]
    s_waitcnt lgkmcnt(4)
    v_cvt_pk_bf16_f32 v82, v4, v5
    v_mfma_f32_16x16x32_bf16 v[240:243], a[120:123], v[88:91], v[240:243]
    ds_read_b128 a[72:75], v9 offset:16384
    v_mfma_f32_16x16x32_bf16 v[244:247], a[120:123], v[92:95], v[244:247]
    s_waitcnt lgkmcnt(3)
    v_exp_f32 v7, v103
    v_mfma_f32_16x16x32_bf16 v[248:251], a[124:127], v[88:91], v[248:251]
    ds_read_b128 a[76:79], v9 offset:18432
    v_mfma_f32_16x16x32_bf16 v[252:255], a[124:127], v[92:95], v[252:255]
    s_waitcnt lgkmcnt(3)
    v_exp_f32 v0, v104
    v_mfma_f32_16x16x32_bf16 v[112:115], a[64:67], a[0:3], v[72:75]
    ds_read_b128 a[80:83], v10 offset:16384
    v_cvt_pk_bf16_f32 v83, v6, v7
    v_mfma_f32_16x16x32_bf16 v[120:123], a[64:67], a[4:7], v[76:79]
    s_waitcnt lgkmcnt(3)
    v_exp_f32 v1, v105
    v_mfma_f32_16x16x32_bf16 v[116:119], a[68:71], a[0:3], v[72:75]
    ds_read_b128 a[84:87], v10 offset:18432
    v_mfma_f32_16x16x32_bf16 v[124:127], a[68:71], a[4:7], v[76:79]
    s_waitcnt lgkmcnt(3)
    v_exp_f32 v2, v106
    v_mfma_f32_16x16x32_bf16 v[112:115], a[72:75], a[8:11], v[112:115]
    ds_read_b128 a[88:91], v11 offset:16384
    buffer_load_dwordx4 v32, s[40:43], s67 offen offset:2048 nt lds
    v_mfma_f32_16x16x32_bf16 v[120:123], a[72:75], a[12:15], v[120:123]
    s_waitcnt lgkmcnt(3)
    v_cvt_pk_bf16_f32 v84, v0, v1
    v_mfma_f32_16x16x32_bf16 v[116:119], a[76:79], a[8:11], v[116:119]
    ds_read_b128 a[92:95], v11 offset:18432
    v_mfma_f32_16x16x32_bf16 v[124:127], a[76:79], a[12:15], v[124:127]
    s_waitcnt lgkmcnt(3)
    v_exp_f32 v3, v107
    v_mfma_f32_16x16x32_bf16 v[112:115], a[80:83], a[16:19], v[112:115]
    ds_read_b128 a[96:99], v8 offset:16640
    buffer_load_dwordx4 v33, s[40:43], s67 offen offset:3072 nt lds
    v_mfma_f32_16x16x32_bf16 v[120:123], a[80:83], a[20:23], v[120:123]
    s_waitcnt lgkmcnt(3)
    v_exp_f32 v4, v108
    v_mfma_f32_16x16x32_bf16 v[116:119], a[84:87], a[16:19], v[116:119]
    s_add_u32 s67, s67, 32768
    ds_read_b128 a[100:103], v8 offset:18688
    v_mfma_f32_16x16x32_bf16 v[124:127], a[84:87], a[20:23], v[124:127]
    s_waitcnt lgkmcnt(3)
    v_cvt_pk_bf16_f32 v85, v2, v3
    v_mfma_f32_16x16x32_bf16 v[112:115], a[88:91], a[24:27], v[112:115]
    s_and_b32 s67, s67, 0x7ffff
    ds_read_b128 a[104:107], v9 offset:16640
    v_mfma_f32_16x16x32_bf16 v[120:123], a[88:91], a[28:31], v[120:123]
    s_waitcnt lgkmcnt(3)
    v_exp_f32 v5, v109
    v_mfma_f32_16x16x32_bf16 v[116:119], a[92:95], a[24:27], v[116:119]
    s_add_u32 m0, s60, 98304
    ds_read_b128 a[108:111], v9 offset:18688
    v_mfma_f32_16x16x32_bf16 v[124:127], a[92:95], a[28:31], v[124:127]
    s_waitcnt lgkmcnt(3)
    v_exp_f32 v6, v110
    v_mfma_f32_16x16x32_bf16 v[112:115], a[96:99], a[32:35], v[112:115]
    ds_read_b128 a[112:115], v10 offset:16640
    buffer_load_dwordx4 v32, s[40:43], s67 offen offset:0 nt lds
    v_mfma_f32_16x16x32_bf16 v[120:123], a[96:99], a[36:39], v[120:123]
    s_waitcnt lgkmcnt(3)
    v_cvt_pk_bf16_f32 v86, v4, v5
    v_mfma_f32_16x16x32_bf16 v[116:119], a[100:103], a[32:35], v[116:119]
    ds_read_b128 a[116:119], v10 offset:18688
    v_mfma_f32_16x16x32_bf16 v[124:127], a[100:103], a[36:39], v[124:127]
    s_waitcnt lgkmcnt(3)
    v_exp_f32 v7, v111
    v_mfma_f32_16x16x32_bf16 v[112:115], a[104:107], a[40:43], v[112:115]
    ds_read_b128 a[120:123], v11 offset:16640
    buffer_load_dwordx4 v33, s[40:43], s67 offen offset:1024 nt lds
    v_mfma_f32_16x16x32_bf16 v[120:123], a[104:107], a[44:47], v[120:123]
    s_waitcnt lgkmcnt(3)
    v_cvt_pk_bf16_f32 v87, v6, v7
    v_mfma_f32_16x16x32_bf16 v[116:119], a[108:111], a[40:43], v[116:119]
    ds_read_b128 a[124:127], v11 offset:18688
    v_mfma_f32_16x16x32_bf16 v[124:127], a[108:111], a[44:47], v[124:127]
    s_waitcnt lgkmcnt(3)
    v_mfma_f32_16x16x32_bf16 v[64:67], a[160:163], v[80:83], v[68:71]
    v_mfma_f32_16x16x32_bf16 v[64:67], a[164:167], v[84:87], v[64:67]
    v_mfma_f32_16x16x32_bf16 v[112:115], a[112:115], a[48:51], v[112:115]
    ds_read_b64_tr_b16 a[64:65], v12 offset:0
    v_mfma_f32_16x16x32_bf16 v[120:123], a[112:115], a[52:55], v[120:123]
    s_waitcnt lgkmcnt(3)
    ds_read_b64_tr_b16 a[66:67], v12 offset:2048
    buffer_load_dwordx4 v32, s[40:43], s67 offen offset:2048 nt lds
    v_mfma_f32_16x16x32_bf16 v[116:119], a[116:119], a[48:51], v[116:119]
    ds_read_b64_tr_b16 a[68:69], v13 offset:0
    v_mfma_f32_16x16x32_bf16 v[124:127], a[116:119], a[52:55], v[124:127]
    s_waitcnt lgkmcnt(4)
    ds_read_b64_tr_b16 a[70:71], v13 offset:2048
    v_mfma_f32_16x16x32_bf16 v[112:115], a[120:123], a[56:59], v[112:115]
    ds_read_b64_tr_b16 a[72:73], v14 offset:0
    v_cmp_nge_f32 vcc, s72, v64
    v_mfma_f32_16x16x32_bf16 v[120:123], a[120:123], a[60:63], v[120:123]
    s_waitcnt lgkmcnt(5)
    ds_read_b64_tr_b16 a[74:75], v14 offset:2048
    buffer_load_dwordx4 v33, s[40:43], s67 offen offset:3072 nt lds
    v_mfma_f32_16x16x32_bf16 v[116:119], a[124:127], a[56:59], v[116:119]
    s_add_u32 s67, s67, 507904
    s_add_u32 m0, s60, 49152
    s_cbranch_vccnz L_fix0
L_ret0:
    v_mfma_f32_16x16x32_bf16 v[124:127], a[124:127], a[60:63], v[124:127]
    s_waitcnt lgkmcnt(4)
    ds_read_b64_tr_b16 a[76:77], v15 offset:0
    ds_read_b64_tr_b16 a[78:79], v15 offset:2048
    v_mfma_f32_16x16x32_bf16 v[128:131], a[64:67], v[80:83], v[128:131]
    s_and_b32 s67, s67, 0x7ffff
    ds_read_b64_tr_b16 a[80:81], v16 offset:0
    v_mfma_f32_16x16x32_bf16 v[132:135], a[64:67], v[84:87], v[132:135]
    s_waitcnt lgkmcnt(5)
    ds_read_b64_tr_b16 a[82:83], v16 offset:2048
    buffer_load_dwordx4 v30, s[36:39], s66 offen offset:0 nt lds
    v_mfma_f32_16x16x32_bf16 v[136:139], a[68:71], v[80:83], v[136:139]
    ds_read_b64_tr_b16 a[84:85], v17 offset:0
    v_mfma_f32_16x16x32_bf16 v[140:143], a[68:71], v[84:87], v[140:143]
    s_waitcnt lgkmcnt(5)
    ds_read_b64_tr_b16 a[86:87], v17 offset:2048
    v_mfma_f32_16x16x32_bf16 v[144:147], a[72:75], v[80:83], v[144:147]
    ds_read_b64_tr_b16 a[88:89], v18 offset:0
    v_mfma_f32_16x16x32_bf16 v[148:151], a[72:75], v[84:87], v[148:151]
    s_waitcnt lgkmcnt(5)
    ds_read_b64_tr_b16 a[90:91], v18 offset:2048
    buffer_load_dwordx4 v31, s[36:39], s66 offen offset:1024 nt lds
    v_mfma_f32_16x16x32_bf16 v[152:155], a[76:79], v[80:83], v[152:155]
    ds_read_b64_tr_b16 a[92:93], v19 offset:0
    ds_read_b64_tr_b16 a[94:95], v19 offset:2048
    v_mfma_f32_16x16x32_bf16 v[156:159], a[76:79], v[84:87], v[156:159]
    s_waitcnt lgkmcnt(6)
    v_exp_f32 v0, v112
    v_mfma_f32_16x16x32_bf16 v[160:163], a[80:83], v[80:83], v[160:163]
    ds_read_b64_tr_b16 a[96:97], v12 offset:256
    ds_read_b64_tr_b16 a[98:99], v12 offset:2304
    v_mfma_f32_16x16x32_bf16 v[164:167], a[80:83], v[84:87], v[164:167]
    s_waitcnt lgkmcnt(6)
    v_exp_f32 v1, v113
    v_mfma_f32_16x16x32_bf16 v[168:171], a[84:87], v[80:83], v[168:171]
    ds_read_b64_tr_b16 a[100:101], v13 offset:256
    ds_read_b64_tr_b16 a[102:103], v13 offset:2304
    v_mfma_f32_16x16x32_bf16 v[172:175], a[84:87], v[84:87], v[172:175]
    s_waitcnt lgkmcnt(6)
    v_exp_f32 v2, v114
    v_mfma_f32_16x16x32_bf16 v[176:179], a[88:91], v[80:83], v[176:179]
    ds_read_b64_tr_b16 a[104:105], v14 offset:256
    v_mfma_f32_16x16x32_bf16 v[180:183], a[88:91], v[84:87], v[180:183]
    s_waitcnt lgkmcnt(5)
    ds_read_b64_tr_b16 a[106:107], v14 offset:2304
    v_cvt_pk_bf16_f32 v88, v0, v1
    v_mfma_f32_16x16x32_bf16 v[184:187], a[92:95], v[80:83], v[184:187]
    ds_read_b64_tr_b16 a[108:109], v15 offset:256
    ds_read_b64_tr_b16 a[110:111], v15 offset:2304
    v_mfma_f32_16x16x32_bf16 v[188:191], a[92:95], v[84:87], v[188:191]
    s_waitcnt lgkmcnt(6)
    v_exp_f32 v3, v115
    v_mfma_f32_16x16x32_bf16 v[192:195], a[96:99], v[80:83], v[192:195]
    ds_read_b64_tr_b16 a[112:113], v16 offset:256
    v_mfma_f32_16x16x32_bf16 v[196:199], a[96:99], v[84:87], v[196:199]
    s_waitcnt lgkmcnt(5)
    ds_read_b64_tr_b16 a[114:115], v16 offset:2304
    v_mfma_f32_16x16x32_bf16 v[200:203], a[100:103], v[80:83], v[200:203]
    ds_read_b64_tr_b16 a[116:117], v17 offset:256
    ds_read_b64_tr_b16 a[118:119], v17 offset:2304
    v_mfma_f32_16x16x32_bf16 v[204:207], a[100:103], v[84:87], v[204:207]
    s_waitcnt lgkmcnt(6)
    v_exp_f32 v4, v116
    v_mfma_f32_16x16x32_bf16 v[208:211], a[104:107], v[80:83], v[208:211]
    ds_read_b64_tr_b16 a[120:121], v18 offset:256
    v_mfma_f32_16x16x32_bf16 v[212:215], a[104:107], v[84:87], v[212:215]
    s_waitcnt lgkmcnt(5)
    ds_read_b64_tr_b16 a[122:123], v18 offset:2304
    v_cvt_pk_bf16_f32 v89, v2, v3
    v_mfma_f32_16x16x32_bf16 v[216:219], a[108:111], v[80:83], v[216:219]
    ds_read_b64_tr_b16 a[124:125], v19 offset:256
    ds_read_b64_tr_b16 a[126:127], v19 offset:2304
    v_mfma_f32_16x16x32_bf16 v[220:223], a[108:111], v[84:87], v[220:223]
    s_waitcnt vmcnt(6) lgkmcnt(6)
    v_exp_f32 v5, v117
    v_mfma_f32_16x16x32_bf16 v[224:227], a[112:115], v[80:83], v[224:227]
    s_barrier
    ds_read_b128 a[64:67], v8 offset:32768
    v_mfma_f32_16x16x32_bf16 v[228:231], a[112:115], v[84:87], v[228:231]
    s_waitcnt lgkmcnt(5)
    v_exp_f32 v6, v118
    v_mfma_f32_16x16x32_bf16 v[232:235], a[116:119], v[80:83], v[232:235]
    ds_read_b128 a[68:71], v8 offset:34816
    v_mfma_f32_16x16x32_bf16 v[236:239], a[116:119], v[84:87], v[236:239]
    s_waitcnt lgkmcnt(4)
    v_cvt_pk_bf16_f32 v90, v4, v5
    v_mfma_f32_16x16x32_bf16 v[240:243], a[120:123], v[80:83], v[240:243]
    ds_read_b128 a[72:75], v9 offset:32768
    v_mfma_f32_16x16x32_bf16 v[244:247], a[120:123], v[84:87], v[244:247]
    s_waitcnt lgkmcnt(3)
    v_exp_f32 v7, v119
    v_mfma_f32_16x16x32_bf16 v[248:251], a[124:127], v[80:83], v[248:251]
    s_add_u32 s73, s73, 1
    ds_read_b128 a[76:79], v9 offset:34816
    v_mfma_f32_16x16x32_bf16 v[252:255], a[124:127], v[84:87], v[252:255]
    s_waitcnt lgkmcnt(3)
    v_exp_f32 v0, v120
    s_cbranch_scc0 L_loop
    v_mfma_f32_16x16x32_bf16 v[96:99], a[64:67], a[0:3], v[72:75]
    ds_read_b128 a[80:83], v10 offset:32768
    v_cvt_pk_bf16_f32 v91, v6, v7
    v_mfma_f32_16x16x32_bf16 v[104:107], a[64:67], a[4:7], v[76:79]
    s_waitcnt lgkmcnt(3)
    v_exp_f32 v1, v121
    v_mfma_f32_16x16x32_bf16 v[100:103], a[68:71], a[0:3], v[72:75]
    ds_read_b128 a[84:87], v10 offset:34816
    v_mfma_f32_16x16x32_bf16 v[108:111], a[68:71], a[4:7], v[76:79]
    s_waitcnt lgkmcnt(3)
    v_exp_f32 v2, v122
    v_mfma_f32_16x16x32_bf16 v[96:99], a[72:75], a[8:11], v[96:99]
    ds_read_b128 a[88:91], v11 offset:32768
    buffer_load_dwordx4 v30, s[36:39], s66 offen offset:2048 nt lds
    v_mfma_f32_16x16x32_bf16 v[104:107], a[72:75], a[12:15], v[104:107]
    s_waitcnt lgkmcnt(3)
    v_cvt_pk_bf16_f32 v92, v0, v1
    v_mfma_f32_16x16x32_bf16 v[100:103], a[76:79], a[8:11], v[100:103]
    ds_read_b128 a[92:95], v11 offset:34816
    v_mfma_f32_16x16x32_bf16 v[108:111], a[76:79], a[12:15], v[108:111]
    s_waitcnt lgkmcnt(3)
    v_exp_f32 v3, v123
    v_mfma_f32_16x16x32_bf16 v[96:99], a[80:83], a[16:19], v[96:99]
    ds_read_b128 a[96:99], v8 offset:33024
    buffer_load_dwordx4 v31, s[36:39], s66 offen offset:3072 nt lds
    v_mfma_f32_16x16x32_bf16 v[104:107], a[80:83], a[20:23], v[104:107]
    s_waitcnt lgkmcnt(3)
    v_exp_f32 v4, v124
    v_mfma_f32_16x16x32_bf16 v[100:103], a[84:87], a[16:19], v[100:103]
    s_add_u32 s66, s66, 32768
    ds_read_b128 a[100:103], v8 offset:35072
    v_mfma_f32_16x16x32_bf16 v[108:111], a[84:87], a[20:23], v[108:111]
    s_waitcnt lgkmcnt(3)
    v_cvt_pk_bf16_f32 v93, v2, v3
    v_mfma_f32_16x16x32_bf16 v[96:99], a[88:91], a[24:27], v[96:99]
    s_and_b32 s66, s66, 0x7ffff
    ds_read_b128 a[104:107], v9 offset:33024
    v_mfma_f32_16x16x32_bf16 v[104:107], a[88:91], a[28:31], v[104:107]
    s_waitcnt lgkmcnt(3)
    v_exp_f32 v5, v125
    v_mfma_f32_16x16x32_bf16 v[100:103], a[92:95], a[24:27], v[100:103]
    s_add_u32 m0, s60, 114688
    ds_read_b128 a[108:111], v9 offset:35072
    v_mfma_f32_16x16x32_bf16 v[108:111], a[92:95], a[28:31], v[108:111]
    s_waitcnt lgkmcnt(3)
    v_exp_f32 v6, v126
    v_mfma_f32_16x16x32_bf16 v[96:99], a[96:99], a[32:35], v[96:99]
    ds_read_b128 a[112:115], v10 offset:33024
    buffer_load_dwordx4 v32, s[40:43], s67 offen offset:0 nt lds
    v_mfma_f32_16x16x32_bf16 v[104:107], a[96:99], a[36:39], v[104:107]
    s_waitcnt lgkmcnt(3)
    v_cvt_pk_bf16_f32 v94, v4, v5
    v_mfma_f32_16x16x32_bf16 v[100:103], a[100:103], a[32:35], v[100:103]
    ds_read_b128 a[116:119], v10 offset:35072
    v_mfma_f32_16x16x32_bf16 v[108:111], a[100:103], a[36:39], v[108:111]
    s_waitcnt lgkmcnt(3)
    v_exp_f32 v7, v127
    v_mfma_f32_16x16x32_bf16 v[96:99], a[104:107], a[40:43], v[96:99]
    ds_read_b128 a[120:123], v11 offset:33024
    buffer_load_dwordx4 v33, s[40:43], s67 offen offset:1024 nt lds
    v_mfma_f32_16x16x32_bf16 v[104:107], a[104:107], a[44:47], v[104:107]
    s_waitcnt lgkmcnt(3)
    v_cvt_pk_bf16_f32 v95, v6, v7
    v_mfma_f32_16x16x32_bf16 v[100:103], a[108:111], a[40:43], v[100:103]
    ds_read_b128 a[124:127], v11 offset:35072
    v_mfma_f32_16x16x32_bf16 v[108:111], a[108:111], a[44:47], v[108:111]
    s_waitcnt lgkmcnt(3)
    v_mfma_f32_16x16x32_bf16 v[68:71], a[160:163], v[88:91], v[64:67]
    v_mfma_f32_16x16x32_bf16 v[68:71], a[164:167], v[92:95], v[68:71]
    v_mfma_f32_16x16x32_bf16 v[96:99], a[112:115], a[48:51], v[96:99]
    ds_read_b64_tr_b16 a[64:65], v12 offset:16384
    v_mfma_f32_16x16x32_bf16 v[104:107], a[112:115], a[52:55], v[104:107]
    s_waitcnt lgkmcnt(3)
    ds_read_b64_tr_b16 a[66:67], v12 offset:18432
    buffer_load_dwordx4 v32, s[40:43], s67 offen offset:2048 nt lds
    v_mfma_f32_16x16x32_bf16 v[100:103], a[116:119], a[48:51], v[100:103]
    ds_read_b64_tr_b16 a[68:69], v13 offset:16384
    v_mfma_f32_16x16x32_bf16 v[108:111], a[116:119], a[52:55], v[108:111]
    s_waitcnt lgkmcnt(4)
    ds_read_b64_tr_b16 a[70:71], v13 offset:18432
    v_mfma_f32_16x16x32_bf16 v[96:99], a[120:123], a[56:59], v[96:99]
    ds_read_b64_tr_b16 a[72:73], v14 offset:16384
    v_cmp_nge_f32 vcc, s72, v68
    v_mfma_f32_16x16x32_bf16 v[104:107], a[120:123], a[60:63], v[104:107]
    s_waitcnt lgkmcnt(5)
    ds_read_b64_tr_b16 a[74:75], v14 offset:18432
    buffer_load_dwordx4 v33, s[40:43], s67 offen offset:3072 nt lds
    v_mfma_f32_16x16x32_bf16 v[100:103], a[124:127], a[56:59], v[100:103]
    s_add_u32 s67, s67, 32768
    s_add_u32 m0, s60, 0
    s_cbranch_vccnz L_fixp29
L_retp29:
    v_mfma_f32_16x16x32_bf16 v[108:111], a[124:127], a[60:63], v[108:111]
    s_waitcnt lgkmcnt(4)
    ds_read_b64_tr_b16 a[76:77], v15 offset:16384
    ds_read_b64_tr_b16 a[78:79], v15 offset:18432
    v_mfma_f32_16x16x32_bf16 v[128:131], a[64:67], v[88:91], v[128:131]
    s_and_b32 s67, s67, 0x7ffff
    ds_read_b64_tr_b16 a[80:81], v16 offset:16384
    ds_read_b64_tr_b16 a[82:83], v16 offset:18432
    v_mfma_f32_16x16x32_bf16 v[132:135], a[64:67], v[92:95], v[132:135]
    s_waitcnt lgkmcnt(6)
    buffer_load_dwordx4 v42, s[48:51], s6 offen offset:0 lds
    global_load_dword v55, v56, s[26:27] sc1
    v_mfma_f32_16x16x32_bf16 v[136:139], a[68:71], v[88:91], v[136:139]
    ds_read_b64_tr_b16 a[84:85], v17 offset:16384
    v_mfma_f32_16x16x32_bf16 v[140:143], a[68:71], v[92:95], v[140:143]
    s_waitcnt lgkmcnt(5)
    ds_read_b64_tr_b16 a[86:87], v17 offset:18432
    v_mfma_f32_16x16x32_bf16 v[144:147], a[72:75], v[88:91], v[144:147]
    ds_read_b64_tr_b16 a[88:89], v18 offset:16384
    v_mfma_f32_16x16x32_bf16 v[148:151], a[72:75], v[92:95], v[148:151]
    s_waitcnt lgkmcnt(5)
    ds_read_b64_tr_b16 a[90:91], v18 offset:18432
    buffer_load_dwordx4 v43, s[48:51], s6 offen offset:1024 lds
    v_mfma_f32_16x16x32_bf16 v[152:155], a[76:79], v[88:91], v[152:155]
    ds_read_b64_tr_b16 a[92:93], v19 offset:16384
    ds_read_b64_tr_b16 a[94:95], v19 offset:18432
    v_mfma_f32_16x16x32_bf16 v[156:159], a[76:79], v[92:95], v[156:159]
    s_waitcnt lgkmcnt(6)
    v_exp_f32 v0, v96
    v_mfma_f32_16x16x32_bf16 v[160:163], a[80:83], v[88:91], v[160:163]
    ds_read_b64_tr_b16 a[96:97], v12 offset:16640
    ds_read_b64_tr_b16 a[98:99], v12 offset:18688
    v_mfma_f32_16x16x32_bf16 v[164:167], a[80:83], v[92:95], v[164:167]
    s_waitcnt lgkmcnt(6)
    v_exp_f32 v1, v97
    v_mfma_f32_16x16x32_bf16 v[168:171], a[84:87], v[88:91], v[168:171]
    ds_read_b64_tr_b16 a[100:101], v13 offset:16640
    ds_read_b64_tr_b16 a[102:103], v13 offset:18688
    v_mfma_f32_16x16x32_bf16 v[172:175], a[84:87], v[92:95], v[172:175]
    s_waitcnt lgkmcnt(6)
    v_exp_f32 v2, v98
    v_mfma_f32_16x16x32_bf16 v[176:179], a[88:91], v[88:91], v[176:179]
    ds_read_b64_tr_b16 a[104:105], v14 offset:16640
    v_mfma_f32_16x16x32_bf16 v[180:183], a[88:91], v[92:95], v[180:183]
    s_waitcnt lgkmcnt(5)
    ds_read_b64_tr_b16 a[106:107], v14 offset:18688
    v_cvt_pk_bf16_f32 v80, v0, v1
    v_mfma_f32_16x16x32_bf16 v[184:187], a[92:95], v[88:91], v[184:187]
    ds_read_b64_tr_b16 a[108:109], v15 offset:16640
    ds_read_b64_tr_b16 a[110:111], v15 offset:18688
    v_mfma_f32_16x16x32_bf16 v[188:191], a[92:95], v[92:95], v[188:191]
    s_waitcnt lgkmcnt(6)
    v_exp_f32 v3, v99
    v_mfma_f32_16x16x32_bf16 v[192:195], a[96:99], v[88:91], v[192:195]
    ds_read_b64_tr_b16 a[112:113], v16 offset:16640
    v_mfma_f32_16x16x32_bf16 v[196:199], a[96:99], v[92:95], v[196:199]
    s_waitcnt lgkmcnt(5)
    ds_read_b64_tr_b16 a[114:115], v16 offset:18688
    v_mfma_f32_16x16x32_bf16 v[200:203], a[100:103], v[88:91], v[200:203]
    ds_read_b64_tr_b16 a[116:117], v17 offset:16640
    ds_read_b64_tr_b16 a[118:119], v17 offset:18688
    v_mfma_f32_16x16x32_bf16 v[204:207], a[100:103], v[92:95], v[204:207]
    s_waitcnt lgkmcnt(6)
    v_exp_f32 v4, v100
    v_mfma_f32_16x16x32_bf16 v[208:211], a[104:107], v[88:91], v[208:211]
    ds_read_b64_tr_b16 a[120:121], v18 offset:16640
    v_mfma_f32_16x16x32_bf16 v[212:215], a[104:107], v[92:95], v[212:215]
    s_waitcnt lgkmcnt(5)
    ds_read_b64_tr_b16 a[122:123], v18 offset:18688
    v_cvt_pk_bf16_f32 v81, v2, v3
    v_mfma_f32_16x16x32_bf16 v[216:219], a[108:111], v[88:91], v[216:219]
    ds_read_b64_tr_b16 a[124:125], v19 offset:16640
    ds_read_b64_tr_b16 a[126:127], v19 offset:18688
    v_mfma_f32_16x16x32_bf16 v[220:223], a[108:111], v[92:95], v[220:223]
    s_waitcnt vmcnt(7) lgkmcnt(6)
    v_exp_f32 v5, v101
    v_mfma_f32_16x16x32_bf16 v[224:227], a[112:115], v[88:91], v[224:227]
    s_barrier
    ds_read_b128 a[64:67], v8 offset:49152
    v_mfma_f32_16x16x32_bf16 v[228:231], a[112:115], v[92:95], v[228:231]
    s_waitcnt lgkmcnt(5)
    v_exp_f32 v6, v102
    v_mfma_f32_16x16x32_bf16 v[232:235], a[116:119], v[88:91], v[232:235]
    ds_read_b128 a[68:71], v8 offset:51200
    v_mfma_f32_16x16x32_bf16 v[236:239], a[116:119], v[92:95], v[236:239]
    s_waitcnt lgkmcnt(4)
    v_cvt_pk_bf16_f32 v82, v4, v5
    v_mfma_f32_16x16x32_bf16 v[240:243], a[120:123], v[88:91], v[240:243]
    ds_read_b128 a[72:75], v9 offset:49152
    v_mfma_f32_16x16x32_bf16 v[244:247], a[120:123], v[92:95], v[244:247]
    s_waitcnt lgkmcnt(3)
    v_exp_f32 v7, v103
    v_mfma_f32_16x16x32_bf16 v[248:251], a[124:127], v[88:91], v[248:251]
    ds_read_b128 a[76:79], v9 offset:51200
    v_mfma_f32_16x16x32_bf16 v[252:255], a[124:127], v[92:95], v[252:255]
    s_waitcnt lgkmcnt(3)
    v_exp_f32 v0, v104
    v_mfma_f32_16x16x32_bf16 v[112:115], a[64:67], a[0:3], v[72:75]
    ds_read_b128 a[80:83], v10 offset:49152
    v_cvt_pk_bf16_f32 v83, v6, v7
    v_mfma_f32_16x16x32_bf16 v[120:123], a[64:67], a[4:7], v[76:79]
    s_waitcnt lgkmcnt(3)
    v_exp_f32 v1, v105
    v_mfma_f32_16x16x32_bf16 v[116:119], a[68:71], a[0:3], v[72:75]
    ds_read_b128 a[84:87], v10 offset:51200
    v_mfma_f32_16x16x32_bf16 v[124:127], a[68:71], a[4:7], v[76:79]
    s_waitcnt lgkmcnt(3)
    v_exp_f32 v2, v106
    v_mfma_f32_16x16x32_bf16 v[112:115], a[72:75], a[8:11], v[112:115]
    ds_read_b128 a[88:91], v11 offset:49152
    buffer_load_dwordx4 v44, s[48:51], s6 offen offset:2048 lds
    v_mfma_f32_16x16x32_bf16 v[120:123], a[72:75], a[12:15], v[120:123]
    s_waitcnt lgkmcnt(3)
    v_cvt_pk_bf16_f32 v84, v0, v1
    v_mfma_f32_16x16x32_bf16 v[116:119], a[76:79], a[8:11], v[116:119]
    ds_read_b128 a[92:95], v11 offset:51200
    v_mfma_f32_16x16x32_bf16 v[124:127], a[76:79], a[12:15], v[124:127]
    s_waitcnt lgkmcnt(3)
    v_exp_f32 v3, v107
    v_mfma_f32_16x16x32_bf16 v[112:115], a[80:83], a[16:19], v[112:115]
    ds_read_b128 a[96:99], v8 offset:49408
    buffer_load_dwordx4 v45, s[48:51], s6 offen offset:3072 lds
    v_mfma_f32_16x16x32_bf16 v[120:123], a[80:83], a[20:23], v[120:123]
    s_waitcnt lgkmcnt(3)
    v_exp_f32 v4, v108
    v_mfma_f32_16x16x32_bf16 v[116:119], a[84:87], a[16:19], v[116:119]
    ds_read_b128 a[100:103], v8 offset:51456
    v_mfma_f32_16x16x32_bf16 v[124:127], a[84:87], a[20:23], v[124:127]
    s_waitcnt lgkmcnt(3)
    v_cvt_pk_bf16_f32 v85, v2, v3
    v_mfma_f32_16x16x32_bf16 v[112:115], a[88:91], a[24:27], v[112:115]
    ds_read_b128 a[104:107], v9 offset:49408
    v_mfma_f32_16x16x32_bf16 v[120:123], a[88:91], a[28:31], v[120:123]
    s_waitcnt lgkmcnt(3)
    v_exp_f32 v5, v109
    v_mfma_f32_16x16x32_bf16 v[116:119], a[92:95], a[24:27], v[116:119]
    s_add_u32 m0, s60, 16384
    ds_read_b128 a[108:111], v9 offset:51456
    v_mfma_f32_16x16x32_bf16 v[124:127], a[92:95], a[28:31], v[124:127]
    s_waitcnt lgkmcnt(3)
    v_exp_f32 v6, v110
    v_mfma_f32_16x16x32_bf16 v[112:115], a[96:99], a[32:35], v[112:115]
    ds_read_b128 a[112:115], v10 offset:49408
    buffer_load_dwordx4 v42, s[48:51], s7 offen offset:0 lds
    v_mfma_f32_16x16x32_bf16 v[120:123], a[96:99], a[36:39], v[120:123]
    s_waitcnt lgkmcnt(3)
    v_cvt_pk_bf16_f32 v86, v4, v5
    v_mfma_f32_16x16x32_bf16 v[116:119], a[100:103], a[32:35], v[116:119]
    ds_read_b128 a[116:119], v10 offset:51456
    buffer_load_dwordx4 v43, s[48:51], s7 offen offset:1024 lds
    v_mfma_f32_16x16x32_bf16 v[124:127], a[100:103], a[36:39], v[124:127]
    s_waitcnt lgkmcnt(3)
    v_exp_f32 v7, v111
    v_mfma_f32_16x16x32_bf16 v[112:115], a[104:107], a[40:43], v[112:115]
    ds_read_b128 a[120:123], v11 offset:49408
    buffer_load_dwordx4 v44, s[48:51], s7 offen offset:2048 lds
    v_mfma_f32_16x16x32_bf16 v[120:123], a[104:107], a[44:47], v[120:123]
    s_waitcnt lgkmcnt(3)
    v_cvt_pk_bf16_f32 v87, v6, v7
    v_mfma_f32_16x16x32_bf16 v[116:119], a[108:111], a[40:43], v[116:119]
    ds_read_b128 a[124:127], v11 offset:51456
    v_mfma_f32_16x16x32_bf16 v[124:127], a[108:111], a[44:47], v[124:127]
    s_waitcnt lgkmcnt(3)
    buffer_load_dwordx4 v45, s[48:51], s7 offen offset:3072 lds
    v_mfma_f32_16x16x32_bf16 v[64:67], a[160:163], v[80:83], v[68:71]
    v_mfma_f32_16x16x32_bf16 v[64:67], a[164:167], v[84:87], v[64:67]
    v_mfma_f32_16x16x32_bf16 v[112:115], a[112:115], a[48:51], v[112:115]
    s_add_u32 m0, s60, 32768
    ds_read_b64_tr_b16 a[64:65], v12 offset:32768
    v_mfma_f32_16x16x32_bf16 v[120:123], a[112:115], a[52:55], v[120:123]
    s_waitcnt lgkmcnt(3)
    ds_read_b64_tr_b16 a[66:67], v12 offset:34816
    v_mfma_f32_16x16x32_bf16 v[116:119], a[116:119], a[48:51], v[116:119]
    ds_read_b64_tr_b16 a[68:69], v13 offset:32768
    v_mfma_f32_16x16x32_bf16 v[124:127], a[116:119], a[52:55], v[124:127]
    s_waitcnt lgkmcnt(4)
    ds_read_b64_tr_b16 a[70:71], v13 offset:34816
    buffer_load_dwordx4 v42, s[48:51], s8 offen offset:0 lds
    v_mfma_f32_16x16x32_bf16 v[112:115], a[120:123], a[56:59], v[112:115]
    ds_read_b64_tr_b16 a[72:73], v14 offset:32768
    v_cmp_nge_f32 vcc, s72, v64
    v_mfma_f32_16x16x32_bf16 v[120:123], a[120:123], a[60:63], v[120:123]
    s_waitcnt lgkmcnt(5)
    ds_read_b64_tr_b16 a[74:75], v14 offset:34816
    buffer_load_dwordx4 v43, s[48:51], s8 offen offset:1024 lds
    v_mfma_f32_16x16x32_bf16 v[116:119], a[124:127], a[56:59], v[116:119]
    s_cbranch_vccnz L_fixp30
L_retp30:
    ds_read_b64_tr_b16 a[76:77], v15 offset:32768
    v_mfma_f32_16x16x32_bf16 v[124:127], a[124:127], a[60:63], v[124:127]
    s_waitcnt lgkmcnt(5)
    ds_read_b64_tr_b16 a[78:79], v15 offset:34816
    buffer_load_dwordx4 v44, s[48:51], s8 offen offset:2048 lds
    v_mfma_f32_16x16x32_bf16 v[128:131], a[64:67], v[80:83], v[128:131]
    ds_read_b64_tr_b16 a[80:81], v16 offset:32768
    v_mfma_f32_16x16x32_bf16 v[132:135], a[64:67], v[84:87], v[132:135]
    s_waitcnt lgkmcnt(5)
    ds_read_b64_tr_b16 a[82:83], v16 offset:34816
    buffer_load_dwordx4 v45, s[48:51], s8 offen offset:3072 lds
    v_mfma_f32_16x16x32_bf16 v[136:139], a[68:71], v[80:83], v[136:139]
    s_add_u32 m0, s60, 65536
    ds_read_b64_tr_b16 a[84:85], v17 offset:32768
    v_mfma_f32_16x16x32_bf16 v[140:143], a[68:71], v[84:87], v[140:143]
    s_waitcnt lgkmcnt(5)
    ds_read_b64_tr_b16 a[86:87], v17 offset:34816
    v_mfma_f32_16x16x32_bf16 v[144:147], a[72:75], v[80:83], v[144:147]
    ds_read_b64_tr_b16 a[88:89], v18 offset:32768
    v_mfma_f32_16x16x32_bf16 v[148:151], a[72:75], v[84:87], v[148:151]
    s_waitcnt lgkmcnt(5)
    ds_read_b64_tr_b16 a[90:91], v18 offset:34816
    buffer_load_dwordx4 v42, s[48:51], s9 offen offset:0 lds
    v_mfma_f32_16x16x32_bf16 v[152:155], a[76:79], v[80:83], v[152:155]
    ds_read_b64_tr_b16 a[92:93], v19 offset:32768
    v_mfma_f32_16x16x32_bf16 v[156:159], a[76:79], v[84:87], v[156:159]
    s_waitcnt lgkmcnt(5)
    ds_read_b64_tr_b16 a[94:95], v19 offset:34816
    buffer_load_dwordx4 v43, s[48:51], s9 offen offset:1024 lds
    v_mfma_f32_16x16x32_bf16 v[160:163], a[80:83], v[80:83], v[160:163]
    ds_read_b64_tr_b16 a[96:97], v12 offset:33024
    v_mfma_f32_16x16x32_bf16 v[164:167], a[80:83], v[84:87], v[164:167]
    s_waitcnt lgkmcnt(5)
    ds_read_b64_tr_b16 a[98:99], v12 offset:35072
    buffer_load_dwordx4 v44, s[48:51], s9 offen offset:2048 lds
    v_mfma_f32_16x16x32_bf16 v[168:171], a[84:87], v[80:83], v[168:171]
    ds_read_b64_tr_b16 a[100:101], v13 offset:33024
    v_mfma_f32_16x16x32_bf16 v[172:175], a[84:87], v[84:87], v[172:175]
    s_waitcnt lgkmcnt(5)
    ds_read_b64_tr_b16 a[102:103], v13 offset:35072
    buffer_load_dwordx4 v45, s[48:51], s9 offen offset:3072 lds
    v_mfma_f32_16x16x32_bf16 v[176:179], a[88:91], v[80:83], v[176:179]
    ds_read_b64_tr_b16 a[104:105], v14 offset:33024
    ds_read_b64_tr_b16 a[106:107], v14 offset:35072
    v_mfma_f32_16x16x32_bf16 v[180:183], a[88:91], v[84:87], v[180:183]
    s_waitcnt lgkmcnt(6)
    v_exp_f32 v0, v112
    v_mfma_f32_16x16x32_bf16 v[184:187], a[92:95], v[80:83], v[184:187]
    ds_read_b64_tr_b16 a[108:109], v15 offset:33024
    ds_read_b64_tr_b16 a[110:111], v15 offset:35072
    v_mfma_f32_16x16x32_bf16 v[188:191], a[92:95], v[84:87], v[188:191]
    s_waitcnt lgkmcnt(6)
    v_exp_f32 v1, v113
    v_mfma_f32_16x16x32_bf16 v[192:195], a[96:99], v[80:83], v[192:195]
    ds_read_b64_tr_b16 a[112:113], v16 offset:33024
    ds_read_b64_tr_b16 a[114:115], v16 offset:35072
    v_mfma_f32_16x16x32_bf16 v[196:199], a[96:99], v[84:87], v[196:199]
    s_waitcnt lgkmcnt(6)
    v_exp_f32 v2, v114
    v_mfma_f32_16x16x32_bf16 v[200:203], a[100:103], v[80:83], v[200:203]
    ds_read_b64_tr_b16 a[116:117], v17 offset:33024
    v_mfma_f32_16x16x32_bf16 v[204:207], a[100:103], v[84:87], v[204:207]
    s_waitcnt lgkmcnt(5)
    ds_read_b64_tr_b16 a[118:119], v17 offset:35072
    v_cvt_pk_bf16_f32 v88, v0, v1
    v_mfma_f32_16x16x32_bf16 v[208:211], a[104:107], v[80:83], v[208:211]
    ds_read_b64_tr_b16 a[120:121], v18 offset:33024
    ds_read_b64_tr_b16 a[122:123], v18 offset:35072
    v_mfma_f32_16x16x32_bf16 v[212:215], a[104:107], v[84:87], v[212:215]
    s_waitcnt lgkmcnt(6)
    v_exp_f32 v3, v115
    v_mfma_f32_16x16x32_bf16 v[216:219], a[108:111], v[80:83], v[216:219]
    ds_read_b64_tr_b16 a[124:125], v19 offset:33024
    ds_read_b64_tr_b16 a[126:127], v19 offset:35072
    v_mfma_f32_16x16x32_bf16 v[220:223], a[108:111], v[84:87], v[220:223]
    s_waitcnt vmcnt(17) lgkmcnt(6)
    v_exp_f32 v4, v116
    v_mfma_f32_16x16x32_bf16 v[224:227], a[112:115], v[80:83], v[224:227]
    s_barrier
    ds_read_b64_tr_b16 a[64:65], v12 offset:49152
    v_mfma_f32_16x16x32_bf16 v[228:231], a[112:115], v[84:87], v[228:231]
    s_waitcnt lgkmcnt(5)
    ds_read_b64_tr_b16 a[66:67], v12 offset:51200
    v_cvt_pk_bf16_f32 v89, v2, v3
    v_mfma_f32_16x16x32_bf16 v[232:235], a[116:119], v[80:83], v[232:235]
    ds_read_b64_tr_b16 a[68:69], v13 offset:49152
    ds_read_b64_tr_b16 a[70:71], v13 offset:51200
    v_mfma_f32_16x16x32_bf16 v[236:239], a[116:119], v[84:87], v[236:239]
    s_waitcnt lgkmcnt(6)
    v_exp_f32 v5, v117
    v_mfma_f32_16x16x32_bf16 v[240:243], a[120:123], v[80:83], v[240:243]
    ds_read_b64_tr_b16 a[72:73], v14 offset:49152
    ds_read_b64_tr_b16 a[74:75], v14 offset:51200
    v_mfma_f32_16x16x32_bf16 v[244:247], a[120:123], v[84:87], v[244:247]
    s_waitcnt lgkmcnt(6)
    v_exp_f32 v6, v118
    v_mfma_f32_16x16x32_bf16 v[248:251], a[124:127], v[80:83], v[248:251]
    ds_read_b64_tr_b16 a[76:77], v15 offset:49152
    ds_read_b64_tr_b16 a[78:79], v15 offset:51200
    v_cvt_pk_bf16_f32 v90, v4, v5
    v_exp_f32 v7, v119
    v_exp_f32 v0, v120
    v_cvt_pk_bf16_f32 v91, v6, v7
    v_exp_f32 v1, v121
    v_exp_f32 v2, v122
    v_cvt_pk_bf16_f32 v92, v0, v1
    v_mfma_f32_16x16x32_bf16 v[252:255], a[124:127], v[84:87], v[252:255]
    s_waitcnt lgkmcnt(6)
    v_exp_f32 v3, v123
    v_exp_f32 v4, v124
    v_cvt_pk_bf16_f32 v93, v2, v3
    v_exp_f32 v5, v125
    v_exp_f32 v6, v126
    v_cvt_pk_bf16_f32 v94, v4, v5
    v_exp_f32 v7, v127
    s_nop 0
    v_cvt_pk_bf16_f32 v95, v6, v7
    v_mfma_f32_16x16x32_bf16 v[68:71], a[160:163], v[88:91], v[64:67]
    s_nop 0
    v_mfma_f32_16x16x32_bf16 v[68:71], a[164:167], v[92:95], v[68:71]
    s_nop 7
    v_cmp_nge_f32 vcc, s72, v68
    s_nop 0
    s_cbranch_vccnz L_fixp31
L_retp31:
    v_mfma_f32_16x16x32_bf16 v[128:131], a[64:67], v[88:91], v[128:131]
    s_add_u32 m0, s60, 49152
    ds_read_b64_tr_b16 a[80:81], v16 offset:49152
    v_mfma_f32_16x16x32_bf16 v[132:135], a[64:67], v[92:95], v[132:135]
    s_waitcnt lgkmcnt(5)
    ds_read_b64_tr_b16 a[82:83], v16 offset:51200
    v_mov_b32 v62, v68
    v_mfma_f32_16x16x32_bf16 v[136:139], a[68:71], v[88:91], v[136:139]
    ds_read_b64_tr_b16 a[84:85], v17 offset:49152
    v_mfma_f32_16x16x32_bf16 v[140:143], a[68:71], v[92:95], v[140:143]
    s_waitcnt lgkmcnt(5)
    ds_read_b64_tr_b16 a[86:87], v17 offset:51200
    buffer_load_dwordx4 v42, s[48:51], s10 offen offset:0 lds
    v_mfma_f32_16x16x32_bf16 v[144:147], a[72:75], v[88:91], v[144:147]
    ds_read_b64_tr_b16 a[88:89], v18 offset:49152
    ds_read_b64_tr_b16 a[90:91], v18 offset:51200
    v_mfma_f32_16x16x32_bf16 v[148:151], a[72:75], v[92:95], v[148:151]
    s_waitcnt lgkmcnt(6)
    v_permlane16_swap_b32 v68, v62
    v_mfma_f32_16x16x32_bf16 v[152:155], a[76:79], v[88:91], v[152:155]
    ds_read_b64_tr_b16 a[92:93], v19 offset:49152
    v_mov_b32 v64, v68
    v_mfma_f32_16x16x32_bf16 v[156:159], a[76:79], v[92:95], v[156:159]
    s_waitcnt lgkmcnt(5)
    ds_read_b64_tr_b16 a[94:95], v19 offset:51200
    buffer_load_dwordx4 v43, s[48:51], s10 offen offset:1024 lds
    v_mfma_f32_16x16x32_bf16 v[160:163], a[80:83], v[88:91], v[160:163]
    ds_read_b64_tr_b16 a[96:97], v12 offset:49408
    v_mfma_f32_16x16x32_bf16 v[164:167], a[80:83], v[92:95], v[164:167]
    s_waitcnt lgkmcnt(5)
    ds_read_b64_tr_b16 a[98:99], v12 offset:51456
    v_mov_b32 v63, v62
    v_mfma_f32_16x16x32_bf16 v[168:171], a[84:87], v[88:91], v[168:171]
    ds_read_b64_tr_b16 a[100:101], v13 offset:49408
    v_mfma_f32_16x16x32_bf16 v[172:175], a[84:87], v[92:95], v[172:175]
    s_waitcnt lgkmcnt(5)
    ds_read_b64_tr_b16 a[102:103], v13 offset:51456
    buffer_load_dwordx4 v44, s[48:51], s10 offen offset:2048 lds
    v_mfma_f32_16x16x32_bf16 v[176:179], a[88:91], v[88:91], v[176:179]
    ds_read_b64_tr_b16 a[104:105], v14 offset:49408
    ds_read_b64_tr_b16 a[106:107], v14 offset:51456
    v_mfma_f32_16x16x32_bf16 v[180:183], a[88:91], v[92:95], v[180:183]
    s_waitcnt lgkmcnt(6)
    v_permlane32_swap_b32 v68, v64
    v_mfma_f32_16x16x32_bf16 v[184:187], a[92:95], v[88:91], v[184:187]
    ds_read_b64_tr_b16 a[108:109], v15 offset:49408
    v_permlane32_swap_b32 v62, v63
    v_rcp_f32 v60, v68
    v_mfma_f32_16x16x32_bf16 v[188:191], a[92:95], v[92:95], v[188:191]
    s_waitcnt lgkmcnt(5)
    ds_read_b64_tr_b16 a[110:111], v15 offset:51456
    buffer_load_dwordx4 v45, s[48:51], s10 offen offset:3072 lds
    v_rcp_f32 v61, v62
    v_mfma_f32_16x16x32_bf16 v[192:195], a[96:99], v[88:91], v[192:195]
    ds_read_b64_tr_b16 a[112:113], v16 offset:49408
    v_mfma_f32_16x16x32_bf16 v[196:199], a[96:99], v[92:95], v[196:199]
    s_waitcnt lgkmcnt(5)
    ds_read_b64_tr_b16 a[114:115], v16 offset:51456
    v_pk_mul_f32 v[128:129], v[128:129], v[60:61] op_sel:[0,0] op_sel_hi:[1,0]
    v_pk_mul_f32 v[130:131], v[130:131], v[60:61] op_sel:[0,0] op_sel_hi:[1,0]
    v_pk_mul_f32 v[136:137], v[136:137], v[60:61] op_sel:[0,0] op_sel_hi:[1,0]
    v_pk_mul_f32 v[138:139], v[138:139], v[60:61] op_sel:[0,0] op_sel_hi:[1,0]
    v_pk_mul_f32 v[132:133], v[132:133], v[60:61] op_sel:[0,1] op_sel_hi:[1,1]
    v_pk_mul_f32 v[134:135], v[134:135], v[60:61] op_sel:[0,1] op_sel_hi:[1,1]
    v_pk_mul_f32 v[140:141], v[140:141], v[60:61] op_sel:[0,1] op_sel_hi:[1,1]
    v_pk_mul_f32 v[142:143], v[142:143], v[60:61] op_sel:[0,1] op_sel_hi:[1,1]
    v_pk_mul_f32 v[144:145], v[144:145], v[60:61] op_sel:[0,0] op_sel_hi:[1,0]
    v_pk_mul_f32 v[146:147], v[146:147], v[60:61] op_sel:[0,0] op_sel_hi:[1,0]
    v_pk_mul_f32 v[152:153], v[152:153], v[60:61] op_sel:[0,0] op_sel_hi:[1,0]
    v_pk_mul_f32 v[154:155], v[154:155], v[60:61] op_sel:[0,0] op_sel_hi:[1,0]
    v_pk_mul_f32 v[148:149], v[148:149], v[60:61] op_sel:[0,1] op_sel_hi:[1,1]
    v_pk_mul_f32 v[150:151], v[150:151], v[60:61] op_sel:[0,1] op_sel_hi:[1,1]
    v_pk_mul_f32 v[156:157], v[156:157], v[60:61] op_sel:[0,1] op_sel_hi:[1,1]
    v_pk_mul_f32 v[158:159], v[158:159], v[60:61] op_sel:[0,1] op_sel_hi:[1,1]
    v_mfma_f32_16x16x32_bf16 v[200:203], a[100:103], v[88:91], v[200:203]
    ds_read_b64_tr_b16 a[116:117], v17 offset:49408
    v_cvt_pk_bf16_f32 v128, v128, v129
    v_mfma_f32_16x16x32_bf16 v[204:207], a[100:103], v[92:95], v[204:207]
    s_waitcnt lgkmcnt(5)
    ds_read_b64_tr_b16 a[118:119], v17 offset:51456
    v_cvt_pk_bf16_f32 v129, v130, v131
    v_mfma_f32_16x16x32_bf16 v[208:211], a[104:107], v[88:91], v[208:211]
    ds_read_b64_tr_b16 a[120:121], v18 offset:49408
    v_cvt_pk_bf16_f32 v130, v136, v137
    v_mfma_f32_16x16x32_bf16 v[212:215], a[104:107], v[92:95], v[212:215]
    s_waitcnt lgkmcnt(5)
    ds_read_b64_tr_b16 a[122:123], v18 offset:51456
    v_cvt_pk_bf16_f32 v131, v138, v139
    v_mfma_f32_16x16x32_bf16 v[216:219], a[108:111], v[88:91], v[216:219]
    ds_read_b64_tr_b16 a[124:125], v19 offset:49408
    v_cvt_pk_bf16_f32 v132, v132, v133
    v_mfma_f32_16x16x32_bf16 v[220:223], a[108:111], v[92:95], v[220:223]
    s_waitcnt vmcnt(4) lgkmcnt(5)
    ds_read_b64_tr_b16 a[126:127], v19 offset:51456
    v_cvt_pk_bf16_f32 v133, v134, v135
    v_mfma_f32_16x16x32_bf16 v[224:227], a[112:115], v[88:91], v[224:227]
    s_barrier
    s_add_u32 m0, s60, 81920
    ds_read_b64_tr_b16 a[64:65], v24 offset:0
    v_mfma_f32_16x16x32_bf16 v[228:231], a[112:115], v[92:95], v[228:231]
    s_waitcnt lgkmcnt(5)
    ds_read_b64_tr_b16 a[66:67], v24 offset:2048
    v_cvt_pk_bf16_f32 v134, v140, v141
    v_mfma_f32_16x16x32_bf16 v[232:235], a[116:119], v[88:91], v[232:235]
    ds_read_b64_tr_b16 a[68:69], v25 offset:0
    v_cvt_pk_bf16_f32 v135, v142, v143
    v_mfma_f32_16x16x32_bf16 v[236:239], a[116:119], v[92:95], v[236:239]
    s_waitcnt lgkmcnt(5)
    ds_read_b64_tr_b16 a[70:71], v25 offset:2048
    buffer_load_dwordx4 v42, s[48:51], s11 offen offset:0 lds
    v_mfma_f32_16x16x32_bf16 v[240:243], a[120:123], v[88:91], v[240:243]
    ds_read_b64_tr_b16 a[72:73], v26 offset:0
    v_cvt_pk_bf16_f32 v136, v144, v145
    v_mfma_f32_16x16x32_bf16 v[244:247], a[120:123], v[92:95], v[244:247]
    s_waitcnt lgkmcnt(5)
    ds_read_b64_tr_b16 a[74:75], v26 offset:2048
    v_cvt_pk_bf16_f32 v137, v146, v147
    v_mfma_f32_16x16x32_bf16 v[248:251], a[124:127], v[88:91], v[248:251]
    ds_read_b64_tr_b16 a[76:77], v27 offset:0
    v_cvt_pk_bf16_f32 v138, v152, v153
    v_mfma_f32_16x16x32_bf16 v[252:255], a[124:127], v[92:95], v[252:255]
    s_waitcnt lgkmcnt(5)
    ds_read_b64_tr_b16 a[78:79], v27 offset:2048
    v_cvt_pk_bf16_f32 v139, v154, v155
    v_mfma_f32_16x16x32_bf16 v[96:99], a[64:67], v[128:131], 0
    ds_read_b64_tr_b16 a[80:81], v24 offset:4096
    v_cvt_pk_bf16_f32 v140, v148, v149
    v_cvt_pk_bf16_f32 v141, v150, v151
    v_mfma_f32_16x16x32_bf16 v[112:115], a[64:67], v[132:135], 0
    s_waitcnt lgkmcnt(5)
    ds_read_b64_tr_b16 a[82:83], v24 offset:6144
    v_cvt_pk_bf16_f32 v142, v156, v157
    v_cvt_pk_bf16_f32 v143, v158, v159
    v_pk_mul_f32 v[160:161], v[160:161], v[60:61] op_sel:[0,0] op_sel_hi:[1,0]
    v_pk_mul_f32 v[162:163], v[162:163], v[60:61] op_sel:[0,0] op_sel_hi:[1,0]
    v_pk_mul_f32 v[168:169], v[168:169], v[60:61] op_sel:[0,0] op_sel_hi:[1,0]
    v_pk_mul_f32 v[170:171], v[170:171], v[60:61] op_sel:[0,0] op_sel_hi:[1,0]
    v_pk_mul_f32 v[164:165], v[164:165], v[60:61] op_sel:[0,1] op_sel_hi:[1,1]
    v_pk_mul_f32 v[166:167], v[166:167], v[60:61] op_sel:[0,1] op_sel_hi:[1,1]
    v_pk_mul_f32 v[172:173], v[172:173], v[60:61] op_sel:[0,1] op_sel_hi:[1,1]
    v_pk_mul_f32 v[174:175], v[174:175], v[60:61] op_sel:[0,1] op_sel_hi:[1,1]
    v_pk_mul_f32 v[176:177], v[176:177], v[60:61] op_sel:[0,0] op_sel_hi:[1,0]
    v_pk_mul_f32 v[178:179], v[178:179], v[60:61] op_sel:[0,0] op_sel_hi:[1,0]
    v_pk_mul_f32 v[184:185], v[184:185], v[60:61] op_sel:[0,0] op_sel_hi:[1,0]
    v_pk_mul_f32 v[186:187], v[186:187], v[60:61] op_sel:[0,0] op_sel_hi:[1,0]
    v_pk_mul_f32 v[180:181], v[180:181], v[60:61] op_sel:[0,1] op_sel_hi:[1,1]
    v_pk_mul_f32 v[182:183], v[182:183], v[60:61] op_sel:[0,1] op_sel_hi:[1,1]
    v_pk_mul_f32 v[188:189], v[188:189], v[60:61] op_sel:[0,1] op_sel_hi:[1,1]
    v_pk_mul_f32 v[190:191], v[190:191], v[60:61] op_sel:[0,1] op_sel_hi:[1,1]
    v_mfma_f32_16x16x32_bf16 v[100:103], a[68:71], v[128:131], 0
    ds_read_b64_tr_b16 a[84:85], v25 offset:4096
    v_cvt_pk_bf16_f32 v144, v160, v161
    v_mfma_f32_16x16x32_bf16 v[116:119], a[68:71], v[132:135], 0
    s_waitcnt lgkmcnt(5)
    ds_read_b64_tr_b16 a[86:87], v25 offset:6144
    buffer_load_dwordx4 v43, s[48:51], s11 offen offset:1024 lds
    v_mfma_f32_16x16x32_bf16 v[104:107], a[72:75], v[128:131], 0
    ds_read_b64_tr_b16 a[88:89], v26 offset:4096
    v_cvt_pk_bf16_f32 v145, v162, v163
    v_mfma_f32_16x16x32_bf16 v[120:123], a[72:75], v[132:135], 0
    s_waitcnt lgkmcnt(5)
    ds_read_b64_tr_b16 a[90:91], v26 offset:6144
    v_cvt_pk_bf16_f32 v146, v168, v169
    v_mfma_f32_16x16x32_bf16 v[108:111], a[76:79], v[128:131], 0
    ds_read_b64_tr_b16 a[92:93], v27 offset:4096
    v_cvt_pk_bf16_f32 v147, v170, v171
    v_mfma_f32_16x16x32_bf16 v[124:127], a[76:79], v[132:135], 0
    s_waitcnt lgkmcnt(5)
    ds_read_b64_tr_b16 a[94:95], v27 offset:6144
    v_cvt_pk_bf16_f32 v148, v164, v165
    v_mfma_f32_16x16x32_bf16 v[96:99], a[80:83], v[136:139], v[96:99]
    ds_read_b64_tr_b16 a[96:97], v24 offset:8192
    v_cvt_pk_bf16_f32 v149, v166, v167
    v_mfma_f32_16x16x32_bf16 v[112:115], a[80:83], v[140:143], v[112:115]
    s_waitcnt lgkmcnt(5)
    ds_read_b64_tr_b16 a[98:99], v24 offset:10240
    v_cvt_pk_bf16_f32 v150, v172, v173
    v_mfma_f32_16x16x32_bf16 v[100:103], a[84:87], v[136:139], v[100:103]
    ds_read_b64_tr_b16 a[100:101], v25 offset:8192
    v_cvt_pk_bf16_f32 v151, v174, v175
    v_mfma_f32_16x16x32_bf16 v[116:119], a[84:87], v[140:143], v[116:119]
    s_waitcnt lgkmcnt(5)
    ds_read_b64_tr_b16 a[102:103], v25 offset:10240
    buffer_load_dwordx4 v44, s[48:51], s11 offen offset:2048 lds
    v_mfma_f32_16x16x32_bf16 v[104:107], a[88:91], v[136:139], v[104:107]
    ds_read_b64_tr_b16 a[104:105], v26 offset:8192
    v_cvt_pk_bf16_f32 v152, v176, v177
    v_mfma_f32_16x16x32_bf16 v[120:123], a[88:91], v[140:143], v[120:123]
    s_waitcnt lgkmcnt(5)
    ds_read_b64_tr_b16 a[106:107], v26 offset:10240
    v_cvt_pk_bf16_f32 v153, v178, v179
    v_mfma_f32_16x16x32_bf16 v[108:111], a[92:95], v[136:139], v[108:111]
    ds_read_b64_tr_b16 a[108:109], v27 offset:8192
    v_cvt_pk_bf16_f32 v154, v184, v185
    v_mfma_f32_16x16x32_bf16 v[124:127], a[92:95], v[140:143], v[124:127]
    s_waitcnt lgkmcnt(5)
    ds_read_b64_tr_b16 a[110:111], v27 offset:10240
    v_cvt_pk_bf16_f32 v155, v186, v187
    v_mfma_f32_16x16x32_bf16 v[96:99], a[96:99], v[144:147], v[96:99]
    ds_read_b64_tr_b16 a[112:113], v24 offset:12288
    v_cvt_pk_bf16_f32 v156, v180, v181
    v_cvt_pk_bf16_f32 v157, v182, v183
    v_mfma_f32_16x16x32_bf16 v[112:115], a[96:99], v[148:151], v[112:115]
    s_waitcnt lgkmcnt(5)
    ds_read_b64_tr_b16 a[114:115], v24 offset:14336
    v_cvt_pk_bf16_f32 v158, v188, v189
    v_cvt_pk_bf16_f32 v159, v190, v191
    v_pk_mul_f32 v[192:193], v[192:193], v[60:61] op_sel:[0,0] op_sel_hi:[1,0]
    v_pk_mul_f32 v[194:195], v[194:195], v[60:61] op_sel:[0,0] op_sel_hi:[1,0]
    v_pk_mul_f32 v[200:201], v[200:201], v[60:61] op_sel:[0,0] op_sel_hi:[1,0]
    v_pk_mul_f32 v[202:203], v[202:203], v[60:61] op_sel:[0,0] op_sel_hi:[1,0]
    v_pk_mul_f32 v[196:197], v[196:197], v[60:61] op_sel:[0,1] op_sel_hi:[1,1]
    v_pk_mul_f32 v[198:199], v[198:199], v[60:61] op_sel:[0,1] op_sel_hi:[1,1]
    v_pk_mul_f32 v[204:205], v[204:205], v[60:61] op_sel:[0,1] op_sel_hi:[1,1]
    v_pk_mul_f32 v[206:207], v[206:207], v[60:61] op_sel:[0,1] op_sel_hi:[1,1]
    v_pk_mul_f32 v[208:209], v[208:209], v[60:61] op_sel:[0,0] op_sel_hi:[1,0]
    v_pk_mul_f32 v[210:211], v[210:211], v[60:61] op_sel:[0,0] op_sel_hi:[1,0]
    v_pk_mul_f32 v[216:217], v[216:217], v[60:61] op_sel:[0,0] op_sel_hi:[1,0]
    v_pk_mul_f32 v[218:219], v[218:219], v[60:61] op_sel:[0,0] op_sel_hi:[1,0]
    v_pk_mul_f32 v[212:213], v[212:213], v[60:61] op_sel:[0,1] op_sel_hi:[1,1]
    v_pk_mul_f32 v[214:215], v[214:215], v[60:61] op_sel:[0,1] op_sel_hi:[1,1]
    v_pk_mul_f32 v[220:221], v[220:221], v[60:61] op_sel:[0,1] op_sel_hi:[1,1]
    v_pk_mul_f32 v[222:223], v[222:223], v[60:61] op_sel:[0,1] op_sel_hi:[1,1]
    v_mfma_f32_16x16x32_bf16 v[100:103], a[100:103], v[144:147], v[100:103]
    ds_read_b64_tr_b16 a[116:117], v25 offset:12288
    v_cvt_pk_bf16_f32 v160, v192, v193
    v_mfma_f32_16x16x32_bf16 v[116:119], a[100:103], v[148:151], v[116:119]
    s_waitcnt lgkmcnt(5)
    ds_read_b64_tr_b16 a[118:119], v25 offset:14336
    buffer_load_dwordx4 v45, s[48:51], s11 offen offset:3072 lds
    v_mfma_f32_16x16x32_bf16 v[104:107], a[104:107], v[144:147], v[104:107]
    ds_read_b64_tr_b16 a[120:121], v26 offset:12288
    v_cvt_pk_bf16_f32 v161, v194, v195
    v_mfma_f32_16x16x32_bf16 v[120:123], a[104:107], v[148:151], v[120:123]
    s_waitcnt lgkmcnt(5)
    ds_read_b64_tr_b16 a[122:123], v26 offset:14336
    v_cvt_pk_bf16_f32 v162, v200, v201
    v_mfma_f32_16x16x32_bf16 v[108:111], a[108:111], v[144:147], v[108:111]
    ds_read_b64_tr_b16 a[124:125], v27 offset:12288
    v_cvt_pk_bf16_f32 v163, v202, v203
    v_mfma_f32_16x16x32_bf16 v[124:127], a[108:111], v[148:151], v[124:127]
    s_waitcnt lgkmcnt(5)
    ds_read_b64_tr_b16 a[126:127], v27 offset:14336
    v_cvt_pk_bf16_f32 v164, v196, v197
    v_mfma_f32_16x16x32_bf16 v[96:99], a[112:115], v[152:155], v[96:99]
    s_add_u32 m0, s60, 98304
    ds_read_b64_tr_b16 a[64:65], v24 offset:16384
    v_cvt_pk_bf16_f32 v165, v198, v199
    v_mfma_f32_16x16x32_bf16 v[112:115], a[112:115], v[156:159], v[112:115]
    s_waitcnt lgkmcnt(5)
    ds_read_b64_tr_b16 a[66:67], v24 offset:18432
    v_cvt_pk_bf16_f32 v166, v204, v205
    v_mfma_f32_16x16x32_bf16 v[100:103], a[116:119], v[152:155], v[100:103]
    ds_read_b64_tr_b16 a[68:69], v25 offset:16384
    v_cvt_pk_bf16_f32 v167, v206, v207
    v_mfma_f32_16x16x32_bf16 v[116:119], a[116:119], v[156:159], v[116:119]
    s_waitcnt lgkmcnt(5)
    ds_read_b64_tr_b16 a[70:71], v25 offset:18432
    buffer_load_dwordx4 v42, s[48:51], s12 offen offset:0 lds
    v_mfma_f32_16x16x32_bf16 v[104:107], a[120:123], v[152:155], v[104:107]
    ds_read_b64_tr_b16 a[72:73], v26 offset:16384
    v_cvt_pk_bf16_f32 v168, v208, v209
    v_mfma_f32_16x16x32_bf16 v[120:123], a[120:123], v[156:159], v[120:123]
    s_waitcnt lgkmcnt(5)
    ds_read_b64_tr_b16 a[74:75], v26 offset:18432
    v_cvt_pk_bf16_f32 v169, v210, v211
    v_mfma_f32_16x16x32_bf16 v[108:111], a[124:127], v[152:155], v[108:111]
    ds_read_b64_tr_b16 a[76:77], v27 offset:16384
    v_cvt_pk_bf16_f32 v170, v216, v217
    v_mfma_f32_16x16x32_bf16 v[124:127], a[124:127], v[156:159], v[124:127]
    s_waitcnt lgkmcnt(5)
    ds_read_b64_tr_b16 a[78:79], v27 offset:18432
    v_cvt_pk_bf16_f32 v171, v218, v219
    v_mfma_f32_16x16x32_bf16 v[96:99], a[64:67], v[160:163], v[96:99]
    ds_read_b64_tr_b16 a[80:81], v24 offset:20480
    v_cvt_pk_bf16_f32 v172, v212, v213
    v_cvt_pk_bf16_f32 v173, v214, v215
    v_mfma_f32_16x16x32_bf16 v[112:115], a[64:67], v[164:167], v[112:115]
    s_waitcnt lgkmcnt(5)
    ds_read_b64_tr_b16 a[82:83], v24 offset:22528
    v_cvt_pk_bf16_f32 v174, v220, v221
    v_cvt_pk_bf16_f32 v175, v222, v223
    v_pk_mul_f32 v[224:225], v[224:225], v[60:61] op_sel:[0,0] op_sel_hi:[1,0]
    v_pk_mul_f32 v[226:227], v[226:227], v[60:61] op_sel:[0,0] op_sel_hi:[1,0]
    v_pk_mul_f32 v[232:233], v[232:233], v[60:61] op_sel:[0,0] op_sel_hi:[1,0]
    v_pk_mul_f32 v[234:235], v[234:235], v[60:61] op_sel:[0,0] op_sel_hi:[1,0]
    v_pk_mul_f32 v[228:229], v[228:229], v[60:61] op_sel:[0,1] op_sel_hi:[1,1]
    v_pk_mul_f32 v[230:231], v[230:231], v[60:61] op_sel:[0,1] op_sel_hi:[1,1]
    v_pk_mul_f32 v[236:237], v[236:237], v[60:61] op_sel:[0,1] op_sel_hi:[1,1]
    v_pk_mul_f32 v[238:239], v[238:239], v[60:61] op_sel:[0,1] op_sel_hi:[1,1]
    v_pk_mul_f32 v[240:241], v[240:241], v[60:61] op_sel:[0,0] op_sel_hi:[1,0]
    v_pk_mul_f32 v[242:243], v[242:243], v[60:61] op_sel:[0,0] op_sel_hi:[1,0]
    v_pk_mul_f32 v[248:249], v[248:249], v[60:61] op_sel:[0,0] op_sel_hi:[1,0]
    v_pk_mul_f32 v[250:251], v[250:251], v[60:61] op_sel:[0,0] op_sel_hi:[1,0]
    v_pk_mul_f32 v[244:245], v[244:245], v[60:61] op_sel:[0,1] op_sel_hi:[1,1]
    v_pk_mul_f32 v[246:247], v[246:247], v[60:61] op_sel:[0,1] op_sel_hi:[1,1]
    v_pk_mul_f32 v[252:253], v[252:253], v[60:61] op_sel:[0,1] op_sel_hi:[1,1]
    v_pk_mul_f32 v[254:255], v[254:255], v[60:61] op_sel:[0,1] op_sel_hi:[1,1]
    v_mfma_f32_16x16x32_bf16 v[100:103], a[68:71], v[160:163], v[100:103]
    ds_read_b64_tr_b16 a[84:85], v25 offset:20480
    v_cvt_pk_bf16_f32 v176, v224, v225
    v_mfma_f32_16x16x32_bf16 v[116:119], a[68:71], v[164:167], v[116:119]
    s_waitcnt lgkmcnt(5)
    ds_read_b64_tr_b16 a[86:87], v25 offset:22528
    buffer_load_dwordx4 v43, s[48:51], s12 offen offset:1024 lds
    v_mfma_f32_16x16x32_bf16 v[104:107], a[72:75], v[160:163], v[104:107]
    ds_read_b64_tr_b16 a[88:89], v26 offset:20480
    v_cvt_pk_bf16_f32 v177, v226, v227
    v_mfma_f32_16x16x32_bf16 v[120:123], a[72:75], v[164:167], v[120:123]
    s_waitcnt lgkmcnt(5)
    ds_read_b64_tr_b16 a[90:91], v26 offset:22528
    v_cvt_pk_bf16_f32 v178, v232, v233
    v_mfma_f32_16x16x32_bf16 v[108:111], a[76:79], v[160:163], v[108:111]
    ds_read_b64_tr_b16 a[92:93], v27 offset:20480
    v_cvt_pk_bf16_f32 v179, v234, v235
    v_mfma_f32_16x16x32_bf16 v[124:127], a[76:79], v[164:167], v[124:127]
    s_waitcnt lgkmcnt(5)
    ds_read_b64_tr_b16 a[94:95], v27 offset:22528
    v_cvt_pk_bf16_f32 v180, v228, v229
    v_mfma_f32_16x16x32_bf16 v[96:99], a[80:83], v[168:171], v[96:99]
    ds_read_b64_tr_b16 a[96:97], v24 offset:24576
    v_cvt_pk_bf16_f32 v181, v230, v231
    v_mfma_f32_16x16x32_bf16 v[112:115], a[80:83], v[172:175], v[112:115]
    s_waitcnt lgkmcnt(5)
    ds_read_b64_tr_b16 a[98:99], v24 offset:26624
    v_cvt_pk_bf16_f32 v182, v236, v237
    v_mfma_f32_16x16x32_bf16 v[100:103], a[84:87], v[168:171], v[100:103]
    ds_read_b64_tr_b16 a[100:101], v25 offset:24576
    v_cvt_pk_bf16_f32 v183, v238, v239
    v_mfma_f32_16x16x32_bf16 v[116:119], a[84:87], v[172:175], v[116:119]
    s_waitcnt lgkmcnt(5)
    ds_read_b64_tr_b16 a[102:103], v25 offset:26624
    buffer_load_dwordx4 v44, s[48:51], s12 offen offset:2048 lds
    v_mfma_f32_16x16x32_bf16 v[104:107], a[88:91], v[168:171], v[104:107]
    ds_read_b64_tr_b16 a[104:105], v26 offset:24576
    v_cvt_pk_bf16_f32 v184, v240, v241
    v_mfma_f32_16x16x32_bf16 v[120:123], a[88:91], v[172:175], v[120:123]
    s_waitcnt lgkmcnt(5)
    ds_read_b64_tr_b16 a[106:107], v26 offset:26624
    v_cvt_pk_bf16_f32 v185, v242, v243
    v_mfma_f32_16x16x32_bf16 v[108:111], a[92:95], v[168:171], v[108:111]
    ds_read_b64_tr_b16 a[108:109], v27 offset:24576
    v_cvt_pk_bf16_f32 v186, v248, v249
    v_mfma_f32_16x16x32_bf16 v[124:127], a[92:95], v[172:175], v[124:127]
    s_waitcnt lgkmcnt(5)
    ds_read_b64_tr_b16 a[110:111], v27 offset:26624
    v_cvt_pk_bf16_f32 v187, v250, v251
    v_mfma_f32_16x16x32_bf16 v[96:99], a[96:99], v[176:179], v[96:99]
    ds_read_b64_tr_b16 a[112:113], v24 offset:28672
    v_cvt_pk_bf16_f32 v188, v244, v245
    v_cvt_pk_bf16_f32 v189, v246, v247
    v_mfma_f32_16x16x32_bf16 v[112:115], a[96:99], v[180:183], v[112:115]
    s_waitcnt lgkmcnt(5)
    ds_read_b64_tr_b16 a[114:115], v24 offset:30720
    v_cvt_pk_bf16_f32 v190, v252, v253
    v_cvt_pk_bf16_f32 v191, v254, v255
    v_mfma_f32_16x16x32_bf16 v[100:103], a[100:103], v[176:179], v[100:103]
    ds_read_b64_tr_b16 a[116:117], v25 offset:28672
    v_mfma_f32_16x16x32_bf16 v[116:119], a[100:103], v[180:183], v[116:119]
    s_waitcnt lgkmcnt(5)
    ds_read_b64_tr_b16 a[118:119], v25 offset:30720
    buffer_load_dwordx4 v45, s[48:51], s12 offen offset:3072 lds
    v_mfma_f32_16x16x32_bf16 v[104:107], a[104:107], v[176:179], v[104:107]
    ds_read_b64_tr_b16 a[120:121], v26 offset:28672
    v_mfma_f32_16x16x32_bf16 v[120:123], a[104:107], v[180:183], v[120:123]
    s_waitcnt lgkmcnt(5)
    ds_read_b64_tr_b16 a[122:123], v26 offset:30720
    v_mfma_f32_16x16x32_bf16 v[108:111], a[108:111], v[176:179], v[108:111]
    ds_read_b64_tr_b16 a[124:125], v27 offset:28672
    v_mfma_f32_16x16x32_bf16 v[124:127], a[108:111], v[180:183], v[124:127]
    s_waitcnt lgkmcnt(5)
    ds_read_b64_tr_b16 a[126:127], v27 offset:30720
    v_mfma_f32_16x16x32_bf16 v[96:99], a[112:115], v[184:187], v[96:99]
    ds_read_b64_tr_b16 a[64:65], v46 offset:0
    v_mfma_f32_16x16x32_bf16 v[112:115], a[112:115], v[188:191], v[112:115]
    s_waitcnt lgkmcnt(5)
    ds_read_b64_tr_b16 a[66:67], v46 offset:2048
    v_mfma_f32_16x16x32_bf16 v[100:103], a[116:119], v[184:187], v[100:103]
    ds_read_b64_tr_b16 a[68:69], v47 offset:0
    v_mfma_f32_16x16x32_bf16 v[116:119], a[116:119], v[188:191], v[116:119]
    s_waitcnt lgkmcnt(5)
    ds_read_b64_tr_b16 a[70:71], v47 offset:2048
    v_mfma_f32_16x16x32_bf16 v[104:107], a[120:123], v[184:187], v[104:107]
    ds_read_b64_tr_b16 a[72:73], v46 offset:4096
    v_mfma_f32_16x16x32_bf16 v[120:123], a[120:123], v[188:191], v[120:123]
    s_waitcnt lgkmcnt(5)
    ds_read_b64_tr_b16 a[74:75], v46 offset:6144
    v_mfma_f32_16x16x32_bf16 v[108:111], a[124:127], v[184:187], v[108:111]
    ds_read_b64_tr_b16 a[76:77], v47 offset:4096
    v_mfma_f32_16x16x32_bf16 v[124:127], a[124:127], v[188:191], v[124:127]
    s_waitcnt lgkmcnt(5)
    ds_read_b64_tr_b16 a[78:79], v47 offset:6144
    v_mfma_f32_16x16x32_bf16 v[192:195], a[64:67], v[128:131], 0
    ds_read_b64_tr_b16 a[80:81], v46 offset:8192
    v_mfma_f32_16x16x32_bf16 v[208:211], a[64:67], v[132:135], 0
    s_waitcnt lgkmcnt(5)
    ds_read_b64_tr_b16 a[82:83], v46 offset:10240
    v_mfma_f32_16x16x32_bf16 v[196:199], a[68:71], v[128:131], 0
    ds_read_b64_tr_b16 a[84:85], v47 offset:8192
    v_mfma_f32_16x16x32_bf16 v[212:215], a[68:71], v[132:135], 0
    s_waitcnt lgkmcnt(5)
    ds_read_b64_tr_b16 a[86:87], v47 offset:10240
    v_mfma_f32_16x16x32_bf16 v[192:195], a[72:75], v[136:139], v[192:195]
    ds_read_b64_tr_b16 a[88:89], v46 offset:12288
    v_cvt_pk_bf16_f32 v80, v96, v97
    v_mfma_f32_16x16x32_bf16 v[208:211], a[72:75], v[140:143], v[208:211]
    s_waitcnt lgkmcnt(5)
    ds_read_b64_tr_b16 a[90:91], v46 offset:14336
    v_cvt_pk_bf16_f32 v81, v98, v99
    v_mfma_f32_16x16x32_bf16 v[196:199], a[76:79], v[136:139], v[196:199]
    ds_read_b64_tr_b16 a[92:93], v47 offset:12288
    v_cvt_pk_bf16_f32 v82, v100, v101
    v_mfma_f32_16x16x32_bf16 v[212:215], a[76:79], v[140:143], v[212:215]
    s_waitcnt lgkmcnt(5)
    ds_read_b64_tr_b16 a[94:95], v47 offset:14336
    v_cvt_pk_bf16_f32 v83, v102, v103
    v_mfma_f32_16x16x32_bf16 v[192:195], a[80:83], v[144:147], v[192:195]
    ds_read_b64_tr_b16 a[96:97], v46 offset:16384
    buffer_store_dwordx4 v[80:83], v50, s[52:55], s18 offen offset:0 sc1
    v_mfma_f32_16x16x32_bf16 v[208:211], a[80:83], v[148:151], v[208:211]
    s_waitcnt lgkmcnt(5)
    ds_read_b64_tr_b16 a[98:99], v46 offset:18432
    v_cvt_pk_bf16_f32 v88, v112, v113
    v_mfma_f32_16x16x32_bf16 v[196:199], a[84:87], v[144:147], v[196:199]
    ds_read_b64_tr_b16 a[100:101], v47 offset:16384
    v_cvt_pk_bf16_f32 v89, v114, v115
    v_mfma_f32_16x16x32_bf16 v[212:215], a[84:87], v[148:151], v[212:215]
    s_waitcnt lgkmcnt(5)
    ds_read_b64_tr_b16 a[102:103], v47 offset:18432
    v_cvt_pk_bf16_f32 v90, v116, v117
    v_mfma_f32_16x16x32_bf16 v[192:195], a[88:91], v[152:155], v[192:195]
    ds_read_b64_tr_b16 a[104:105], v46 offset:20480
    v_mfma_f32_16x16x32_bf16 v[208:211], a[88:91], v[156:159], v[208:211]
    s_waitcnt lgkmcnt(5)
    ds_read_b64_tr_b16 a[106:107], v46 offset:22528
    v_cvt_pk_bf16_f32 v91, v118, v119
    v_mfma_f32_16x16x32_bf16 v[196:199], a[92:95], v[152:155], v[196:199]
    ds_read_b64_tr_b16 a[108:109], v47 offset:20480
    buffer_store_dwordx4 v[88:91], v50, s[52:55], s18 offen offset:2048 sc1
    v_mfma_f32_16x16x32_bf16 v[212:215], a[92:95], v[156:159], v[212:215]
    s_waitcnt lgkmcnt(5)
    ds_read_b64_tr_b16 a[110:111], v47 offset:22528
    v_cvt_pk_bf16_f32 v84, v104, v105
    v_mfma_f32_16x16x32_bf16 v[192:195], a[96:99], v[160:163], v[192:195]
    ds_read_b64_tr_b16 a[112:113], v46 offset:24576
    v_cvt_pk_bf16_f32 v85, v106, v107
    v_mfma_f32_16x16x32_bf16 v[208:211], a[96:99], v[164:167], v[208:211]
    s_waitcnt lgkmcnt(5)
    ds_read_b64_tr_b16 a[114:115], v46 offset:26624
    v_cvt_pk_bf16_f32 v86, v108, v109
    v_mfma_f32_16x16x32_bf16 v[196:199], a[100:103], v[160:163], v[196:199]
    ds_read_b64_tr_b16 a[116:117], v47 offset:24576
    v_cvt_pk_bf16_f32 v87, v110, v111
    v_mfma_f32_16x16x32_bf16 v[212:215], a[100:103], v[164:167], v[212:215]
    s_waitcnt lgkmcnt(5)
    ds_read_b64_tr_b16 a[118:119], v47 offset:26624
    v_cvt_pk_bf16_f32 v92, v120, v121
    v_mfma_f32_16x16x32_bf16 v[192:195], a[104:107], v[168:171], v[192:195]
    ds_read_b64_tr_b16 a[120:121], v46 offset:28672
    buffer_store_dwordx4 v[84:87], v50, s[52:55], s18 offen offset:1024 sc1
    v_mfma_f32_16x16x32_bf16 v[208:211], a[104:107], v[172:175], v[208:211]
    s_waitcnt lgkmcnt(5)
    ds_read_b64_tr_b16 a[122:123], v46 offset:30720
    v_cvt_pk_bf16_f32 v93, v122, v123
    v_mfma_f32_16x16x32_bf16 v[196:199], a[108:111], v[168:171], v[196:199]
    ds_read_b64_tr_b16 a[124:125], v47 offset:28672
    v_cvt_pk_bf16_f32 v94, v124, v125
    v_mfma_f32_16x16x32_bf16 v[212:215], a[108:111], v[172:175], v[212:215]
    s_waitcnt lgkmcnt(5)
    ds_read_b64_tr_b16 a[126:127], v47 offset:30720
    v_cvt_pk_bf16_f32 v95, v126, v127
    v_mfma_f32_16x16x32_bf16 v[192:195], a[112:115], v[176:179], v[192:195]
    s_barrier
    s_add_u32 m0, s60, 114688
    ds_read_b64_tr_b16 a[64:65], v48 offset:0
    v_mfma_f32_16x16x32_bf16 v[208:211], a[112:115], v[180:183], v[208:211]
    s_waitcnt lgkmcnt(5)
    ds_read_b64_tr_b16 a[66:67], v48 offset:2048
    buffer_store_dwordx4 v[92:95], v50, s[52:55], s18 offen offset:3072 sc1
    v_mfma_f32_16x16x32_bf16 v[196:199], a[116:119], v[176:179], v[196:199]
    ds_read_b64_tr_b16 a[68:69], v49 offset:0
    v_mfma_f32_16x16x32_bf16 v[212:215], a[116:119], v[180:183], v[212:215]
    s_waitcnt lgkmcnt(5)
    ds_read_b64_tr_b16 a[70:71], v49 offset:2048
    buffer_load_dwordx4 v42, s[48:51], s13 offen offset:0 lds
    v_mfma_f32_16x16x32_bf16 v[192:195], a[120:123], v[184:187], v[192:195]
    ds_read_b64_tr_b16 a[72:73], v48 offset:4096
    v_mfma_f32_16x16x32_bf16 v[208:211], a[120:123], v[188:191], v[208:211]
    s_waitcnt lgkmcnt(5)
    ds_read_b64_tr_b16 a[74:75], v48 offset:6144
    v_mfma_f32_16x16x32_bf16 v[196:199], a[124:127], v[184:187], v[196:199]
    ds_read_b64_tr_b16 a[76:77], v49 offset:4096
    v_mfma_f32_16x16x32_bf16 v[212:215], a[124:127], v[188:191], v[212:215]
    s_waitcnt lgkmcnt(5)
    ds_read_b64_tr_b16 a[78:79], v49 offset:6144
    v_mfma_f32_16x16x32_bf16 v[200:203], a[64:67], v[128:131], 0
    ds_read_b64_tr_b16 a[80:81], v48 offset:8192
    v_mfma_f32_16x16x32_bf16 v[216:219], a[64:67], v[132:135], 0
    s_waitcnt lgkmcnt(5)
    ds_read_b64_tr_b16 a[82:83], v48 offset:10240
    v_mfma_f32_16x16x32_bf16 v[204:207], a[68:71], v[128:131], 0
    ds_read_b64_tr_b16 a[84:85], v49 offset:8192
    v_cvt_pk_bf16_f32 v80, v192, v193
    v_mfma_f32_16x16x32_bf16 v[220:223], a[68:71], v[132:135], 0
    s_waitcnt lgkmcnt(5)
    ds_read_b64_tr_b16 a[86:87], v49 offset:10240
    buffer_load_dwordx4 v43, s[48:51], s13 offen offset:1024 lds
    v_mfma_f32_16x16x32_bf16 v[200:203], a[72:75], v[136:139], v[200:203]
    ds_read_b64_tr_b16 a[88:89], v48 offset:12288
    v_mfma_f32_16x16x32_bf16 v[216:219], a[72:75], v[140:143], v[216:219]
    s_waitcnt lgkmcnt(5)
    ds_read_b64_tr_b16 a[90:91], v48 offset:14336
    v_cvt_pk_bf16_f32 v81, v194, v195
    v_mfma_f32_16x16x32_bf16 v[204:207], a[76:79], v[136:139], v[204:207]
    ds_read_b64_tr_b16 a[92:93], v49 offset:12288
    v_mfma_f32_16x16x32_bf16 v[220:223], a[76:79], v[140:143], v[220:223]
    s_waitcnt lgkmcnt(5)
    ds_read_b64_tr_b16 a[94:95], v49 offset:14336
    v_mfma_f32_16x16x32_bf16 v[200:203], a[80:83], v[144:147], v[200:203]
    ds_read_b64_tr_b16 a[96:97], v48 offset:16384
    v_mfma_f32_16x16x32_bf16 v[216:219], a[80:83], v[148:151], v[216:219]
    s_waitcnt lgkmcnt(5)
    ds_read_b64_tr_b16 a[98:99], v48 offset:18432
    v_cvt_pk_bf16_f32 v82, v196, v197
    v_mfma_f32_16x16x32_bf16 v[204:207], a[84:87], v[144:147], v[204:207]
    ds_read_b64_tr_b16 a[100:101], v49 offset:16384
    v_cvt_pk_bf16_f32 v83, v198, v199
    v_mfma_f32_16x16x32_bf16 v[220:223], a[84:87], v[148:151], v[220:223]
    s_waitcnt lgkmcnt(5)
    ds_read_b64_tr_b16 a[102:103], v49 offset:18432
    buffer_load_dwordx4 v44, s[48:51], s13 offen offset:2048 lds
    v_mfma_f32_16x16x32_bf16 v[200:203], a[88:91], v[152:155], v[200:203]
    ds_read_b64_tr_b16 a[104:105], v48 offset:20480
    v_mfma_f32_16x16x32_bf16 v[216:219], a[88:91], v[156:159], v[216:219]
    s_waitcnt lgkmcnt(5)
    ds_read_b64_tr_b16 a[106:107], v48 offset:22528
    v_mfma_f32_16x16x32_bf16 v[204:207], a[92:95], v[152:155], v[204:207]
    ds_read_b64_tr_b16 a[108:109], v49 offset:20480
    v_mfma_f32_16x16x32_bf16 v[220:223], a[92:95], v[156:159], v[220:223]
    s_waitcnt lgkmcnt(5)
    ds_read_b64_tr_b16 a[110:111], v49 offset:22528
    buffer_store_dwordx4 v[80:83], v50, s[52:55], s19 offen offset:0 sc1
    v_mfma_f32_16x16x32_bf16 v[200:203], a[96:99], v[160:163], v[200:203]
    ds_read_b64_tr_b16 a[112:113], v48 offset:24576
    v_mfma_f32_16x16x32_bf16 v[216:219], a[96:99], v[164:167], v[216:219]
    s_waitcnt lgkmcnt(5)
    ds_read_b64_tr_b16 a[114:115], v48 offset:26624
    v_cvt_pk_bf16_f32 v88, v208, v209
    v_mfma_f32_16x16x32_bf16 v[204:207], a[100:103], v[160:163], v[204:207]
    ds_read_b64_tr_b16 a[116:117], v49 offset:24576
    v_mfma_f32_16x16x32_bf16 v[220:223], a[100:103], v[164:167], v[220:223]
    s_waitcnt lgkmcnt(5)
    ds_read_b64_tr_b16 a[118:119], v49 offset:26624
    buffer_load_dwordx4 v45, s[48:51], s13 offen offset:3072 lds
    v_mfma_f32_16x16x32_bf16 v[200:203], a[104:107], v[168:171], v[200:203]
    ds_read_b64_tr_b16 a[120:121], v48 offset:28672
    v_mfma_f32_16x16x32_bf16 v[216:219], a[104:107], v[172:175], v[216:219]
    s_waitcnt lgkmcnt(5)
    ds_read_b64_tr_b16 a[122:123], v48 offset:30720
    v_cvt_pk_bf16_f32 v89, v210, v211
    v_mfma_f32_16x16x32_bf16 v[204:207], a[108:111], v[168:171], v[204:207]
    ds_read_b64_tr_b16 a[124:125], v49 offset:28672
    v_mfma_f32_16x16x32_bf16 v[220:223], a[108:111], v[172:175], v[220:223]
    s_waitcnt lgkmcnt(5)
    ds_read_b64_tr_b16 a[126:127], v49 offset:30720
    v_cvt_pk_bf16_f32 v90, v212, v213
    v_mfma_f32_16x16x32_bf16 v[200:203], a[112:115], v[176:179], v[200:203]
    s_add_u32 m0, s60, 131072
    ds_read_b64_tr_b16 a[64:65], v46 offset:32768
    v_mfma_f32_16x16x32_bf16 v[216:219], a[112:115], v[180:183], v[216:219]
    s_waitcnt lgkmcnt(5)
    ds_read_b64_tr_b16 a[66:67], v46 offset:34816
    v_cvt_pk_bf16_f32 v91, v214, v215
    v_mfma_f32_16x16x32_bf16 v[204:207], a[116:119], v[176:179], v[204:207]
    ds_read_b64_tr_b16 a[68:69], v47 offset:32768
    v_mfma_f32_16x16x32_bf16 v[220:223], a[116:119], v[180:183], v[220:223]
    s_waitcnt lgkmcnt(5)
    ds_read_b64_tr_b16 a[70:71], v47 offset:34816
    buffer_load_dwordx4 v42, s[48:51], s14 offen offset:0 lds
    v_mfma_f32_16x16x32_bf16 v[200:203], a[120:123], v[184:187], v[200:203]
    ds_read_b64_tr_b16 a[72:73], v46 offset:36864
    v_mfma_f32_16x16x32_bf16 v[216:219], a[120:123], v[188:191], v[216:219]
    s_waitcnt lgkmcnt(5)
    ds_read_b64_tr_b16 a[74:75], v46 offset:38912
    buffer_store_dwordx4 v[88:91], v50, s[52:55], s19 offen offset:2048 sc1
    v_mfma_f32_16x16x32_bf16 v[204:207], a[124:127], v[184:187], v[204:207]
    ds_read_b64_tr_b16 a[76:77], v47 offset:36864
    v_mfma_f32_16x16x32_bf16 v[220:223], a[124:127], v[188:191], v[220:223]
    s_waitcnt lgkmcnt(5)
    ds_read_b64_tr_b16 a[78:79], v47 offset:38912
    v_mfma_f32_16x16x32_bf16 v[96:99], a[64:67], v[128:131], 0
    ds_read_b64_tr_b16 a[80:81], v46 offset:40960
    v_mfma_f32_16x16x32_bf16 v[112:115], a[64:67], v[132:135], 0
    s_waitcnt lgkmcnt(5)
    ds_read_b64_tr_b16 a[82:83], v46 offset:43008
    v_mfma_f32_16x16x32_bf16 v[100:103], a[68:71], v[128:131], 0
    ds_read_b64_tr_b16 a[84:85], v47 offset:40960
    v_cvt_pk_bf16_f32 v84, v200, v201
    v_mfma_f32_16x16x32_bf16 v[116:119], a[68:71], v[132:135], 0
    s_waitcnt lgkmcnt(5)
    ds_read_b64_tr_b16 a[86:87], v47 offset:43008
    buffer_load_dwordx4 v43, s[48:51], s14 offen offset:1024 lds
    v_mfma_f32_16x16x32_bf16 v[96:99], a[72:75], v[136:139], v[96:99]
    ds_read_b64_tr_b16 a[88:89], v46 offset:45056
    v_mfma_f32_16x16x32_bf16 v[112:115], a[72:75], v[140:143], v[112:115]
    s_waitcnt lgkmcnt(5)
    ds_read_b64_tr_b16 a[90:91], v46 offset:47104
    v_cvt_pk_bf16_f32 v85, v202, v203
    v_mfma_f32_16x16x32_bf16 v[100:103], a[76:79], v[136:139], v[100:103]
    ds_read_b64_tr_b16 a[92:93], v47 offset:45056
    v_mfma_f32_16x16x32_bf16 v[116:119], a[76:79], v[140:143], v[116:119]
    s_waitcnt lgkmcnt(5)
    ds_read_b64_tr_b16 a[94:95], v47 offset:47104
    v_mfma_f32_16x16x32_bf16 v[96:99], a[80:83], v[144:147], v[96:99]
    ds_read_b64_tr_b16 a[96:97], v20 offset:0
    v_mfma_f32_16x16x32_bf16 v[112:115], a[80:83], v[148:151], v[112:115]
    s_waitcnt lgkmcnt(5)
    ds_read_b64_tr_b16 a[98:99], v20 offset:2048
    v_cvt_pk_bf16_f32 v86, v204, v205
    v_mfma_f32_16x16x32_bf16 v[100:103], a[84:87], v[144:147], v[100:103]
    ds_read_b64_tr_b16 a[100:101], v21 offset:0
    v_cvt_pk_bf16_f32 v87, v206, v207
    v_mfma_f32_16x16x32_bf16 v[116:119], a[84:87], v[148:151], v[116:119]
    s_waitcnt lgkmcnt(5)
    ds_read_b64_tr_b16 a[102:103], v21 offset:2048
    buffer_load_dwordx4 v44, s[48:51], s14 offen offset:2048 lds
    v_mfma_f32_16x16x32_bf16 v[96:99], a[88:91], v[152:155], v[96:99]
    ds_read_b64_tr_b16 a[104:105], v20 offset:4096
    v_mfma_f32_16x16x32_bf16 v[112:115], a[88:91], v[156:159], v[112:115]
    s_waitcnt lgkmcnt(5)
    ds_read_b64_tr_b16 a[106:107], v20 offset:6144
    v_mfma_f32_16x16x32_bf16 v[100:103], a[92:95], v[152:155], v[100:103]
    ds_read_b64_tr_b16 a[108:109], v21 offset:4096
    v_mfma_f32_16x16x32_bf16 v[116:119], a[92:95], v[156:159], v[116:119]
    s_waitcnt lgkmcnt(5)
    ds_read_b64_tr_b16 a[110:111], v21 offset:6144
    buffer_store_dwordx4 v[84:87], v50, s[52:55], s19 offen offset:1024 sc1
    v_mfma_f32_16x16x32_bf16 v[96:99], a[96:99], v[160:163], v[96:99]
    ds_read_b64_tr_b16 a[112:113], v20 offset:8192
    v_mfma_f32_16x16x32_bf16 v[112:115], a[96:99], v[164:167], v[112:115]
    s_waitcnt lgkmcnt(5)
    ds_read_b64_tr_b16 a[114:115], v20 offset:10240
    v_cvt_pk_bf16_f32 v92, v216, v217
    v_mfma_f32_16x16x32_bf16 v[100:103], a[100:103], v[160:163], v[100:103]
    ds_read_b64_tr_b16 a[116:117], v21 offset:8192
    v_mfma_f32_16x16x32_bf16 v[116:119], a[100:103], v[164:167], v[116:119]
    s_waitcnt lgkmcnt(5)
    ds_read_b64_tr_b16 a[118:119], v21 offset:10240
    buffer_load_dwordx4 v45, s[48:51], s14 offen offset:3072 lds
    v_mfma_f32_16x16x32_bf16 v[96:99], a[104:107], v[168:171], v[96:99]
    ds_read_b64_tr_b16 a[120:121], v20 offset:12288
    v_mfma_f32_16x16x32_bf16 v[112:115], a[104:107], v[172:175], v[112:115]
    s_waitcnt lgkmcnt(5)
    ds_read_b64_tr_b16 a[122:123], v20 offset:14336
    v_cvt_pk_bf16_f32 v93, v218, v219
    v_mfma_f32_16x16x32_bf16 v[100:103], a[108:111], v[168:171], v[100:103]
    ds_read_b64_tr_b16 a[124:125], v21 offset:12288
    v_mfma_f32_16x16x32_bf16 v[116:119], a[108:111], v[172:175], v[116:119]
    s_waitcnt lgkmcnt(5)
    ds_read_b64_tr_b16 a[126:127], v21 offset:14336
    v_cvt_pk_bf16_f32 v94, v220, v221
    v_mfma_f32_16x16x32_bf16 v[96:99], a[112:115], v[176:179], v[96:99]
    s_add_u32 m0, s60, 147456
    ds_read_b64_tr_b16 a[64:65], v48 offset:32768
    v_mfma_f32_16x16x32_bf16 v[112:115], a[112:115], v[180:183], v[112:115]
    s_waitcnt lgkmcnt(5)
    ds_read_b64_tr_b16 a[66:67], v48 offset:34816
    v_cvt_pk_bf16_f32 v95, v222, v223
    v_mfma_f32_16x16x32_bf16 v[100:103], a[116:119], v[176:179], v[100:103]
    ds_read_b64_tr_b16 a[68:69], v49 offset:32768
    v_mfma_f32_16x16x32_bf16 v[116:119], a[116:119], v[180:183], v[116:119]
    s_waitcnt lgkmcnt(5)
    ds_read_b64_tr_b16 a[70:71], v49 offset:34816
    buffer_load_dwordx4 v42, s[48:51], s15 offen offset:0 lds
    v_mfma_f32_16x16x32_bf16 v[96:99], a[120:123], v[184:187], v[96:99]
    ds_read_b64_tr_b16 a[72:73], v48 offset:36864
    v_mfma_f32_16x16x32_bf16 v[112:115], a[120:123], v[188:191], v[112:115]
    s_waitcnt lgkmcnt(5)
    ds_read_b64_tr_b16 a[74:75], v48 offset:38912
    buffer_store_dwordx4 v[92:95], v50, s[52:55], s19 offen offset:3072 sc1
    v_mfma_f32_16x16x32_bf16 v[100:103], a[124:127], v[184:187], v[100:103]
    ds_read_b64_tr_b16 a[76:77], v49 offset:36864
    v_mfma_f32_16x16x32_bf16 v[116:119], a[124:127], v[188:191], v[116:119]
    s_waitcnt lgkmcnt(5)
    ds_read_b64_tr_b16 a[78:79], v49 offset:38912
    v_mfma_f32_16x16x32_bf16 v[104:107], a[64:67], v[128:131], 0
    ds_read_b64_tr_b16 a[80:81], v48 offset:40960
    v_mfma_f32_16x16x32_bf16 v[120:123], a[64:67], v[132:135], 0
    s_waitcnt lgkmcnt(5)
    ds_read_b64_tr_b16 a[82:83], v48 offset:43008
    v_mfma_f32_16x16x32_bf16 v[108:111], a[68:71], v[128:131], 0
    ds_read_b64_tr_b16 a[84:85], v49 offset:40960
    v_cvt_pk_bf16_f32 v80, v96, v97
    v_mfma_f32_16x16x32_bf16 v[124:127], a[68:71], v[132:135], 0
    s_waitcnt lgkmcnt(5)
    ds_read_b64_tr_b16 a[86:87], v49 offset:43008
    buffer_load_dwordx4 v43, s[48:51], s15 offen offset:1024 lds
    v_mfma_f32_16x16x32_bf16 v[104:107], a[72:75], v[136:139], v[104:107]
    ds_read_b64_tr_b16 a[88:89], v48 offset:45056
    v_mfma_f32_16x16x32_bf16 v[120:123], a[72:75], v[140:143], v[120:123]
    s_waitcnt lgkmcnt(5)
    ds_read_b64_tr_b16 a[90:91], v48 offset:47104
    v_cvt_pk_bf16_f32 v81, v98, v99
    v_mfma_f32_16x16x32_bf16 v[108:111], a[76:79], v[136:139], v[108:111]
    ds_read_b64_tr_b16 a[92:93], v49 offset:45056
    v_mfma_f32_16x16x32_bf16 v[124:127], a[76:79], v[140:143], v[124:127]
    s_waitcnt lgkmcnt(5)
    ds_read_b64_tr_b16 a[94:95], v49 offset:47104
    v_cvt_pk_bf16_f32 v82, v100, v101
    v_mfma_f32_16x16x32_bf16 v[104:107], a[80:83], v[144:147], v[104:107]
    ds_read_b64_tr_b16 a[96:97], v22 offset:0
    v_mfma_f32_16x16x32_bf16 v[120:123], a[80:83], v[148:151], v[120:123]
    s_waitcnt lgkmcnt(5)
    ds_read_b64_tr_b16 a[98:99], v22 offset:2048
    v_mfma_f32_16x16x32_bf16 v[108:111], a[84:87], v[144:147], v[108:111]
    ds_read_b64_tr_b16 a[100:101], v23 offset:0
    v_cvt_pk_bf16_f32 v83, v102, v103
    v_mfma_f32_16x16x32_bf16 v[124:127], a[84:87], v[148:151], v[124:127]
    s_waitcnt lgkmcnt(5)
    ds_read_b64_tr_b16 a[102:103], v23 offset:2048
    buffer_load_dwordx4 v44, s[48:51], s15 offen offset:2048 lds
    v_mfma_f32_16x16x32_bf16 v[104:107], a[88:91], v[152:155], v[104:107]
    ds_read_b64_tr_b16 a[104:105], v22 offset:4096
    v_mfma_f32_16x16x32_bf16 v[120:123], a[88:91], v[156:159], v[120:123]
    s_waitcnt lgkmcnt(5)
    ds_read_b64_tr_b16 a[106:107], v22 offset:6144
    buffer_store_dwordx4 v[80:83], v50, s[52:55], s20 offen offset:0 sc1
    v_mfma_f32_16x16x32_bf16 v[108:111], a[92:95], v[152:155], v[108:111]
    ds_read_b64_tr_b16 a[108:109], v23 offset:4096
    v_mfma_f32_16x16x32_bf16 v[124:127], a[92:95], v[156:159], v[124:127]
    s_waitcnt lgkmcnt(5)
    ds_read_b64_tr_b16 a[110:111], v23 offset:6144
    v_mfma_f32_16x16x32_bf16 v[104:107], a[96:99], v[160:163], v[104:107]
    ds_read_b64_tr_b16 a[112:113], v22 offset:8192
    v_mfma_f32_16x16x32_bf16 v[120:123], a[96:99], v[164:167], v[120:123]
    s_waitcnt lgkmcnt(5)
    ds_read_b64_tr_b16 a[114:115], v22 offset:10240
    v_cvt_pk_bf16_f32 v88, v112, v113
    v_mfma_f32_16x16x32_bf16 v[108:111], a[100:103], v[160:163], v[108:111]
    ds_read_b64_tr_b16 a[116:117], v23 offset:8192
    v_cvt_pk_bf16_f32 v89, v114, v115
    v_mfma_f32_16x16x32_bf16 v[124:127], a[100:103], v[164:167], v[124:127]
    s_waitcnt lgkmcnt(5)
    ds_read_b64_tr_b16 a[118:119], v23 offset:10240
    buffer_load_dwordx4 v45, s[48:51], s15 offen offset:3072 lds
    v_mfma_f32_16x16x32_bf16 v[104:107], a[104:107], v[168:171], v[104:107]
    ds_read_b64_tr_b16 a[120:121], v22 offset:12288
    v_mfma_f32_16x16x32_bf16 v[120:123], a[104:107], v[172:175], v[120:123]
    s_waitcnt lgkmcnt(5)
    ds_read_b64_tr_b16 a[122:123], v22 offset:14336
    v_mfma_f32_16x16x32_bf16 v[108:111], a[108:111], v[168:171], v[108:111]
    ds_read_b64_tr_b16 a[124:125], v23 offset:12288
    v_mfma_f32_16x16x32_bf16 v[124:127], a[108:111], v[172:175], v[124:127]
    s_waitcnt vmcnt(12) lgkmcnt(5)
    ds_read_b64_tr_b16 a[126:127], v23 offset:14336
    v_cvt_pk_bf16_f32 v90, v116, v117
    v_mfma_f32_16x16x32_bf16 v[104:107], a[112:115], v[176:179], v[104:107]
    s_barrier
    s_add_u32 m0, s60, 0
    ds_read_b64_tr_b16 a[64:65], v46 offset:49152
    v_mfma_f32_16x16x32_bf16 v[120:123], a[112:115], v[180:183], v[120:123]
    s_waitcnt lgkmcnt(5)
    ds_read_b64_tr_b16 a[66:67], v46 offset:51200
    v_cvt_pk_bf16_f32 v91, v118, v119
    v_mfma_f32_16x16x32_bf16 v[108:111], a[116:119], v[176:179], v[108:111]
    ds_read_b64_tr_b16 a[68:69], v47 offset:49152
    v_mfma_f32_16x16x32_bf16 v[124:127], a[116:119], v[180:183], v[124:127]
    s_waitcnt lgkmcnt(5)
    ds_read_b64_tr_b16 a[70:71], v47 offset:51200
    buffer_load_dwordx4 v42, s[48:51], s16 offen offset:0 lds
    v_mfma_f32_16x16x32_bf16 v[104:107], a[120:123], v[184:187], v[104:107]
    ds_read_b64_tr_b16 a[72:73], v46 offset:53248
    v_mfma_f32_16x16x32_bf16 v[120:123], a[120:123], v[188:191], v[120:123]
    s_waitcnt lgkmcnt(5)
    ds_read_b64_tr_b16 a[74:75], v46 offset:55296
    buffer_store_dwordx4 v[88:91], v50, s[52:55], s20 offen offset:2048 sc1
    v_mfma_f32_16x16x32_bf16 v[108:111], a[124:127], v[184:187], v[108:111]
    ds_read_b64_tr_b16 a[76:77], v47 offset:53248
    v_mfma_f32_16x16x32_bf16 v[124:127], a[124:127], v[188:191], v[124:127]
    s_waitcnt lgkmcnt(5)
    ds_read_b64_tr_b16 a[78:79], v47 offset:55296
    v_mfma_f32_16x16x32_bf16 v[192:195], a[64:67], v[128:131], 0
    ds_read_b64_tr_b16 a[80:81], v46 offset:57344
    v_mfma_f32_16x16x32_bf16 v[208:211], a[64:67], v[132:135], 0
    s_waitcnt lgkmcnt(5)
    ds_read_b64_tr_b16 a[82:83], v46 offset:59392
    v_mfma_f32_16x16x32_bf16 v[196:199], a[68:71], v[128:131], 0
    ds_read_b64_tr_b16 a[84:85], v47 offset:57344
    v_cvt_pk_bf16_f32 v84, v104, v105
    v_mfma_f32_16x16x32_bf16 v[212:215], a[68:71], v[132:135], 0
    s_waitcnt lgkmcnt(5)
    ds_read_b64_tr_b16 a[86:87], v47 offset:59392
    buffer_load_dwordx4 v43, s[48:51], s16 offen offset:1024 lds
    v_mfma_f32_16x16x32_bf16 v[192:195], a[72:75], v[136:139], v[192:195]
    ds_read_b64_tr_b16 a[88:89], v46 offset:61440
    v_mfma_f32_16x16x32_bf16 v[208:211], a[72:75], v[140:143], v[208:211]
    s_waitcnt lgkmcnt(5)
    ds_read_b64_tr_b16 a[90:91], v46 offset:63488
    v_cvt_pk_bf16_f32 v85, v106, v107
    v_mfma_f32_16x16x32_bf16 v[196:199], a[76:79], v[136:139], v[196:199]
    ds_read_b64_tr_b16 a[92:93], v47 offset:61440
    v_mfma_f32_16x16x32_bf16 v[212:215], a[76:79], v[140:143], v[212:215]
    s_waitcnt lgkmcnt(5)
    ds_read_b64_tr_b16 a[94:95], v47 offset:63488
    v_mfma_f32_16x16x32_bf16 v[192:195], a[80:83], v[144:147], v[192:195]
    ds_read_b64_tr_b16 a[96:97], v20 offset:16384
    v_mfma_f32_16x16x32_bf16 v[208:211], a[80:83], v[148:151], v[208:211]
    s_waitcnt lgkmcnt(5)
    ds_read_b64_tr_b16 a[98:99], v20 offset:18432
    v_cvt_pk_bf16_f32 v86, v108, v109
    v_mfma_f32_16x16x32_bf16 v[196:199], a[84:87], v[144:147], v[196:199]
    ds_read_b64_tr_b16 a[100:101], v21 offset:16384
    v_cvt_pk_bf16_f32 v87, v110, v111
    v_mfma_f32_16x16x32_bf16 v[212:215], a[84:87], v[148:151], v[212:215]
    s_waitcnt lgkmcnt(5)
    ds_read_b64_tr_b16 a[102:103], v21 offset:18432
    buffer_load_dwordx4 v44, s[48:51], s16 offen offset:2048 lds
    v_mfma_f32_16x16x32_bf16 v[192:195], a[88:91], v[152:155], v[192:195]
    ds_read_b64_tr_b16 a[104:105], v20 offset:20480
    v_mfma_f32_16x16x32_bf16 v[208:211], a[88:91], v[156:159], v[208:211]
    s_waitcnt lgkmcnt(5)
    ds_read_b64_tr_b16 a[106:107], v20 offset:22528
    v_mfma_f32_16x16x32_bf16 v[196:199], a[92:95], v[152:155], v[196:199]
    ds_read_b64_tr_b16 a[108:109], v21 offset:20480
    v_mfma_f32_16x16x32_bf16 v[212:215], a[92:95], v[156:159], v[212:215]
    s_waitcnt lgkmcnt(5)
    ds_read_b64_tr_b16 a[110:111], v21 offset:22528
    buffer_store_dwordx4 v[84:87], v50, s[52:55], s20 offen offset:1024 sc1
    v_mfma_f32_16x16x32_bf16 v[192:195], a[96:99], v[160:163], v[192:195]
    ds_read_b64_tr_b16 a[112:113], v20 offset:24576
    v_mfma_f32_16x16x32_bf16 v[208:211], a[96:99], v[164:167], v[208:211]
    s_waitcnt lgkmcnt(5)
    ds_read_b64_tr_b16 a[114:115], v20 offset:26624
    v_cvt_pk_bf16_f32 v92, v120, v121
    v_mfma_f32_16x16x32_bf16 v[196:199], a[100:103], v[160:163], v[196:199]
    ds_read_b64_tr_b16 a[116:117], v21 offset:24576
    v_mfma_f32_16x16x32_bf16 v[212:215], a[100:103], v[164:167], v[212:215]
    s_waitcnt lgkmcnt(5)
    ds_read_b64_tr_b16 a[118:119], v21 offset:26624
    buffer_load_dwordx4 v45, s[48:51], s16 offen offset:3072 lds
    v_mfma_f32_16x16x32_bf16 v[192:195], a[104:107], v[168:171], v[192:195]
    ds_read_b64_tr_b16 a[120:121], v20 offset:28672
    v_mfma_f32_16x16x32_bf16 v[208:211], a[104:107], v[172:175], v[208:211]
    s_waitcnt lgkmcnt(5)
    ds_read_b64_tr_b16 a[122:123], v20 offset:30720
    v_cvt_pk_bf16_f32 v93, v122, v123
    v_mfma_f32_16x16x32_bf16 v[196:199], a[108:111], v[168:171], v[196:199]
    ds_read_b64_tr_b16 a[124:125], v21 offset:28672
    v_mfma_f32_16x16x32_bf16 v[212:215], a[108:111], v[172:175], v[212:215]
    s_waitcnt lgkmcnt(5)
    ds_read_b64_tr_b16 a[126:127], v21 offset:30720
    v_cvt_pk_bf16_f32 v94, v124, v125
    v_mfma_f32_16x16x32_bf16 v[192:195], a[112:115], v[176:179], v[192:195]
    s_add_u32 m0, s60, 16384
    ds_read_b64_tr_b16 a[64:65], v48 offset:49152
    v_mfma_f32_16x16x32_bf16 v[208:211], a[112:115], v[180:183], v[208:211]
    s_waitcnt lgkmcnt(5)
    ds_read_b64_tr_b16 a[66:67], v48 offset:51200
    v_cvt_pk_bf16_f32 v95, v126, v127
    v_mfma_f32_16x16x32_bf16 v[196:199], a[116:119], v[176:179], v[196:199]
    ds_read_b64_tr_b16 a[68:69], v49 offset:49152
    v_mfma_f32_16x16x32_bf16 v[212:215], a[116:119], v[180:183], v[212:215]
    s_waitcnt lgkmcnt(5)
    ds_read_b64_tr_b16 a[70:71], v49 offset:51200
    buffer_load_dwordx4 v42, s[48:51], s17 offen offset:0 lds
    v_mfma_f32_16x16x32_bf16 v[192:195], a[120:123], v[184:187], v[192:195]
    ds_read_b64_tr_b16 a[72:73], v48 offset:53248
    v_mfma_f32_16x16x32_bf16 v[208:211], a[120:123], v[188:191], v[208:211]
    s_waitcnt lgkmcnt(5)
    ds_read_b64_tr_b16 a[74:75], v48 offset:55296
    buffer_store_dwordx4 v[92:95], v50, s[52:55], s20 offen offset:3072 sc1
    v_mfma_f32_16x16x32_bf16 v[196:199], a[124:127], v[184:187], v[196:199]
    ds_read_b64_tr_b16 a[76:77], v49 offset:53248
    v_mfma_f32_16x16x32_bf16 v[212:215], a[124:127], v[188:191], v[212:215]
    s_waitcnt lgkmcnt(5)
    ds_read_b64_tr_b16 a[78:79], v49 offset:55296
    v_mfma_f32_16x16x32_bf16 v[200:203], a[64:67], v[128:131], 0
    ds_read_b64_tr_b16 a[80:81], v48 offset:57344
    v_mfma_f32_16x16x32_bf16 v[216:219], a[64:67], v[132:135], 0
    s_waitcnt lgkmcnt(5)
    ds_read_b64_tr_b16 a[82:83], v48 offset:59392
    v_mfma_f32_16x16x32_bf16 v[204:207], a[68:71], v[128:131], 0
    ds_read_b64_tr_b16 a[84:85], v49 offset:57344
    v_cvt_pk_bf16_f32 v80, v192, v193
    v_mfma_f32_16x16x32_bf16 v[220:223], a[68:71], v[132:135], 0
    s_waitcnt lgkmcnt(5)
    ds_read_b64_tr_b16 a[86:87], v49 offset:59392
    buffer_load_dwordx4 v43, s[48:51], s17 offen offset:1024 lds
    v_mfma_f32_16x16x32_bf16 v[200:203], a[72:75], v[136:139], v[200:203]
    ds_read_b64_tr_b16 a[88:89], v48 offset:61440
    v_mfma_f32_16x16x32_bf16 v[216:219], a[72:75], v[140:143], v[216:219]
    s_waitcnt lgkmcnt(5)
    ds_read_b64_tr_b16 a[90:91], v48 offset:63488
    v_cvt_pk_bf16_f32 v81, v194, v195
    v_mfma_f32_16x16x32_bf16 v[204:207], a[76:79], v[136:139], v[204:207]
    ds_read_b64_tr_b16 a[92:93], v49 offset:61440
    v_mfma_f32_16x16x32_bf16 v[220:223], a[76:79], v[140:143], v[220:223]
    s_waitcnt lgkmcnt(5)
    ds_read_b64_tr_b16 a[94:95], v49 offset:63488
    v_mfma_f32_16x16x32_bf16 v[200:203], a[80:83], v[144:147], v[200:203]
    ds_read_b64_tr_b16 a[96:97], v22 offset:16384
    v_mfma_f32_16x16x32_bf16 v[216:219], a[80:83], v[148:151], v[216:219]
    s_waitcnt lgkmcnt(5)
    ds_read_b64_tr_b16 a[98:99], v22 offset:18432
    v_cvt_pk_bf16_f32 v82, v196, v197
    v_mfma_f32_16x16x32_bf16 v[204:207], a[84:87], v[144:147], v[204:207]
    ds_read_b64_tr_b16 a[100:101], v23 offset:16384
    v_mfma_f32_16x16x32_bf16 v[220:223], a[84:87], v[148:151], v[220:223]
    s_waitcnt lgkmcnt(5)
    ds_read_b64_tr_b16 a[102:103], v23 offset:18432
    buffer_load_dwordx4 v44, s[48:51], s17 offen offset:2048 lds
    v_mfma_f32_16x16x32_bf16 v[200:203], a[88:91], v[152:155], v[200:203]
    ds_read_b64_tr_b16 a[104:105], v22 offset:20480
    v_mfma_f32_16x16x32_bf16 v[216:219], a[88:91], v[156:159], v[216:219]
    s_waitcnt lgkmcnt(5)
    ds_read_b64_tr_b16 a[106:107], v22 offset:22528
    v_cvt_pk_bf16_f32 v83, v198, v199
    v_mfma_f32_16x16x32_bf16 v[204:207], a[92:95], v[152:155], v[204:207]
    ds_read_b64_tr_b16 a[108:109], v23 offset:20480
    v_mfma_f32_16x16x32_bf16 v[220:223], a[92:95], v[156:159], v[220:223]
    s_waitcnt lgkmcnt(5)
    ds_read_b64_tr_b16 a[110:111], v23 offset:22528
    buffer_store_dwordx4 v[80:83], v50, s[52:55], s21 offen offset:0 sc1
    v_mfma_f32_16x16x32_bf16 v[200:203], a[96:99], v[160:163], v[200:203]
    ds_read_b64_tr_b16 a[112:113], v22 offset:24576
    v_mfma_f32_16x16x32_bf16 v[216:219], a[96:99], v[164:167], v[216:219]
    s_waitcnt lgkmcnt(5)
    ds_read_b64_tr_b16 a[114:115], v22 offset:26624
    v_cvt_pk_bf16_f32 v88, v208, v209
    v_mfma_f32_16x16x32_bf16 v[204:207], a[100:103], v[160:163], v[204:207]
    ds_read_b64_tr_b16 a[116:117], v23 offset:24576
    v_mfma_f32_16x16x32_bf16 v[220:223], a[100:103], v[164:167], v[220:223]
    s_waitcnt lgkmcnt(5)
    ds_read_b64_tr_b16 a[118:119], v23 offset:26624
    buffer_load_dwordx4 v45, s[48:51], s17 offen offset:3072 lds
    v_mfma_f32_16x16x32_bf16 v[200:203], a[104:107], v[168:171], v[200:203]
    ds_read_b64_tr_b16 a[120:121], v22 offset:28672
    v_mfma_f32_16x16x32_bf16 v[216:219], a[104:107], v[172:175], v[216:219]
    s_waitcnt lgkmcnt(5)
    ds_read_b64_tr_b16 a[122:123], v22 offset:30720
    v_cvt_pk_bf16_f32 v89, v210, v211
    v_mfma_f32_16x16x32_bf16 v[204:207], a[108:111], v[168:171], v[204:207]
    ds_read_b64_tr_b16 a[124:125], v23 offset:28672
    v_mfma_f32_16x16x32_bf16 v[220:223], a[108:111], v[172:175], v[220:223]
    s_waitcnt lgkmcnt(5)
    ds_read_b64_tr_b16 a[126:127], v23 offset:30720
    v_cvt_pk_bf16_f32 v90, v212, v213
    v_mfma_f32_16x16x32_bf16 v[200:203], a[112:115], v[176:179], v[200:203]
    ds_read_b64_tr_b16 a[64:65], v20 offset:32768
    v_mfma_f32_16x16x32_bf16 v[216:219], a[112:115], v[180:183], v[216:219]
    s_waitcnt lgkmcnt(5)
    ds_read_b64_tr_b16 a[66:67], v20 offset:34816
    v_mfma_f32_16x16x32_bf16 v[204:207], a[116:119], v[176:179], v[204:207]
    ds_read_b64_tr_b16 a[68:69], v21 offset:32768
    v_mfma_f32_16x16x32_bf16 v[220:223], a[116:119], v[180:183], v[220:223]
    s_waitcnt lgkmcnt(5)
    ds_read_b64_tr_b16 a[70:71], v21 offset:34816
    v_cvt_pk_bf16_f32 v91, v214, v215
    v_mfma_f32_16x16x32_bf16 v[200:203], a[120:123], v[184:187], v[200:203]
    ds_read_b64_tr_b16 a[72:73], v20 offset:36864
    v_mfma_f32_16x16x32_bf16 v[216:219], a[120:123], v[188:191], v[216:219]
    s_waitcnt lgkmcnt(5)
    ds_read_b64_tr_b16 a[74:75], v20 offset:38912
    buffer_store_dwordx4 v[88:91], v50, s[52:55], s21 offen offset:2048 sc1
    v_mfma_f32_16x16x32_bf16 v[204:207], a[124:127], v[184:187], v[204:207]
    ds_read_b64_tr_b16 a[76:77], v21 offset:36864
    v_mfma_f32_16x16x32_bf16 v[220:223], a[124:127], v[188:191], v[220:223]
    s_waitcnt lgkmcnt(5)
    ds_read_b64_tr_b16 a[78:79], v21 offset:38912
    v_mfma_f32_16x16x32_bf16 v[96:99], a[64:67], v[128:131], 0
    ds_read_b64_tr_b16 a[80:81], v20 offset:40960
    v_mfma_f32_16x16x32_bf16 v[112:115], a[64:67], v[132:135], 0
    s_waitcnt lgkmcnt(5)
    ds_read_b64_tr_b16 a[82:83], v20 offset:43008
    v_mfma_f32_16x16x32_bf16 v[100:103], a[68:71], v[128:131], 0
    ds_read_b64_tr_b16 a[84:85], v21 offset:40960
    v_mfma_f32_16x16x32_bf16 v[116:119], a[68:71], v[132:135], 0
    s_waitcnt lgkmcnt(5)
    ds_read_b64_tr_b16 a[86:87], v21 offset:43008
    v_cvt_pk_bf16_f32 v84, v200, v201
    v_mfma_f32_16x16x32_bf16 v[96:99], a[72:75], v[136:139], v[96:99]
    ds_read_b64_tr_b16 a[88:89], v20 offset:45056
    v_mfma_f32_16x16x32_bf16 v[112:115], a[72:75], v[140:143], v[112:115]
    s_waitcnt lgkmcnt(5)
    ds_read_b64_tr_b16 a[90:91], v20 offset:47104
    v_cvt_pk_bf16_f32 v85, v202, v203
    v_mfma_f32_16x16x32_bf16 v[100:103], a[76:79], v[136:139], v[100:103]
    ds_read_b64_tr_b16 a[92:93], v21 offset:45056
    v_mfma_f32_16x16x32_bf16 v[116:119], a[76:79], v[140:143], v[116:119]
    s_waitcnt lgkmcnt(5)
    ds_read_b64_tr_b16 a[94:95], v21 offset:47104
    v_cvt_pk_bf16_f32 v86, v204, v205
    v_mfma_f32_16x16x32_bf16 v[96:99], a[80:83], v[144:147], v[96:99]
    ds_read_b64_tr_b16 a[96:97], v20 offset:49152
    v_mfma_f32_16x16x32_bf16 v[112:115], a[80:83], v[148:151], v[112:115]
    s_waitcnt lgkmcnt(5)
    ds_read_b64_tr_b16 a[98:99], v20 offset:51200
    v_mfma_f32_16x16x32_bf16 v[100:103], a[84:87], v[144:147], v[100:103]
    ds_read_b64_tr_b16 a[100:101], v21 offset:49152
    v_mfma_f32_16x16x32_bf16 v[116:119], a[84:87], v[148:151], v[116:119]
    s_waitcnt lgkmcnt(5)
    ds_read_b64_tr_b16 a[102:103], v21 offset:51200
    v_cvt_pk_bf16_f32 v87, v206, v207
    v_mfma_f32_16x16x32_bf16 v[96:99], a[88:91], v[152:155], v[96:99]
    ds_read_b64_tr_b16 a[104:105], v20 offset:53248
    v_mfma_f32_16x16x32_bf16 v[112:115], a[88:91], v[156:159], v[112:115]
    s_waitcnt lgkmcnt(5)
    ds_read_b64_tr_b16 a[106:107], v20 offset:55296
    buffer_store_dwordx4 v[84:87], v50, s[52:55], s21 offen offset:1024 sc1
    v_mfma_f32_16x16x32_bf16 v[100:103], a[92:95], v[152:155], v[100:103]
    ds_read_b64_tr_b16 a[108:109], v21 offset:53248
    v_mfma_f32_16x16x32_bf16 v[116:119], a[92:95], v[156:159], v[116:119]
    s_waitcnt lgkmcnt(5)
    ds_read_b64_tr_b16 a[110:111], v21 offset:55296
    v_mfma_f32_16x16x32_bf16 v[96:99], a[96:99], v[160:163], v[96:99]
    ds_read_b64_tr_b16 a[112:113], v20 offset:57344
    v_mfma_f32_16x16x32_bf16 v[112:115], a[96:99], v[164:167], v[112:115]
    s_waitcnt lgkmcnt(5)
    ds_read_b64_tr_b16 a[114:115], v20 offset:59392
    v_cvt_pk_bf16_f32 v92, v216, v217
    v_mfma_f32_16x16x32_bf16 v[100:103], a[100:103], v[160:163], v[100:103]
    ds_read_b64_tr_b16 a[116:117], v21 offset:57344
    v_mfma_f32_16x16x32_bf16 v[116:119], a[100:103], v[164:167], v[116:119]
    s_waitcnt lgkmcnt(5)
    ds_read_b64_tr_b16 a[118:119], v21 offset:59392
    v_cvt_pk_bf16_f32 v93, v218, v219
    v_mfma_f32_16x16x32_bf16 v[96:99], a[104:107], v[168:171], v[96:99]
    ds_read_b64_tr_b16 a[120:121], v20 offset:61440
    v_mfma_f32_16x16x32_bf16 v[112:115], a[104:107], v[172:175], v[112:115]
    s_waitcnt lgkmcnt(5)
    ds_read_b64_tr_b16 a[122:123], v20 offset:63488
    v_mfma_f32_16x16x32_bf16 v[100:103], a[108:111], v[168:171], v[100:103]
    ds_read_b64_tr_b16 a[124:125], v21 offset:61440
    v_mfma_f32_16x16x32_bf16 v[116:119], a[108:111], v[172:175], v[116:119]
    s_waitcnt lgkmcnt(5)
    ds_read_b64_tr_b16 a[126:127], v21 offset:63488
    v_cvt_pk_bf16_f32 v94, v220, v221
    v_mfma_f32_16x16x32_bf16 v[96:99], a[112:115], v[176:179], v[96:99]
    ds_read_b64_tr_b16 a[64:65], v22 offset:32768
    v_mfma_f32_16x16x32_bf16 v[112:115], a[112:115], v[180:183], v[112:115]
    s_waitcnt lgkmcnt(5)
    ds_read_b64_tr_b16 a[66:67], v22 offset:34816
    v_cvt_pk_bf16_f32 v95, v222, v223
    v_mfma_f32_16x16x32_bf16 v[100:103], a[116:119], v[176:179], v[100:103]
    ds_read_b64_tr_b16 a[68:69], v23 offset:32768
    v_mfma_f32_16x16x32_bf16 v[116:119], a[116:119], v[180:183], v[116:119]
    s_waitcnt lgkmcnt(5)
    ds_read_b64_tr_b16 a[70:71], v23 offset:34816
    v_mfma_f32_16x16x32_bf16 v[96:99], a[120:123], v[184:187], v[96:99]
    ds_read_b64_tr_b16 a[72:73], v22 offset:36864
    v_mfma_f32_16x16x32_bf16 v[112:115], a[120:123], v[188:191], v[112:115]
    s_waitcnt lgkmcnt(5)
    ds_read_b64_tr_b16 a[74:75], v22 offset:38912
    buffer_store_dwordx4 v[92:95], v50, s[52:55], s21 offen offset:3072 sc1
    v_mfma_f32_16x16x32_bf16 v[100:103], a[124:127], v[184:187], v[100:103]
    ds_read_b64_tr_b16 a[76:77], v23 offset:36864
    v_mfma_f32_16x16x32_bf16 v[116:119], a[124:127], v[188:191], v[116:119]
    s_waitcnt lgkmcnt(5)
    ds_read_b64_tr_b16 a[78:79], v23 offset:38912
    v_mfma_f32_16x16x32_bf16 v[104:107], a[64:67], v[128:131], 0
    ds_read_b64_tr_b16 a[80:81], v22 offset:40960
    v_mfma_f32_16x16x32_bf16 v[120:123], a[64:67], v[132:135], 0
    s_waitcnt lgkmcnt(5)
    ds_read_b64_tr_b16 a[82:83], v22 offset:43008
    v_mfma_f32_16x16x32_bf16 v[108:111], a[68:71], v[128:131], 0
    ds_read_b64_tr_b16 a[84:85], v23 offset:40960
    v_mfma_f32_16x16x32_bf16 v[124:127], a[68:71], v[132:135], 0
    s_waitcnt lgkmcnt(5)
    ds_read_b64_tr_b16 a[86:87], v23 offset:43008
    v_cvt_pk_bf16_f32 v80, v96, v97
    v_mfma_f32_16x16x32_bf16 v[104:107], a[72:75], v[136:139], v[104:107]
    ds_read_b64_tr_b16 a[88:89], v22 offset:45056
    v_mfma_f32_16x16x32_bf16 v[120:123], a[72:75], v[140:143], v[120:123]
    s_waitcnt lgkmcnt(5)
    ds_read_b64_tr_b16 a[90:91], v22 offset:47104
    v_cvt_pk_bf16_f32 v81, v98, v99
    v_mfma_f32_16x16x32_bf16 v[108:111], a[76:79], v[136:139], v[108:111]
    ds_read_b64_tr_b16 a[92:93], v23 offset:45056
    v_mfma_f32_16x16x32_bf16 v[124:127], a[76:79], v[140:143], v[124:127]
    s_waitcnt lgkmcnt(5)
    ds_read_b64_tr_b16 a[94:95], v23 offset:47104
    v_cvt_pk_bf16_f32 v82, v100, v101
    v_mfma_f32_16x16x32_bf16 v[104:107], a[80:83], v[144:147], v[104:107]
    ds_read_b64_tr_b16 a[96:97], v22 offset:49152
    v_mfma_f32_16x16x32_bf16 v[120:123], a[80:83], v[148:151], v[120:123]
    s_waitcnt lgkmcnt(5)
    ds_read_b64_tr_b16 a[98:99], v22 offset:51200
    v_mfma_f32_16x16x32_bf16 v[108:111], a[84:87], v[144:147], v[108:111]
    ds_read_b64_tr_b16 a[100:101], v23 offset:49152
    v_mfma_f32_16x16x32_bf16 v[124:127], a[84:87], v[148:151], v[124:127]
    s_waitcnt lgkmcnt(5)
    ds_read_b64_tr_b16 a[102:103], v23 offset:51200
    v_cvt_pk_bf16_f32 v83, v102, v103
    v_mfma_f32_16x16x32_bf16 v[104:107], a[88:91], v[152:155], v[104:107]
    ds_read_b64_tr_b16 a[104:105], v22 offset:53248
    v_mfma_f32_16x16x32_bf16 v[120:123], a[88:91], v[156:159], v[120:123]
    s_waitcnt lgkmcnt(5)
    ds_read_b64_tr_b16 a[106:107], v22 offset:55296
    buffer_store_dwordx4 v[80:83], v50, s[52:55], s22 offen offset:0 sc1
    v_mfma_f32_16x16x32_bf16 v[108:111], a[92:95], v[152:155], v[108:111]
    ds_read_b64_tr_b16 a[108:109], v23 offset:53248
    v_mfma_f32_16x16x32_bf16 v[124:127], a[92:95], v[156:159], v[124:127]
    s_waitcnt lgkmcnt(5)
    ds_read_b64_tr_b16 a[110:111], v23 offset:55296
    v_mfma_f32_16x16x32_bf16 v[104:107], a[96:99], v[160:163], v[104:107]
    ds_read_b64_tr_b16 a[112:113], v22 offset:57344
    v_mfma_f32_16x16x32_bf16 v[120:123], a[96:99], v[164:167], v[120:123]
    s_waitcnt lgkmcnt(5)
    ds_read_b64_tr_b16 a[114:115], v22 offset:59392
    v_cvt_pk_bf16_f32 v88, v112, v113
    v_mfma_f32_16x16x32_bf16 v[108:111], a[100:103], v[160:163], v[108:111]
    ds_read_b64_tr_b16 a[116:117], v23 offset:57344
    v_mfma_f32_16x16x32_bf16 v[124:127], a[100:103], v[164:167], v[124:127]
    s_waitcnt lgkmcnt(5)
    ds_read_b64_tr_b16 a[118:119], v23 offset:59392
    v_cvt_pk_bf16_f32 v89, v114, v115
    v_mfma_f32_16x16x32_bf16 v[104:107], a[104:107], v[168:171], v[104:107]
    ds_read_b64_tr_b16 a[120:121], v22 offset:61440
    v_mfma_f32_16x16x32_bf16 v[120:123], a[104:107], v[172:175], v[120:123]
    s_waitcnt lgkmcnt(5)
    ds_read_b64_tr_b16 a[122:123], v22 offset:63488
    v_mfma_f32_16x16x32_bf16 v[108:111], a[108:111], v[168:171], v[108:111]
    ds_read_b64_tr_b16 a[124:125], v23 offset:61440
    v_mfma_f32_16x16x32_bf16 v[124:127], a[108:111], v[172:175], v[124:127]
    s_waitcnt vmcnt(4) lgkmcnt(5)
    ds_read_b64_tr_b16 a[126:127], v23 offset:63488
    v_cvt_pk_bf16_f32 v90, v116, v117
    v_mfma_f32_16x16x32_bf16 v[104:107], a[112:115], v[176:179], v[104:107]
    s_barrier
    ds_read_b64_tr_b16 a[64:65], v24 offset:0
    v_mfma_f32_16x16x32_bf16 v[120:123], a[112:115], v[180:183], v[120:123]
    s_waitcnt lgkmcnt(5)
    ds_read_b64_tr_b16 a[66:67], v24 offset:2048
    v_cvt_pk_bf16_f32 v91, v118, v119
    v_mfma_f32_16x16x32_bf16 v[108:111], a[116:119], v[176:179], v[108:111]
    ds_read_b64_tr_b16 a[68:69], v25 offset:0
    v_mfma_f32_16x16x32_bf16 v[124:127], a[116:119], v[180:183], v[124:127]
    s_waitcnt lgkmcnt(5)
    ds_read_b64_tr_b16 a[70:71], v25 offset:2048
    v_mfma_f32_16x16x32_bf16 v[104:107], a[120:123], v[184:187], v[104:107]
    ds_read_b64_tr_b16 a[72:73], v24 offset:4096
    v_mfma_f32_16x16x32_bf16 v[120:123], a[120:123], v[188:191], v[120:123]
    s_waitcnt lgkmcnt(5)
    ds_read_b64_tr_b16 a[74:75], v24 offset:6144
    buffer_store_dwordx4 v[88:91], v50, s[52:55], s22 offen offset:2048 sc1
    v_mfma_f32_16x16x32_bf16 v[108:111], a[124:127], v[184:187], v[108:111]
    ds_read_b64_tr_b16 a[76:77], v25 offset:4096
    v_mfma_f32_16x16x32_bf16 v[124:127], a[124:127], v[188:191], v[124:127]
    s_waitcnt lgkmcnt(5)
    ds_read_b64_tr_b16 a[78:79], v25 offset:6144
    v_mfma_f32_16x16x32_bf16 v[192:195], a[64:67], v[128:131], 0
    ds_read_b64_tr_b16 a[80:81], v24 offset:8192
    v_mfma_f32_16x16x32_bf16 v[208:211], a[64:67], v[132:135], 0
    s_waitcnt lgkmcnt(5)
    ds_read_b64_tr_b16 a[82:83], v24 offset:10240
    v_mfma_f32_16x16x32_bf16 v[196:199], a[68:71], v[128:131], 0
    ds_read_b64_tr_b16 a[84:85], v25 offset:8192
    v_mfma_f32_16x16x32_bf16 v[212:215], a[68:71], v[132:135], 0
    s_waitcnt lgkmcnt(5)
    ds_read_b64_tr_b16 a[86:87], v25 offset:10240
    v_cvt_pk_bf16_f32 v84, v104, v105
    v_mfma_f32_16x16x32_bf16 v[192:195], a[72:75], v[136:139], v[192:195]
    ds_read_b64_tr_b16 a[88:89], v24 offset:12288
    v_mfma_f32_16x16x32_bf16 v[208:211], a[72:75], v[140:143], v[208:211]
    s_waitcnt lgkmcnt(5)
    ds_read_b64_tr_b16 a[90:91], v24 offset:14336
    v_cvt_pk_bf16_f32 v85, v106, v107
    v_mfma_f32_16x16x32_bf16 v[196:199], a[76:79], v[136:139], v[196:199]
    ds_read_b64_tr_b16 a[92:93], v25 offset:12288
    v_mfma_f32_16x16x32_bf16 v[212:215], a[76:79], v[140:143], v[212:215]
    s_waitcnt lgkmcnt(5)
    ds_read_b64_tr_b16 a[94:95], v25 offset:14336
    v_cvt_pk_bf16_f32 v86, v108, v109
    v_mfma_f32_16x16x32_bf16 v[192:195], a[80:83], v[144:147], v[192:195]
    ds_read_b64_tr_b16 a[96:97], v24 offset:16384
    v_mfma_f32_16x16x32_bf16 v[208:211], a[80:83], v[148:151], v[208:211]
    s_waitcnt lgkmcnt(5)
    ds_read_b64_tr_b16 a[98:99], v24 offset:18432
    v_mfma_f32_16x16x32_bf16 v[196:199], a[84:87], v[144:147], v[196:199]
    ds_read_b64_tr_b16 a[100:101], v25 offset:16384
    v_mfma_f32_16x16x32_bf16 v[212:215], a[84:87], v[148:151], v[212:215]
    s_waitcnt lgkmcnt(5)
    ds_read_b64_tr_b16 a[102:103], v25 offset:18432
    v_cvt_pk_bf16_f32 v87, v110, v111
    v_mfma_f32_16x16x32_bf16 v[192:195], a[88:91], v[152:155], v[192:195]
    ds_read_b64_tr_b16 a[104:105], v24 offset:20480
    v_mfma_f32_16x16x32_bf16 v[208:211], a[88:91], v[156:159], v[208:211]
    s_waitcnt lgkmcnt(5)
    ds_read_b64_tr_b16 a[106:107], v24 offset:22528
    buffer_store_dwordx4 v[84:87], v50, s[52:55], s22 offen offset:1024 sc1
    v_mfma_f32_16x16x32_bf16 v[196:199], a[92:95], v[152:155], v[196:199]
    ds_read_b64_tr_b16 a[108:109], v25 offset:20480
    v_mfma_f32_16x16x32_bf16 v[212:215], a[92:95], v[156:159], v[212:215]
    s_waitcnt lgkmcnt(5)
    ds_read_b64_tr_b16 a[110:111], v25 offset:22528
    v_mfma_f32_16x16x32_bf16 v[192:195], a[96:99], v[160:163], v[192:195]
    ds_read_b64_tr_b16 a[112:113], v24 offset:24576
    v_mfma_f32_16x16x32_bf16 v[208:211], a[96:99], v[164:167], v[208:211]
    s_waitcnt lgkmcnt(5)
    ds_read_b64_tr_b16 a[114:115], v24 offset:26624
    v_cvt_pk_bf16_f32 v92, v120, v121
    v_mfma_f32_16x16x32_bf16 v[196:199], a[100:103], v[160:163], v[196:199]
    ds_read_b64_tr_b16 a[116:117], v25 offset:24576
    v_mfma_f32_16x16x32_bf16 v[212:215], a[100:103], v[164:167], v[212:215]
    s_waitcnt lgkmcnt(5)
    ds_read_b64_tr_b16 a[118:119], v25 offset:26624
    v_cvt_pk_bf16_f32 v93, v122, v123
    v_mfma_f32_16x16x32_bf16 v[192:195], a[104:107], v[168:171], v[192:195]
    ds_read_b64_tr_b16 a[120:121], v24 offset:28672
    v_mfma_f32_16x16x32_bf16 v[208:211], a[104:107], v[172:175], v[208:211]
    s_waitcnt lgkmcnt(5)
    ds_read_b64_tr_b16 a[122:123], v24 offset:30720
    v_mfma_f32_16x16x32_bf16 v[196:199], a[108:111], v[168:171], v[196:199]
    ds_read_b64_tr_b16 a[124:125], v25 offset:28672
    v_mfma_f32_16x16x32_bf16 v[212:215], a[108:111], v[172:175], v[212:215]
    s_waitcnt lgkmcnt(5)
    ds_read_b64_tr_b16 a[126:127], v25 offset:30720
    v_cvt_pk_bf16_f32 v94, v124, v125
    v_mfma_f32_16x16x32_bf16 v[192:195], a[112:115], v[176:179], v[192:195]
    ds_read_b64_tr_b16 a[64:65], v26 offset:0
    v_mfma_f32_16x16x32_bf16 v[208:211], a[112:115], v[180:183], v[208:211]
    s_waitcnt lgkmcnt(5)
    ds_read_b64_tr_b16 a[66:67], v26 offset:2048
    v_cvt_pk_bf16_f32 v95, v126, v127
    v_mfma_f32_16x16x32_bf16 v[196:199], a[116:119], v[176:179], v[196:199]
    ds_read_b64_tr_b16 a[68:69], v27 offset:0
    v_mfma_f32_16x16x32_bf16 v[212:215], a[116:119], v[180:183], v[212:215]
    s_waitcnt lgkmcnt(5)
    ds_read_b64_tr_b16 a[70:71], v27 offset:2048
    v_mfma_f32_16x16x32_bf16 v[192:195], a[120:123], v[184:187], v[192:195]
    ds_read_b64_tr_b16 a[72:73], v26 offset:4096
    v_mfma_f32_16x16x32_bf16 v[208:211], a[120:123], v[188:191], v[208:211]
    s_waitcnt lgkmcnt(5)
    ds_read_b64_tr_b16 a[74:75], v26 offset:6144
    buffer_store_dwordx4 v[92:95], v50, s[52:55], s22 offen offset:3072 sc1
    v_mfma_f32_16x16x32_bf16 v[196:199], a[124:127], v[184:187], v[196:199]
    ds_read_b64_tr_b16 a[76:77], v27 offset:4096
    v_mfma_f32_16x16x32_bf16 v[212:215], a[124:127], v[188:191], v[212:215]
    s_waitcnt vmcnt(4) lgkmcnt(5)
    ds_read_b64_tr_b16 a[78:79], v27 offset:6144
    v_mfma_f32_16x16x32_bf16 v[200:203], a[64:67], v[128:131], 0
    s_barrier
    ds_read_b64_tr_b16 a[80:81], v26 offset:8192
    v_mfma_f32_16x16x32_bf16 v[216:219], a[64:67], v[132:135], 0
    s_waitcnt lgkmcnt(5)
    ds_read_b64_tr_b16 a[82:83], v26 offset:10240
    s_cmp_lg_u32 s61, 0
    s_cbranch_scc1 L_nosig1
    v_readfirstlane_b32 s69, v55
    s_nop 0
    s_cmp_lt_u32 s69, 16
    s_cbranch_scc1 L_hs
L_hsok:
    s_mov_b64 exec, 0xffff
    global_store_dword v53, v54, s[80:81] sc1
    s_mov_b64 exec, -1
L_nosig1:
    v_mfma_f32_16x16x32_bf16 v[204:207], a[68:71], v[128:131], 0
    ds_read_b64_tr_b16 a[84:85], v27 offset:8192
    v_mfma_f32_16x16x32_bf16 v[220:223], a[68:71], v[132:135], 0
    s_waitcnt lgkmcnt(5)
    ds_read_b64_tr_b16 a[86:87], v27 offset:10240
    v_cvt_pk_bf16_f32 v80, v192, v193
    v_mfma_f32_16x16x32_bf16 v[200:203], a[72:75], v[136:139], v[200:203]
    ds_read_b64_tr_b16 a[88:89], v26 offset:12288
    v_mfma_f32_16x16x32_bf16 v[216:219], a[72:75], v[140:143], v[216:219]
    s_waitcnt lgkmcnt(5)
    ds_read_b64_tr_b16 a[90:91], v26 offset:14336
    v_cvt_pk_bf16_f32 v81, v194, v195
    v_mfma_f32_16x16x32_bf16 v[204:207], a[76:79], v[136:139], v[204:207]
    ds_read_b64_tr_b16 a[92:93], v27 offset:12288
    v_mfma_f32_16x16x32_bf16 v[220:223], a[76:79], v[140:143], v[220:223]
    s_waitcnt lgkmcnt(5)
    ds_read_b64_tr_b16 a[94:95], v27 offset:14336
    v_cvt_pk_bf16_f32 v82, v196, v197
    v_mfma_f32_16x16x32_bf16 v[200:203], a[80:83], v[144:147], v[200:203]
    ds_read_b64_tr_b16 a[96:97], v26 offset:16384
    v_mfma_f32_16x16x32_bf16 v[216:219], a[80:83], v[148:151], v[216:219]
    s_waitcnt lgkmcnt(5)
    ds_read_b64_tr_b16 a[98:99], v26 offset:18432
    v_mfma_f32_16x16x32_bf16 v[204:207], a[84:87], v[144:147], v[204:207]
    ds_read_b64_tr_b16 a[100:101], v27 offset:16384
    v_mfma_f32_16x16x32_bf16 v[220:223], a[84:87], v[148:151], v[220:223]
    s_waitcnt lgkmcnt(5)
    ds_read_b64_tr_b16 a[102:103], v27 offset:18432
    v_cvt_pk_bf16_f32 v83, v198, v199
    v_mfma_f32_16x16x32_bf16 v[200:203], a[88:91], v[152:155], v[200:203]
    ds_read_b64_tr_b16 a[104:105], v26 offset:20480
    v_mfma_f32_16x16x32_bf16 v[216:219], a[88:91], v[156:159], v[216:219]
    s_waitcnt lgkmcnt(5)
    ds_read_b64_tr_b16 a[106:107], v26 offset:22528
    buffer_store_dwordx4 v[80:83], v50, s[52:55], s23 offen offset:0 sc1
    v_mfma_f32_16x16x32_bf16 v[204:207], a[92:95], v[152:155], v[204:207]
    ds_read_b64_tr_b16 a[108:109], v27 offset:20480
    v_mfma_f32_16x16x32_bf16 v[220:223], a[92:95], v[156:159], v[220:223]
    s_waitcnt lgkmcnt(5)
    ds_read_b64_tr_b16 a[110:111], v27 offset:22528
    v_mfma_f32_16x16x32_bf16 v[200:203], a[96:99], v[160:163], v[200:203]
    ds_read_b64_tr_b16 a[112:113], v26 offset:24576
    v_mfma_f32_16x16x32_bf16 v[216:219], a[96:99], v[164:167], v[216:219]
    s_waitcnt lgkmcnt(5)
    ds_read_b64_tr_b16 a[114:115], v26 offset:26624
    v_cvt_pk_bf16_f32 v88, v208, v209
    v_mfma_f32_16x16x32_bf16 v[204:207], a[100:103], v[160:163], v[204:207]
    ds_read_b64_tr_b16 a[116:117], v27 offset:24576
    v_mfma_f32_16x16x32_bf16 v[220:223], a[100:103], v[164:167], v[220:223]
    s_waitcnt lgkmcnt(5)
    ds_read_b64_tr_b16 a[118:119], v27 offset:26624
    v_cvt_pk_bf16_f32 v89, v210, v211
    v_mfma_f32_16x16x32_bf16 v[200:203], a[104:107], v[168:171], v[200:203]
    ds_read_b64_tr_b16 a[120:121], v26 offset:28672
    v_mfma_f32_16x16x32_bf16 v[216:219], a[104:107], v[172:175], v[216:219]
    s_waitcnt lgkmcnt(5)
    ds_read_b64_tr_b16 a[122:123], v26 offset:30720
    v_mfma_f32_16x16x32_bf16 v[204:207], a[108:111], v[168:171], v[204:207]
    ds_read_b64_tr_b16 a[124:125], v27 offset:28672
    v_mfma_f32_16x16x32_bf16 v[220:223], a[108:111], v[172:175], v[220:223]
    s_waitcnt lgkmcnt(5)
    ds_read_b64_tr_b16 a[126:127], v27 offset:30720
    v_cvt_pk_bf16_f32 v90, v212, v213
    v_mfma_f32_16x16x32_bf16 v[200:203], a[112:115], v[176:179], v[200:203]
    ds_read_b64_tr_b16 a[64:65], v46 offset:0
    v_mfma_f32_16x16x32_bf16 v[216:219], a[112:115], v[180:183], v[216:219]
    s_waitcnt lgkmcnt(5)
    ds_read_b64_tr_b16 a[66:67], v46 offset:2048
    v_cvt_pk_bf16_f32 v91, v214, v215
    v_mfma_f32_16x16x32_bf16 v[204:207], a[116:119], v[176:179], v[204:207]
    ds_read_b64_tr_b16 a[68:69], v47 offset:0
    v_mfma_f32_16x16x32_bf16 v[220:223], a[116:119], v[180:183], v[220:223]
    s_waitcnt lgkmcnt(5)
    ds_read_b64_tr_b16 a[70:71], v47 offset:2048
    v_mfma_f32_16x16x32_bf16 v[200:203], a[120:123], v[184:187], v[200:203]
    ds_read_b64_tr_b16 a[72:73], v46 offset:4096
    v_mfma_f32_16x16x32_bf16 v[216:219], a[120:123], v[188:191], v[216:219]
    s_waitcnt lgkmcnt(5)
    ds_read_b64_tr_b16 a[74:75], v46 offset:6144
    buffer_store_dwordx4 v[88:91], v50, s[52:55], s23 offen offset:2048 sc1
    v_mfma_f32_16x16x32_bf16 v[204:207], a[124:127], v[184:187], v[204:207]
    ds_read_b64_tr_b16 a[76:77], v47 offset:4096
    v_mfma_f32_16x16x32_bf16 v[220:223], a[124:127], v[188:191], v[220:223]
    s_waitcnt lgkmcnt(5)
    ds_read_b64_tr_b16 a[78:79], v47 offset:6144
    v_mfma_f32_16x16x32_bf16 v[96:99], a[64:67], v[128:131], 0
    ds_read_b64_tr_b16 a[80:81], v46 offset:8192
    v_mfma_f32_16x16x32_bf16 v[112:115], a[64:67], v[132:135], 0
    s_waitcnt lgkmcnt(5)
    ds_read_b64_tr_b16 a[82:83], v46 offset:10240
    v_mfma_f32_16x16x32_bf16 v[100:103], a[68:71], v[128:131], 0
    ds_read_b64_tr_b16 a[84:85], v47 offset:8192
    v_mfma_f32_16x16x32_bf16 v[116:119], a[68:71], v[132:135], 0
    s_waitcnt lgkmcnt(5)
    ds_read_b64_tr_b16 a[86:87], v47 offset:10240
    v_cvt_pk_bf16_f32 v84, v200, v201
    v_mfma_f32_16x16x32_bf16 v[96:99], a[72:75], v[136:139], v[96:99]
    ds_read_b64_tr_b16 a[88:89], v46 offset:12288
    v_mfma_f32_16x16x32_bf16 v[112:115], a[72:75], v[140:143], v[112:115]
    s_waitcnt lgkmcnt(5)
    ds_read_b64_tr_b16 a[90:91], v46 offset:14336
    v_cvt_pk_bf16_f32 v85, v202, v203
    v_mfma_f32_16x16x32_bf16 v[100:103], a[76:79], v[136:139], v[100:103]
    ds_read_b64_tr_b16 a[92:93], v47 offset:12288
    v_mfma_f32_16x16x32_bf16 v[116:119], a[76:79], v[140:143], v[116:119]
    s_waitcnt lgkmcnt(5)
    ds_read_b64_tr_b16 a[94:95], v47 offset:14336
    v_cvt_pk_bf16_f32 v86, v204, v205
    v_mfma_f32_16x16x32_bf16 v[96:99], a[80:83], v[144:147], v[96:99]
    ds_read_b64_tr_b16 a[96:97], v46 offset:16384
    v_mfma_f32_16x16x32_bf16 v[112:115], a[80:83], v[148:151], v[112:115]
    s_waitcnt lgkmcnt(5)
    ds_read_b64_tr_b16 a[98:99], v46 offset:18432
    v_mfma_f32_16x16x32_bf16 v[100:103], a[84:87], v[144:147], v[100:103]
    ds_read_b64_tr_b16 a[100:101], v47 offset:16384
    v_mfma_f32_16x16x32_bf16 v[116:119], a[84:87], v[148:151], v[116:119]
    s_waitcnt lgkmcnt(5)
    ds_read_b64_tr_b16 a[102:103], v47 offset:18432
    v_cvt_pk_bf16_f32 v87, v206, v207
    v_mfma_f32_16x16x32_bf16 v[96:99], a[88:91], v[152:155], v[96:99]
    ds_read_b64_tr_b16 a[104:105], v46 offset:20480
    v_mfma_f32_16x16x32_bf16 v[112:115], a[88:91], v[156:159], v[112:115]
    s_waitcnt lgkmcnt(5)
    ds_read_b64_tr_b16 a[106:107], v46 offset:22528
    buffer_store_dwordx4 v[84:87], v50, s[52:55], s23 offen offset:1024 sc1
    v_mfma_f32_16x16x32_bf16 v[100:103], a[92:95], v[152:155], v[100:103]
    ds_read_b64_tr_b16 a[108:109], v47 offset:20480
    v_mfma_f32_16x16x32_bf16 v[116:119], a[92:95], v[156:159], v[116:119]
    s_waitcnt lgkmcnt(5)
    ds_read_b64_tr_b16 a[110:111], v47 offset:22528
    v_mfma_f32_16x16x32_bf16 v[96:99], a[96:99], v[160:163], v[96:99]
    ds_read_b64_tr_b16 a[112:113], v46 offset:24576
    v_mfma_f32_16x16x32_bf16 v[112:115], a[96:99], v[164:167], v[112:115]
    s_waitcnt lgkmcnt(5)
    ds_read_b64_tr_b16 a[114:115], v46 offset:26624
    v_cvt_pk_bf16_f32 v92, v216, v217
    v_mfma_f32_16x16x32_bf16 v[100:103], a[100:103], v[160:163], v[100:103]
    ds_read_b64_tr_b16 a[116:117], v47 offset:24576
    v_mfma_f32_16x16x32_bf16 v[116:119], a[100:103], v[164:167], v[116:119]
    s_waitcnt lgkmcnt(5)
    ds_read_b64_tr_b16 a[118:119], v47 offset:26624
    v_cvt_pk_bf16_f32 v93, v218, v219
    v_mfma_f32_16x16x32_bf16 v[96:99], a[104:107], v[168:171], v[96:99]
    ds_read_b64_tr_b16 a[120:121], v46 offset:28672
    v_mfma_f32_16x16x32_bf16 v[112:115], a[104:107], v[172:175], v[112:115]
    s_waitcnt lgkmcnt(5)
    ds_read_b64_tr_b16 a[122:123], v46 offset:30720
    v_mfma_f32_16x16x32_bf16 v[100:103], a[108:111], v[168:171], v[100:103]
    ds_read_b64_tr_b16 a[124:125], v47 offset:28672
    v_mfma_f32_16x16x32_bf16 v[116:119], a[108:111], v[172:175], v[116:119]
    s_waitcnt lgkmcnt(5)
    ds_read_b64_tr_b16 a[126:127], v47 offset:30720
    v_cvt_pk_bf16_f32 v94, v220, v221
    v_mfma_f32_16x16x32_bf16 v[96:99], a[112:115], v[176:179], v[96:99]
    ds_read_b64_tr_b16 a[64:65], v48 offset:0
    v_mfma_f32_16x16x32_bf16 v[112:115], a[112:115], v[180:183], v[112:115]
    s_waitcnt lgkmcnt(5)
    ds_read_b64_tr_b16 a[66:67], v48 offset:2048
    v_cvt_pk_bf16_f32 v95, v222, v223
    v_mfma_f32_16x16x32_bf16 v[100:103], a[116:119], v[176:179], v[100:103]
    ds_read_b64_tr_b16 a[68:69], v49 offset:0
    v_mfma_f32_16x16x32_bf16 v[116:119], a[116:119], v[180:183], v[116:119]
    s_waitcnt lgkmcnt(5)
    ds_read_b64_tr_b16 a[70:71], v49 offset:2048
    v_mfma_f32_16x16x32_bf16 v[96:99], a[120:123], v[184:187], v[96:99]
    ds_read_b64_tr_b16 a[72:73], v48 offset:4096
    v_mfma_f32_16x16x32_bf16 v[112:115], a[120:123], v[188:191], v[112:115]
    s_waitcnt lgkmcnt(5)
    ds_read_b64_tr_b16 a[74:75], v48 offset:6144
    buffer_store_dwordx4 v[92:95], v50, s[52:55], s23 offen offset:3072 sc1
    v_mfma_f32_16x16x32_bf16 v[100:103], a[124:127], v[184:187], v[100:103]
    ds_read_b64_tr_b16 a[76:77], v49 offset:4096
    v_mfma_f32_16x16x32_bf16 v[116:119], a[124:127], v[188:191], v[116:119]
    s_waitcnt lgkmcnt(5)
    ds_read_b64_tr_b16 a[78:79], v49 offset:6144
    v_mfma_f32_16x16x32_bf16 v[104:107], a[64:67], v[128:131], 0
    ds_read_b64_tr_b16 a[80:81], v48 offset:8192
    v_mfma_f32_16x16x32_bf16 v[120:123], a[64:67], v[132:135], 0
    s_waitcnt lgkmcnt(5)
    ds_read_b64_tr_b16 a[82:83], v48 offset:10240
    v_mfma_f32_16x16x32_bf16 v[108:111], a[68:71], v[128:131], 0
    ds_read_b64_tr_b16 a[84:85], v49 offset:8192
    v_mfma_f32_16x16x32_bf16 v[124:127], a[68:71], v[132:135], 0
    s_waitcnt lgkmcnt(5)
    ds_read_b64_tr_b16 a[86:87], v49 offset:10240
    v_cvt_pk_bf16_f32 v80, v96, v97
    v_mfma_f32_16x16x32_bf16 v[104:107], a[72:75], v[136:139], v[104:107]
    ds_read_b64_tr_b16 a[88:89], v48 offset:12288
    v_mfma_f32_16x16x32_bf16 v[120:123], a[72:75], v[140:143], v[120:123]
    s_waitcnt lgkmcnt(5)
    ds_read_b64_tr_b16 a[90:91], v48 offset:14336
    v_cvt_pk_bf16_f32 v81, v98, v99
    v_mfma_f32_16x16x32_bf16 v[108:111], a[76:79], v[136:139], v[108:111]
    ds_read_b64_tr_b16 a[92:93], v49 offset:12288
    v_mfma_f32_16x16x32_bf16 v[124:127], a[76:79], v[140:143], v[124:127]
    s_waitcnt lgkmcnt(5)
    ds_read_b64_tr_b16 a[94:95], v49 offset:14336
    v_mfma_f32_16x16x32_bf16 v[104:107], a[80:83], v[144:147], v[104:107]
    ds_read_b64_tr_b16 a[96:97], v48 offset:16384
    v_mfma_f32_16x16x32_bf16 v[120:123], a[80:83], v[148:151], v[120:123]
    s_waitcnt lgkmcnt(5)
    ds_read_b64_tr_b16 a[98:99], v48 offset:18432
    v_cvt_pk_bf16_f32 v82, v100, v101
    v_mfma_f32_16x16x32_bf16 v[108:111], a[84:87], v[144:147], v[108:111]
    ds_read_b64_tr_b16 a[100:101], v49 offset:16384
    v_mfma_f32_16x16x32_bf16 v[124:127], a[84:87], v[148:151], v[124:127]
    s_waitcnt lgkmcnt(5)
    ds_read_b64_tr_b16 a[102:103], v49 offset:18432
    v_mfma_f32_16x16x32_bf16 v[104:107], a[88:91], v[152:155], v[104:107]
    ds_read_b64_tr_b16 a[104:105], v48 offset:20480
    v_mfma_f32_16x16x32_bf16 v[120:123], a[88:91], v[156:159], v[120:123]
    s_waitcnt lgkmcnt(5)
    ds_read_b64_tr_b16 a[106:107], v48 offset:22528
    v_cvt_pk_bf16_f32 v83, v102, v103
    v_mfma_f32_16x16x32_bf16 v[108:111], a[92:95], v[152:155], v[108:111]
    ds_read_b64_tr_b16 a[108:109], v49 offset:20480
    v_mfma_f32_16x16x32_bf16 v[124:127], a[92:95], v[156:159], v[124:127]
    s_waitcnt lgkmcnt(5)
    ds_read_b64_tr_b16 a[110:111], v49 offset:22528
    v_mfma_f32_16x16x32_bf16 v[104:107], a[96:99], v[160:163], v[104:107]
    ds_read_b64_tr_b16 a[112:113], v48 offset:24576
    v_mfma_f32_16x16x32_bf16 v[120:123], a[96:99], v[164:167], v[120:123]
    s_waitcnt lgkmcnt(5)
    ds_read_b64_tr_b16 a[114:115], v48 offset:26624
    buffer_store_dwordx4 v[80:83], v50, s[52:55], s92 offen offset:0 sc1
    v_mfma_f32_16x16x32_bf16 v[108:111], a[100:103], v[160:163], v[108:111]
    ds_read_b64_tr_b16 a[116:117], v49 offset:24576
    v_mfma_f32_16x16x32_bf16 v[124:127], a[100:103], v[164:167], v[124:127]
    s_waitcnt lgkmcnt(5)
    ds_read_b64_tr_b16 a[118:119], v49 offset:26624
    v_mfma_f32_16x16x32_bf16 v[104:107], a[104:107], v[168:171], v[104:107]
    ds_read_b64_tr_b16 a[120:121], v48 offset:28672
    v_mfma_f32_16x16x32_bf16 v[120:123], a[104:107], v[172:175], v[120:123]
    s_waitcnt lgkmcnt(5)
    ds_read_b64_tr_b16 a[122:123], v48 offset:30720
    v_cvt_pk_bf16_f32 v88, v112, v113
    v_mfma_f32_16x16x32_bf16 v[108:111], a[108:111], v[168:171], v[108:111]
    ds_read_b64_tr_b16 a[124:125], v49 offset:28672
    v_mfma_f32_16x16x32_bf16 v[124:127], a[108:111], v[172:175], v[124:127]
    s_waitcnt lgkmcnt(5)
    ds_read_b64_tr_b16 a[126:127], v49 offset:30720
    v_mfma_f32_16x16x32_bf16 v[104:107], a[112:115], v[176:179], v[104:107]
    v_mfma_f32_16x16x32_bf16 v[120:123], a[112:115], v[180:183], v[120:123]
    s_waitcnt lgkmcnt(4)
    v_cvt_pk_bf16_f32 v89, v114, v115
    v_mfma_f32_16x16x32_bf16 v[108:111], a[116:119], v[176:179], v[108:111]
    v_mfma_f32_16x16x32_bf16 v[124:127], a[116:119], v[180:183], v[124:127]
    s_waitcnt lgkmcnt(2)
    v_cvt_pk_bf16_f32 v90, v116, v117
    v_mfma_f32_16x16x32_bf16 v[104:107], a[120:123], v[184:187], v[104:107]
    v_mfma_f32_16x16x32_bf16 v[120:123], a[120:123], v[188:191], v[120:123]
    s_waitcnt lgkmcnt(0)
    v_cvt_pk_bf16_f32 v91, v118, v119
    v_mfma_f32_16x16x32_bf16 v[108:111], a[124:127], v[184:187], v[108:111]
    v_mfma_f32_16x16x32_bf16 v[124:127], a[124:127], v[188:191], v[124:127]
    buffer_store_dwordx4 v[88:91], v50, s[52:55], s92 offen offset:2048 sc1
    s_nop 1
    v_cvt_pk_bf16_f32 v84, v104, v105
    v_cvt_pk_bf16_f32 v85, v106, v107
    s_nop 1
    v_cvt_pk_bf16_f32 v86, v108, v109
    v_cvt_pk_bf16_f32 v87, v110, v111
    buffer_store_dwordx4 v[84:87], v50, s[52:55], s92 offen offset:1024 sc1
    v_cvt_pk_bf16_f32 v92, v120, v121
    v_cvt_pk_bf16_f32 v93, v122, v123
    v_cvt_pk_bf16_f32 v94, v124, v125
    v_cvt_pk_bf16_f32 v95, v126, v127
    buffer_store_dwordx4 v[92:95], v50, s[52:55], s92 offen offset:3072 sc1
    global_load_dword v59, v52, s[80:81] sc1
    s_waitcnt vmcnt(0)
    s_barrier
    s_cmp_lg_u32 s61, 0
    s_cbranch_scc1 L_nosig2
    s_mov_b64 exec, 0xffff
    global_store_dword v53, v54, s[80:81] offset:64 sc1
    s_mov_b64 exec, -1
L_nosig2:
    s_mov_b32 s73, 0
    s_cmp_eq_u32 s98, 0
    s_cbranch_scc1 L_st2
L_w0:
    v_cmp_ne_u32 vcc, 1, v59
    s_nop 0
    s_and_b32 s69, vcc_lo, 0xffff
    s_cbranch_scc0 L_ok0
    s_add_u32 s73, s73, 1
    s_cmp_ge_u32 s73, 0x40000
    s_cbranch_scc1 L_ok0
    s_sleep 2
    global_load_dword v59, v52, s[80:81] sc1
    s_waitcnt vmcnt(0)
    s_branch L_w0
L_ok0:
    buffer_load_dwordx4 v[128:131], v50, s[52:55], s94 offen sc1
    s_add_u32 s94, s94, 114688
    buffer_load_dwordx4 v[132:135], v50, s[52:55], s94 offen sc1
    s_add_u32 s94, s94, 114688
    buffer_load_dwordx4 v[136:139], v50, s[52:55], s94 offen sc1
    s_add_u32 s94, s94, 114688
    buffer_load_dwordx4 v[140:143], v50, s[52:55], s94 offen sc1
    s_add_u32 s94, s94, 114688
    buffer_load_dwordx4 v[144:147], v50, s[52:55], s94 offen sc1
    s_add_u32 s94, s94, 114688
    buffer_load_dwordx4 v[148:151], v50, s[52:55], s94 offen sc1
    s_add_u32 s94, s94, 114688
    buffer_load_dwordx4 v[152:155], v50, s[52:55], s94 offen sc1
    s_add_u32 s94, s94, 114688
    buffer_load_dwordx4 v[156:159], v50, s[52:55], s94 offen sc1
    s_add_u32 s94, s94, 114688
    buffer_load_dwordx4 v[160:163], v50, s[52:55], s94 offen sc1
    s_add_u32 s94, s94, 114688
    buffer_load_dwordx4 v[164:167], v50, s[52:55], s94 offen sc1
    s_add_u32 s94, s94, 114688
    buffer_load_dwordx4 v[168:171], v50, s[52:55], s94 offen sc1
    s_add_u32 s94, s94, 114688
    buffer_load_dwordx4 v[172:175], v50, s[52:55], s94 offen sc1
    s_add_u32 s94, s94, 114688
    buffer_load_dwordx4 v[176:179], v50, s[52:55], s94 offen sc1
    s_add_u32 s94, s94, 114688
    buffer_load_dwordx4 v[180:183], v50, s[52:55], s94 offen sc1
    s_add_u32 s94, s94, 114688
    buffer_load_dwordx4 v[184:187], v50, s[52:55], s94 offen sc1
    s_add_u32 s94, s94, 114688
    buffer_load_dwordx4 v[188:191], v50, s[52:55], s94 offen sc1
L_join:
    s_waitcnt vmcnt(15)
    v_dot2_f32_bf16 v96, v128, s100, 0
    v_dot2_f32_bf16 v97, v128, s101, 0
    v_dot2_f32_bf16 v98, v129, s100, 0
    v_dot2_f32_bf16 v99, v129, s101, 0
    v_dot2_f32_bf16 v100, v130, s100, 0
    v_dot2_f32_bf16 v101, v130, s101, 0
    v_dot2_f32_bf16 v102, v131, s100, 0
    v_dot2_f32_bf16 v103, v131, s101, 0
    s_waitcnt vmcnt(14)
    v_dot2_f32_bf16 v96, v132, s100, v96
    v_dot2_f32_bf16 v97, v132, s101, v97
    v_dot2_f32_bf16 v98, v133, s100, v98
    v_dot2_f32_bf16 v99, v133, s101, v99
    v_dot2_f32_bf16 v100, v134, s100, v100
    v_dot2_f32_bf16 v101, v134, s101, v101
    v_dot2_f32_bf16 v102, v135, s100, v102
    v_dot2_f32_bf16 v103, v135, s101, v103
    s_waitcnt vmcnt(13)
    v_dot2_f32_bf16 v96, v136, s100, v96
    v_dot2_f32_bf16 v97, v136, s101, v97
    v_dot2_f32_bf16 v98, v137, s100, v98
    v_dot2_f32_bf16 v99, v137, s101, v99
    v_dot2_f32_bf16 v100, v138, s100, v100
    v_dot2_f32_bf16 v101, v138, s101, v101
    v_dot2_f32_bf16 v102, v139, s100, v102
    v_dot2_f32_bf16 v103, v139, s101, v103
    s_waitcnt vmcnt(12)
    v_dot2_f32_bf16 v96, v140, s100, v96
    v_dot2_f32_bf16 v97, v140, s101, v97
    v_dot2_f32_bf16 v98, v141, s100, v98
    v_dot2_f32_bf16 v99, v141, s101, v99
    v_dot2_f32_bf16 v100, v142, s100, v100
    v_dot2_f32_bf16 v101, v142, s101, v101
    v_dot2_f32_bf16 v102, v143, s100, v102
    v_dot2_f32_bf16 v103, v143, s101, v103
    s_waitcnt vmcnt(11)
    v_dot2_f32_bf16 v96, v144, s100, v96
    v_dot2_f32_bf16 v97, v144, s101, v97
    v_dot2_f32_bf16 v98, v145, s100, v98
    v_dot2_f32_bf16 v99, v145, s101, v99
    v_dot2_f32_bf16 v100, v146, s100, v100
    v_dot2_f32_bf16 v101, v146, s101, v101
    v_dot2_f32_bf16 v102, v147, s100, v102
    v_dot2_f32_bf16 v103, v147, s101, v103
    s_waitcnt vmcnt(10)
    v_dot2_f32_bf16 v96, v148, s100, v96
    v_dot2_f32_bf16 v97, v148, s101, v97
    v_dot2_f32_bf16 v98, v149, s100, v98
    v_dot2_f32_bf16 v99, v149, s101, v99
    v_dot2_f32_bf16 v100, v150, s100, v100
    v_dot2_f32_bf16 v101, v150, s101, v101
    v_dot2_f32_bf16 v102, v151, s100, v102
    v_dot2_f32_bf16 v103, v151, s101, v103
    s_waitcnt vmcnt(9)
    v_dot2_f32_bf16 v96, v152, s100, v96
    v_dot2_f32_bf16 v97, v152, s101, v97
    v_dot2_f32_bf16 v98, v153, s100, v98
    v_dot2_f32_bf16 v99, v153, s101, v99
    v_dot2_f32_bf16 v100, v154, s100, v100
    v_dot2_f32_bf16 v101, v154, s101, v101
    v_dot2_f32_bf16 v102, v155, s100, v102
    v_dot2_f32_bf16 v103, v155, s101, v103
    s_waitcnt vmcnt(8)
    v_dot2_f32_bf16 v96, v156, s100, v96
    v_dot2_f32_bf16 v97, v156, s101, v97
    v_dot2_f32_bf16 v98, v157, s100, v98
    v_dot2_f32_bf16 v99, v157, s101, v99
    v_dot2_f32_bf16 v100, v158, s100, v100
    v_dot2_f32_bf16 v101, v158, s101, v101
    v_dot2_f32_bf16 v102, v159, s100, v102
    v_dot2_f32_bf16 v103, v159, s101, v103
    s_waitcnt vmcnt(7)
    v_dot2_f32_bf16 v96, v160, s100, v96
    v_dot2_f32_bf16 v97, v160, s101, v97
    v_dot2_f32_bf16 v98, v161, s100, v98
    v_dot2_f32_bf16 v99, v161, s101, v99
    v_dot2_f32_bf16 v100, v162, s100, v100
    v_dot2_f32_bf16 v101, v162, s101, v101
    v_dot2_f32_bf16 v102, v163, s100, v102
    v_dot2_f32_bf16 v103, v163, s101, v103
    s_waitcnt vmcnt(6)
    v_dot2_f32_bf16 v96, v164, s100, v96
    v_dot2_f32_bf16 v97, v164, s101, v97
    v_dot2_f32_bf16 v98, v165, s100, v98
    v_dot2_f32_bf16 v99, v165, s101, v99
    v_dot2_f32_bf16 v100, v166, s100, v100
    v_dot2_f32_bf16 v101, v166, s101, v101
    v_dot2_f32_bf16 v102, v167, s100, v102
    v_dot2_f32_bf16 v103, v167, s101, v103
    s_waitcnt vmcnt(5)
    v_dot2_f32_bf16 v96, v168, s100, v96
    v_dot2_f32_bf16 v97, v168, s101, v97
    v_dot2_f32_bf16 v98, v169, s100, v98
    v_dot2_f32_bf16 v99, v169, s101, v99
    v_dot2_f32_bf16 v100, v170, s100, v100
    v_dot2_f32_bf16 v101, v170, s101, v101
    v_dot2_f32_bf16 v102, v171, s100, v102
    v_dot2_f32_bf16 v103, v171, s101, v103
    s_waitcnt vmcnt(4)
    v_dot2_f32_bf16 v96, v172, s100, v96
    v_dot2_f32_bf16 v97, v172, s101, v97
    v_dot2_f32_bf16 v98, v173, s100, v98
    v_dot2_f32_bf16 v99, v173, s101, v99
    v_dot2_f32_bf16 v100, v174, s100, v100
    v_dot2_f32_bf16 v101, v174, s101, v101
    v_dot2_f32_bf16 v102, v175, s100, v102
    v_dot2_f32_bf16 v103, v175, s101, v103
    global_load_dword v59, v52, s[80:81] sc1
    s_waitcnt vmcnt(4)
    v_dot2_f32_bf16 v96, v176, s100, v96
    v_dot2_f32_bf16 v97, v176, s101, v97
    v_dot2_f32_bf16 v98, v177, s100, v98
    v_dot2_f32_bf16 v99, v177, s101, v99
    v_dot2_f32_bf16 v100, v178, s100, v100
    v_dot2_f32_bf16 v101, v178, s101, v101
    v_dot2_f32_bf16 v102, v179, s100, v102
    v_dot2_f32_bf16 v103, v179, s101, v103
    s_waitcnt vmcnt(3)
    v_dot2_f32_bf16 v96, v180, s100, v96
    v_dot2_f32_bf16 v97, v180, s101, v97
    v_dot2_f32_bf16 v98, v181, s100, v98
    v_dot2_f32_bf16 v99, v181, s101, v99
    v_dot2_f32_bf16 v100, v182, s100, v100
    v_dot2_f32_bf16 v101, v182, s101, v101
    v_dot2_f32_bf16 v102, v183, s100, v102
    v_dot2_f32_bf16 v103, v183, s101, v103
    s_waitcnt vmcnt(2)
    v_dot2_f32_bf16 v96, v184, s100, v96
    v_dot2_f32_bf16 v97, v184, s101, v97
    v_dot2_f32_bf16 v98, v185, s100, v98
    v_dot2_f32_bf16 v99, v185, s101, v99
    v_dot2_f32_bf16 v100, v186, s100, v100
    v_dot2_f32_bf16 v101, v186, s101, v101
    v_dot2_f32_bf16 v102, v187, s100, v102
    v_dot2_f32_bf16 v103, v187, s101, v103
    s_waitcnt vmcnt(1)
    v_dot2_f32_bf16 v96, v188, s100, v96
    v_dot2_f32_bf16 v97, v188, s101, v97
    v_dot2_f32_bf16 v98, v189, s100, v98
    v_dot2_f32_bf16 v99, v189, s101, v99
    v_dot2_f32_bf16 v100, v190, s100, v100
    v_dot2_f32_bf16 v101, v190, s101, v101
    v_dot2_f32_bf16 v102, v191, s100, v102
    v_dot2_f32_bf16 v103, v191, s101, v103
    s_waitcnt vmcnt(0)
L_st2:
    s_cmp_eq_u32 s99, 0
    s_cbranch_scc1 L_fin0
L_w1:
    v_cmp_ne_u32 vcc, 1, v59
    s_nop 0
    s_and_b32 s69, vcc_lo, 0xffff0000
    s_cbranch_scc0 L_ok1
    s_add_u32 s73, s73, 1
    s_cmp_ge_u32 s73, 0x40000
    s_cbranch_scc1 L_ok1
    s_sleep 2
    global_load_dword v59, v52, s[80:81] sc1
    s_waitcnt vmcnt(0)
    s_branch L_w1
L_ok1:
    buffer_load_dwordx4 v[192:195], v50, s[52:55], s95 offen sc1
    s_add_u32 s95, s95, 114688
    buffer_load_dwordx4 v[196:199], v50, s[52:55], s95 offen sc1
    s_add_u32 s95, s95, 114688
    buffer_load_dwordx4 v[200:203], v50, s[52:55], s95 offen sc1
    s_add_u32 s95, s95, 114688
    buffer_load_dwordx4 v[204:207], v50, s[52:55], s95 offen sc1
    s_add_u32 s95, s95, 114688
    buffer_load_dwordx4 v[208:211], v50, s[52:55], s95 offen sc1
    s_add_u32 s95, s95, 114688
    buffer_load_dwordx4 v[212:215], v50, s[52:55], s95 offen sc1
    s_add_u32 s95, s95, 114688
    buffer_load_dwordx4 v[216:219], v50, s[52:55], s95 offen sc1
    s_add_u32 s95, s95, 114688
    buffer_load_dwordx4 v[220:223], v50, s[52:55], s95 offen sc1
    s_add_u32 s95, s95, 114688
    buffer_load_dwordx4 v[224:227], v50, s[52:55], s95 offen sc1
    s_add_u32 s95, s95, 114688
    buffer_load_dwordx4 v[228:231], v50, s[52:55], s95 offen sc1
    s_add_u32 s95, s95, 114688
    buffer_load_dwordx4 v[232:235], v50, s[52:55], s95 offen sc1
    s_add_u32 s95, s95, 114688
    buffer_load_dwordx4 v[236:239], v50, s[52:55], s95 offen sc1
    s_add_u32 s95, s95, 114688
    buffer_load_dwordx4 v[240:243], v50, s[52:55], s95 offen sc1
    s_add_u32 s95, s95, 114688
    buffer_load_dwordx4 v[244:247], v50, s[52:55], s95 offen sc1
    s_add_u32 s95, s95, 114688
    buffer_load_dwordx4 v[248:251], v50, s[52:55], s95 offen sc1
    s_add_u32 s95, s95, 114688
    buffer_load_dwordx4 v[252:255], v50, s[52:55], s95 offen sc1
    s_waitcnt vmcnt(15)
    v_dot2_f32_bf16 v112, v192, s100, 0
    v_dot2_f32_bf16 v113, v192, s101, 0
    v_dot2_f32_bf16 v114, v193, s100, 0
    v_dot2_f32_bf16 v115, v193, s101, 0
    v_dot2_f32_bf16 v116, v194, s100, 0
    v_dot2_f32_bf16 v117, v194, s101, 0
    v_dot2_f32_bf16 v118, v195, s100, 0
    v_dot2_f32_bf16 v119, v195, s101, 0
    s_waitcnt vmcnt(14)
    v_dot2_f32_bf16 v112, v196, s100, v112
    v_dot2_f32_bf16 v113, v196, s101, v113
    v_dot2_f32_bf16 v114, v197, s100, v114
    v_dot2_f32_bf16 v115, v197, s101, v115
    v_dot2_f32_bf16 v116, v198, s100, v116
    v_dot2_f32_bf16 v117, v198, s101, v117
    v_dot2_f32_bf16 v118, v199, s100, v118
    v_dot2_f32_bf16 v119, v199, s101, v119
    s_waitcnt vmcnt(13)
    v_dot2_f32_bf16 v112, v200, s100, v112
    v_dot2_f32_bf16 v113, v200, s101, v113
    v_dot2_f32_bf16 v114, v201, s100, v114
    v_dot2_f32_bf16 v115, v201, s101, v115
    v_dot2_f32_bf16 v116, v202, s100, v116
    v_dot2_f32_bf16 v117, v202, s101, v117
    v_dot2_f32_bf16 v118, v203, s100, v118
    v_dot2_f32_bf16 v119, v203, s101, v119
    s_waitcnt vmcnt(12)
    v_dot2_f32_bf16 v112, v204, s100, v112
    v_dot2_f32_bf16 v113, v204, s101, v113
    v_dot2_f32_bf16 v114, v205, s100, v114
    v_dot2_f32_bf16 v115, v205, s101, v115
    v_dot2_f32_bf16 v116, v206, s100, v116
    v_dot2_f32_bf16 v117, v206, s101, v117
    v_dot2_f32_bf16 v118, v207, s100, v118
    v_dot2_f32_bf16 v119, v207, s101, v119
    s_waitcnt vmcnt(11)
    v_dot2_f32_bf16 v112, v208, s100, v112
    v_dot2_f32_bf16 v113, v208, s101, v113
    v_dot2_f32_bf16 v114, v209, s100, v114
    v_dot2_f32_bf16 v115, v209, s101, v115
    v_dot2_f32_bf16 v116, v210, s100, v116
    v_dot2_f32_bf16 v117, v210, s101, v117
    v_dot2_f32_bf16 v118, v211, s100, v118
    v_dot2_f32_bf16 v119, v211, s101, v119
    s_waitcnt vmcnt(10)
    v_dot2_f32_bf16 v112, v212, s100, v112
    v_dot2_f32_bf16 v113, v212, s101, v113
    v_dot2_f32_bf16 v114, v213, s100, v114
    v_dot2_f32_bf16 v115, v213, s101, v115
    v_dot2_f32_bf16 v116, v214, s100, v116
    v_dot2_f32_bf16 v117, v214, s101, v117
    v_dot2_f32_bf16 v118, v215, s100, v118
    v_dot2_f32_bf16 v119, v215, s101, v119
    s_waitcnt vmcnt(9)
    v_dot2_f32_bf16 v112, v216, s100, v112
    v_dot2_f32_bf16 v113, v216, s101, v113
    v_dot2_f32_bf16 v114, v217, s100, v114
    v_dot2_f32_bf16 v115, v217, s101, v115
    v_dot2_f32_bf16 v116, v218, s100, v116
    v_dot2_f32_bf16 v117, v218, s101, v117
    v_dot2_f32_bf16 v118, v219, s100, v118
    v_dot2_f32_bf16 v119, v219, s101, v119
    s_waitcnt vmcnt(8)
    v_dot2_f32_bf16 v112, v220, s100, v112
    v_dot2_f32_bf16 v113, v220, s101, v113
    v_dot2_f32_bf16 v114, v221, s100, v114
    v_dot2_f32_bf16 v115, v221, s101, v115
    v_dot2_f32_bf16 v116, v222, s100, v116
    v_dot2_f32_bf16 v117, v222, s101, v117
    v_dot2_f32_bf16 v118, v223, s100, v118
    v_dot2_f32_bf16 v119, v223, s101, v119
    s_waitcnt vmcnt(7)
    v_dot2_f32_bf16 v112, v224, s100, v112
    v_dot2_f32_bf16 v113, v224, s101, v113
    v_dot2_f32_bf16 v114, v225, s100, v114
    v_dot2_f32_bf16 v115, v225, s101, v115
    v_dot2_f32_bf16 v116, v226, s100, v116
    v_dot2_f32_bf16 v117, v226, s101, v117
    v_dot2_f32_bf16 v118, v227, s100, v118
    v_dot2_f32_bf16 v119, v227, s101, v119
    s_waitcnt vmcnt(6)
    v_dot2_f32_bf16 v112, v228, s100, v112
    v_dot2_f32_bf16 v113, v228, s101, v113
    v_dot2_f32_bf16 v114, v229, s100, v114
    v_dot2_f32_bf16 v115, v229, s101, v115
    v_dot2_f32_bf16 v116, v230, s100, v116
    v_dot2_f32_bf16 v117, v230, s101, v117
    v_dot2_f32_bf16 v118, v231, s100, v118
    v_dot2_f32_bf16 v119, v231, s101, v119
    s_waitcnt vmcnt(5)
    v_dot2_f32_bf16 v112, v232, s100, v112
    v_dot2_f32_bf16 v113, v232, s101, v113
    v_dot2_f32_bf16 v114, v233, s100, v114
    v_dot2_f32_bf16 v115, v233, s101, v115
    v_dot2_f32_bf16 v116, v234, s100, v116
    v_dot2_f32_bf16 v117, v234, s101, v117
    v_dot2_f32_bf16 v118, v235, s100, v118
    v_dot2_f32_bf16 v119, v235, s101, v119
    s_waitcnt vmcnt(4)
    v_dot2_f32_bf16 v112, v236, s100, v112
    v_dot2_f32_bf16 v113, v236, s101, v113
    v_dot2_f32_bf16 v114, v237, s100, v114
    v_dot2_f32_bf16 v115, v237, s101, v115
    v_dot2_f32_bf16 v116, v238, s100, v116
    v_dot2_f32_bf16 v117, v238, s101, v117
    v_dot2_f32_bf16 v118, v239, s100, v118
    v_dot2_f32_bf16 v119, v239, s101, v119
    s_waitcnt vmcnt(3)
    v_dot2_f32_bf16 v112, v240, s100, v112
    v_dot2_f32_bf16 v113, v240, s101, v113
    v_dot2_f32_bf16 v114, v241, s100, v114
    v_dot2_f32_bf16 v115, v241, s101, v115
    v_dot2_f32_bf16 v116, v242, s100, v116
    v_dot2_f32_bf16 v117, v242, s101, v117
    v_dot2_f32_bf16 v118, v243, s100, v118
    v_dot2_f32_bf16 v119, v243, s101, v119
    s_waitcnt vmcnt(2)
    v_dot2_f32_bf16 v112, v244, s100, v112
    v_dot2_f32_bf16 v113, v244, s101, v113
    v_dot2_f32_bf16 v114, v245, s100, v114
    v_dot2_f32_bf16 v115, v245, s101, v115
    v_dot2_f32_bf16 v116, v246, s100, v116
    v_dot2_f32_bf16 v117, v246, s101, v117
    v_dot2_f32_bf16 v118, v247, s100, v118
    v_dot2_f32_bf16 v119, v247, s101, v119
    s_waitcnt vmcnt(1)
    v_dot2_f32_bf16 v112, v248, s100, v112
    v_dot2_f32_bf16 v113, v248, s101, v113
    v_dot2_f32_bf16 v114, v249, s100, v114
    v_dot2_f32_bf16 v115, v249, s101, v115
    v_dot2_f32_bf16 v116, v250, s100, v116
    v_dot2_f32_bf16 v117, v250, s101, v117
    v_dot2_f32_bf16 v118, v251, s100, v118
    v_dot2_f32_bf16 v119, v251, s101, v119
    s_waitcnt vmcnt(0)
    v_dot2_f32_bf16 v112, v252, s100, v112
    v_dot2_f32_bf16 v113, v252, s101, v113
    v_dot2_f32_bf16 v114, v253, s100, v114
    v_dot2_f32_bf16 v115, v253, s101, v115
    v_dot2_f32_bf16 v116, v254, s100, v116
    v_dot2_f32_bf16 v117, v254, s101, v117
    v_dot2_f32_bf16 v118, v255, s100, v118
    v_dot2_f32_bf16 v119, v255, s101, v119
    v_cvt_pk_bf16_f32 v88, v112, v113
    v_cvt_pk_bf16_f32 v89, v114, v115
    v_cvt_pk_bf16_f32 v90, v116, v117
    v_cvt_pk_bf16_f32 v91, v118, v119
    s_nop 0
    v_permlane16_swap_b32 v88, v90
    v_permlane16_swap_b32 v89, v91
    buffer_store_dwordx4 v[88:91], v51, s[56:59], s97 offen sc1
    s_cmp_eq_u32 s98, 0
    s_cbranch_scc1 L_done
L_fin0:
    s_nop 2
    v_cvt_pk_bf16_f32 v80, v96, v97
    v_cvt_pk_bf16_f32 v81, v98, v99
    v_cvt_pk_bf16_f32 v82, v100, v101
    v_cvt_pk_bf16_f32 v83, v102, v103
    s_nop 0
    v_permlane16_swap_b32 v80, v82
    v_permlane16_swap_b32 v81, v83
    buffer_store_dwordx4 v[80:83], v51, s[56:59], s96 offen sc1
L_done:
L_end:
    s_endpgm
L_hs:
    s_mov_b32 s73, 0
L_hs2:
    s_sleep 8
    global_load_dword v55, v56, s[26:27] sc1
    s_waitcnt vmcnt(0)
    v_readfirstlane_b32 s69, v55
    s_add_u32 s73, s73, 1
    s_cmp_ge_u32 s73, 0x40000
    s_cbranch_scc1 L_hsok
    s_cmp_lt_u32 s69, 16
    s_cbranch_scc1 L_hs2
    s_branch L_hsok
L_fixp0:
    s_call_b64 s[78:79], L_rescale0
    s_branch L_retp0
L_fix1:
    s_call_b64 s[78:79], L_rescale1
    s_branch L_ret1
L_fix2:
    s_call_b64 s[78:79], L_rescale0
    s_branch L_ret2
L_fix3:
    s_call_b64 s[78:79], L_rescale1
    s_branch L_ret3
L_fix0:
    s_call_b64 s[78:79], L_rescale0
    s_branch L_ret0
L_fixp29:
    s_call_b64 s[78:79], L_rescale1
    s_branch L_retp29
L_fixp30:
    s_call_b64 s[78:79], L_rescale0
    s_branch L_retp30
L_fixp31:
    s_call_b64 s[78:79], L_rescale1
    s_branch L_retp31
L_rescale0:
    s_nop 15
    v_max3_f32 v62, v96, v97, v98
    v_max3_f32 v62, v62, v99, v100
    v_max3_f32 v62, v62, v101, v102
    v_max_f32 v62, v62, v103
    v_mov_b32 v0, v62
    s_nop 1
    v_permlane32_swap_b32 v62, v0
    v_max_f32 v62, v62, v0
    v_mov_b32 v0, v62
    s_nop 1
    v_permlane16_swap_b32 v62, v0
    v_max_f32 v62, v62, v0
    v_max_f32 v62, 0, v62
    v_exp_f32 v1, -v62
    v_sub_f32 v72, v72, v62
    v_sub_f32 v73, v73, v62
    v_sub_f32 v74, v74, v62
    v_sub_f32 v75, v75, v62
    v_sub_f32 v96, v96, v62
    v_sub_f32 v112, v112, v62
    v_sub_f32 v97, v97, v62
    v_sub_f32 v113, v113, v62
    v_sub_f32 v98, v98, v62
    v_sub_f32 v114, v114, v62
    v_sub_f32 v99, v99, v62
    v_sub_f32 v115, v115, v62
    v_sub_f32 v100, v100, v62
    v_sub_f32 v116, v116, v62
    v_sub_f32 v101, v101, v62
    v_sub_f32 v117, v117, v62
    v_sub_f32 v102, v102, v62
    v_sub_f32 v118, v118, v62
    v_sub_f32 v103, v103, v62
    v_sub_f32 v119, v119, v62
    s_mov_b32 exec_lo, 0xffff
    s_mov_b32 exec_hi, 0
    v_mul_f32 v68, v68, v1
    s_mov_b64 exec, -1
    v_mul_f32 v128, v1, v128
    v_mul_f32 v129, v1, v129
    v_mul_f32 v130, v1, v130
    v_mul_f32 v131, v1, v131
    v_mul_f32 v136, v1, v136
    v_mul_f32 v137, v1, v137
    v_mul_f32 v138, v1, v138
    v_mul_f32 v139, v1, v139
    v_mul_f32 v144, v1, v144
    v_mul_f32 v145, v1, v145
    v_mul_f32 v146, v1, v146
    v_mul_f32 v147, v1, v147
    v_mul_f32 v152, v1, v152
    v_mul_f32 v153, v1, v153
    v_mul_f32 v154, v1, v154
    v_mul_f32 v155, v1, v155
    v_mul_f32 v160, v1, v160
    v_mul_f32 v161, v1, v161
    v_mul_f32 v162, v1, v162
    v_mul_f32 v163, v1, v163
    v_mul_f32 v168, v1, v168
    v_mul_f32 v169, v1, v169
    v_mul_f32 v170, v1, v170
    v_mul_f32 v171, v1, v171
    v_mul_f32 v176, v1, v176
    v_mul_f32 v177, v1, v177
    v_mul_f32 v178, v1, v178
    v_mul_f32 v179, v1, v179
    v_mul_f32 v184, v1, v184
    v_mul_f32 v185, v1, v185
    v_mul_f32 v186, v1, v186
    v_mul_f32 v187, v1, v187
    v_mul_f32 v192, v1, v192
    v_mul_f32 v193, v1, v193
    v_mul_f32 v194, v1, v194
    v_mul_f32 v195, v1, v195
    v_mul_f32 v200, v1, v200
    v_mul_f32 v201, v1, v201
    v_mul_f32 v202, v1, v202
    v_mul_f32 v203, v1, v203
    v_mul_f32 v208, v1, v208
    v_mul_f32 v209, v1, v209
    v_mul_f32 v210, v1, v210
    v_mul_f32 v211, v1, v211
    v_mul_f32 v216, v1, v216
    v_mul_f32 v217, v1, v217
    v_mul_f32 v218, v1, v218
    v_mul_f32 v219, v1, v219
    v_mul_f32 v224, v1, v224
    v_mul_f32 v225, v1, v225
    v_mul_f32 v226, v1, v226
    v_mul_f32 v227, v1, v227
    v_mul_f32 v232, v1, v232
    v_mul_f32 v233, v1, v233
    v_mul_f32 v234, v1, v234
    v_mul_f32 v235, v1, v235
    v_mul_f32 v240, v1, v240
    v_mul_f32 v241, v1, v241
    v_mul_f32 v242, v1, v242
    v_mul_f32 v243, v1, v243
    v_mul_f32 v248, v1, v248
    v_mul_f32 v249, v1, v249
    v_mul_f32 v250, v1, v250
    v_mul_f32 v251, v1, v251
    v_max3_f32 v63, v104, v105, v106
    v_max3_f32 v63, v63, v107, v108
    v_max3_f32 v63, v63, v109, v110
    v_max_f32 v63, v63, v111
    v_mov_b32 v0, v63
    s_nop 1
    v_permlane32_swap_b32 v63, v0
    v_max_f32 v63, v63, v0
    v_mov_b32 v0, v63
    s_nop 1
    v_permlane16_swap_b32 v63, v0
    v_max_f32 v63, v63, v0
    v_max_f32 v63, 0, v63
    v_exp_f32 v1, -v63
    v_sub_f32 v76, v76, v63
    v_sub_f32 v77, v77, v63
    v_sub_f32 v78, v78, v63
    v_sub_f32 v79, v79, v63
    v_sub_f32 v104, v104, v63
    v_sub_f32 v120, v120, v63
    v_sub_f32 v105, v105, v63
    v_sub_f32 v121, v121, v63
    v_sub_f32 v106, v106, v63
    v_sub_f32 v122, v122, v63
    v_sub_f32 v107, v107, v63
    v_sub_f32 v123, v123, v63
    v_sub_f32 v108, v108, v63
    v_sub_f32 v124, v124, v63
    v_sub_f32 v109, v109, v63
    v_sub_f32 v125, v125, v63
    v_sub_f32 v110, v110, v63
    v_sub_f32 v126, v126, v63
    v_sub_f32 v111, v111, v63
    v_sub_f32 v127, v127, v63
    s_mov_b32 exec_lo, 0xffff0000
    s_mov_b32 exec_hi, 0
    v_mul_f32 v68, v68, v1
    s_mov_b64 exec, -1
    v_mul_f32 v132, v1, v132
    v_mul_f32 v133, v1, v133
    v_mul_f32 v134, v1, v134
    v_mul_f32 v135, v1, v135
    v_mul_f32 v140, v1, v140
    v_mul_f32 v141, v1, v141
    v_mul_f32 v142, v1, v142
    v_mul_f32 v143, v1, v143
    v_mul_f32 v148, v1, v148
    v_mul_f32 v149, v1, v149
    v_mul_f32 v150, v1, v150
    v_mul_f32 v151, v1, v151
    v_mul_f32 v156, v1, v156
    v_mul_f32 v157, v1, v157
    v_mul_f32 v158, v1, v158
    v_mul_f32 v159, v1, v159
    v_mul_f32 v164, v1, v164
    v_mul_f32 v165, v1, v165
    v_mul_f32 v166, v1, v166
    v_mul_f32 v167, v1, v167
    v_mul_f32 v172, v1, v172
    v_mul_f32 v173, v1, v173
    v_mul_f32 v174, v1, v174
    v_mul_f32 v175, v1, v175
    v_mul_f32 v180, v1, v180
    v_mul_f32 v181, v1, v181
    v_mul_f32 v182, v1, v182
    v_mul_f32 v183, v1, v183
    v_mul_f32 v188, v1, v188
    v_mul_f32 v189, v1, v189
    v_mul_f32 v190, v1, v190
    v_mul_f32 v191, v1, v191
    v_mul_f32 v196, v1, v196
    v_mul_f32 v197, v1, v197
    v_mul_f32 v198, v1, v198
    v_mul_f32 v199, v1, v199
    v_mul_f32 v204, v1, v204
    v_mul_f32 v205, v1, v205
    v_mul_f32 v206, v1, v206
    v_mul_f32 v207, v1, v207
    v_mul_f32 v212, v1, v212
    v_mul_f32 v213, v1, v213
    v_mul_f32 v214, v1, v214
    v_mul_f32 v215, v1, v215
    v_mul_f32 v220, v1, v220
    v_mul_f32 v221, v1, v221
    v_mul_f32 v222, v1, v222
    v_mul_f32 v223, v1, v223
    v_mul_f32 v228, v1, v228
    v_mul_f32 v229, v1, v229
    v_mul_f32 v230, v1, v230
    v_mul_f32 v231, v1, v231
    v_mul_f32 v236, v1, v236
    v_mul_f32 v237, v1, v237
    v_mul_f32 v238, v1, v238
    v_mul_f32 v239, v1, v239
    v_mul_f32 v244, v1, v244
    v_mul_f32 v245, v1, v245
    v_mul_f32 v246, v1, v246
    v_mul_f32 v247, v1, v247
    v_mul_f32 v252, v1, v252
    v_mul_f32 v253, v1, v253
    v_mul_f32 v254, v1, v254
    v_mul_f32 v255, v1, v255
    v_exp_f32 v0, v96
    v_exp_f32 v1, v97
    v_exp_f32 v2, v98
    v_cvt_pk_bf16_f32 v80, v0, v1
    v_exp_f32 v3, v99
    v_exp_f32 v4, v100
    v_cvt_pk_bf16_f32 v81, v2, v3
    v_exp_f32 v5, v101
    v_exp_f32 v6, v102
    v_cvt_pk_bf16_f32 v82, v4, v5
    v_exp_f32 v7, v103
    v_exp_f32 v0, v104
    v_cvt_pk_bf16_f32 v83, v6, v7
    v_exp_f32 v1, v105
    v_exp_f32 v2, v106
    v_cvt_pk_bf16_f32 v84, v0, v1
    v_exp_f32 v3, v107
    v_exp_f32 v4, v108
    v_cvt_pk_bf16_f32 v85, v2, v3
    v_exp_f32 v5, v109
    v_exp_f32 v6, v110
    v_cvt_pk_bf16_f32 v86, v4, v5
    v_exp_f32 v7, v111
    s_nop 0
    v_cvt_pk_bf16_f32 v87, v6, v7
    v_mfma_f32_16x16x32_bf16 v[64:67], a[160:163], v[80:83], v[68:71]
    s_nop 0
    v_mfma_f32_16x16x32_bf16 v[64:67], a[164:167], v[84:87], v[64:67]
    s_nop 7
    s_nop 3
    s_setpc_b64 s[78:79]
L_rescale1:
    s_nop 15
    v_max3_f32 v62, v112, v113, v114
    v_max3_f32 v62, v62, v115, v116
    v_max3_f32 v62, v62, v117, v118
    v_max_f32 v62, v62, v119
    v_mov_b32 v0, v62
    s_nop 1
    v_permlane32_swap_b32 v62, v0
    v_max_f32 v62, v62, v0
    v_mov_b32 v0, v62
    s_nop 1
    v_permlane16_swap_b32 v62, v0
    v_max_f32 v62, v62, v0
    v_max_f32 v62, 0, v62
    v_exp_f32 v1, -v62
    v_sub_f32 v72, v72, v62
    v_sub_f32 v73, v73, v62
    v_sub_f32 v74, v74, v62
    v_sub_f32 v75, v75, v62
    v_sub_f32 v112, v112, v62
    v_sub_f32 v96, v96, v62
    v_sub_f32 v113, v113, v62
    v_sub_f32 v97, v97, v62
    v_sub_f32 v114, v114, v62
    v_sub_f32 v98, v98, v62
    v_sub_f32 v115, v115, v62
    v_sub_f32 v99, v99, v62
    v_sub_f32 v116, v116, v62
    v_sub_f32 v100, v100, v62
    v_sub_f32 v117, v117, v62
    v_sub_f32 v101, v101, v62
    v_sub_f32 v118, v118, v62
    v_sub_f32 v102, v102, v62
    v_sub_f32 v119, v119, v62
    v_sub_f32 v103, v103, v62
    s_mov_b32 exec_lo, 0xffff
    s_mov_b32 exec_hi, 0
    v_mul_f32 v64, v64, v1
    s_mov_b64 exec, -1
    v_mul_f32 v128, v1, v128
    v_mul_f32 v129, v1, v129
    v_mul_f32 v130, v1, v130
    v_mul_f32 v131, v1, v131
    v_mul_f32 v136, v1, v136
    v_mul_f32 v137, v1, v137
    v_mul_f32 v138, v1, v138
    v_mul_f32 v139, v1, v139
    v_mul_f32 v144, v1, v144
    v_mul_f32 v145, v1, v145
    v_mul_f32 v146, v1, v146
    v_mul_f32 v147, v1, v147
    v_mul_f32 v152, v1, v152
    v_mul_f32 v153, v1, v153
    v_mul_f32 v154, v1, v154
    v_mul_f32 v155, v1, v155
    v_mul_f32 v160, v1, v160
    v_mul_f32 v161, v1, v161
    v_mul_f32 v162, v1, v162
    v_mul_f32 v163, v1, v163
    v_mul_f32 v168, v1, v168
    v_mul_f32 v169, v1, v169
    v_mul_f32 v170, v1, v170
    v_mul_f32 v171, v1, v171
    v_mul_f32 v176, v1, v176
    v_mul_f32 v177, v1, v177
    v_mul_f32 v178, v1, v178
    v_mul_f32 v179, v1, v179
    v_mul_f32 v184, v1, v184
    v_mul_f32 v185, v1, v185
    v_mul_f32 v186, v1, v186
    v_mul_f32 v187, v1, v187
    v_mul_f32 v192, v1, v192
    v_mul_f32 v193, v1, v193
    v_mul_f32 v194, v1, v194
    v_mul_f32 v195, v1, v195
    v_mul_f32 v200, v1, v200
    v_mul_f32 v201, v1, v201
    v_mul_f32 v202, v1, v202
    v_mul_f32 v203, v1, v203
    v_mul_f32 v208, v1, v208
    v_mul_f32 v209, v1, v209
    v_mul_f32 v210, v1, v210
    v_mul_f32 v211, v1, v211
    v_mul_f32 v216, v1, v216
    v_mul_f32 v217, v1, v217
    v_mul_f32 v218, v1, v218
    v_mul_f32 v219, v1, v219
    v_mul_f32 v224, v1, v224
    v_mul_f32 v225, v1, v225
    v_mul_f32 v226, v1, v226
    v_mul_f32 v227, v1, v227
    v_mul_f32 v232, v1, v232
    v_mul_f32 v233, v1, v233
    v_mul_f32 v234, v1, v234
    v_mul_f32 v235, v1, v235
    v_mul_f32 v240, v1, v240
    v_mul_f32 v241, v1, v241
    v_mul_f32 v242, v1, v242
    v_mul_f32 v243, v1, v243
    v_mul_f32 v248, v1, v248
    v_mul_f32 v249, v1, v249
    v_mul_f32 v250, v1, v250
    v_mul_f32 v251, v1, v251
    v_max3_f32 v63, v120, v121, v122
    v_max3_f32 v63, v63, v123, v124
    v_max3_f32 v63, v63, v125, v126
    v_max_f32 v63, v63, v127
    v_mov_b32 v0, v63
    s_nop 1
    v_permlane32_swap_b32 v63, v0
    v_max_f32 v63, v63, v0
    v_mov_b32 v0, v63
    s_nop 1
    v_permlane16_swap_b32 v63, v0
    v_max_f32 v63, v63, v0
    v_max_f32 v63, 0, v63
    v_exp_f32 v1, -v63
    v_sub_f32 v76, v76, v63
    v_sub_f32 v77, v77, v63
    v_sub_f32 v78, v78, v63
    v_sub_f32 v79, v79, v63
    v_sub_f32 v120, v120, v63
    v_sub_f32 v104, v104, v63
    v_sub_f32 v121, v121, v63
    v_sub_f32 v105, v105, v63
    v_sub_f32 v122, v122, v63
    v_sub_f32 v106, v106, v63
    v_sub_f32 v123, v123, v63
    v_sub_f32 v107, v107, v63
    v_sub_f32 v124, v124, v63
    v_sub_f32 v108, v108, v63
    v_sub_f32 v125, v125, v63
    v_sub_f32 v109, v109, v63
    v_sub_f32 v126, v126, v63
    v_sub_f32 v110, v110, v63
    v_sub_f32 v127, v127, v63
    v_sub_f32 v111, v111, v63
    s_mov_b32 exec_lo, 0xffff0000
    s_mov_b32 exec_hi, 0
    v_mul_f32 v64, v64, v1
    s_mov_b64 exec, -1
    v_mul_f32 v132, v1, v132
    v_mul_f32 v133, v1, v133
    v_mul_f32 v134, v1, v134
    v_mul_f32 v135, v1, v135
    v_mul_f32 v140, v1, v140
    v_mul_f32 v141, v1, v141
    v_mul_f32 v142, v1, v142
    v_mul_f32 v143, v1, v143
    v_mul_f32 v148, v1, v148
    v_mul_f32 v149, v1, v149
    v_mul_f32 v150, v1, v150
    v_mul_f32 v151, v1, v151
    v_mul_f32 v156, v1, v156
    v_mul_f32 v157, v1, v157
    v_mul_f32 v158, v1, v158
    v_mul_f32 v159, v1, v159
    v_mul_f32 v164, v1, v164
    v_mul_f32 v165, v1, v165
    v_mul_f32 v166, v1, v166
    v_mul_f32 v167, v1, v167
    v_mul_f32 v172, v1, v172
    v_mul_f32 v173, v1, v173
    v_mul_f32 v174, v1, v174
    v_mul_f32 v175, v1, v175
    v_mul_f32 v180, v1, v180
    v_mul_f32 v181, v1, v181
    v_mul_f32 v182, v1, v182
    v_mul_f32 v183, v1, v183
    v_mul_f32 v188, v1, v188
    v_mul_f32 v189, v1, v189
    v_mul_f32 v190, v1, v190
    v_mul_f32 v191, v1, v191
    v_mul_f32 v196, v1, v196
    v_mul_f32 v197, v1, v197
    v_mul_f32 v198, v1, v198
    v_mul_f32 v199, v1, v199
    v_mul_f32 v204, v1, v204
    v_mul_f32 v205, v1, v205
    v_mul_f32 v206, v1, v206
    v_mul_f32 v207, v1, v207
    v_mul_f32 v212, v1, v212
    v_mul_f32 v213, v1, v213
    v_mul_f32 v214, v1, v214
    v_mul_f32 v215, v1, v215
    v_mul_f32 v220, v1, v220
    v_mul_f32 v221, v1, v221
    v_mul_f32 v222, v1, v222
    v_mul_f32 v223, v1, v223
    v_mul_f32 v228, v1, v228
    v_mul_f32 v229, v1, v229
    v_mul_f32 v230, v1, v230
    v_mul_f32 v231, v1, v231
    v_mul_f32 v236, v1, v236
    v_mul_f32 v237, v1, v237
    v_mul_f32 v238, v1, v238
    v_mul_f32 v239, v1, v239
    v_mul_f32 v244, v1, v244
    v_mul_f32 v245, v1, v245
    v_mul_f32 v246, v1, v246
    v_mul_f32 v247, v1, v247
    v_mul_f32 v252, v1, v252
    v_mul_f32 v253, v1, v253
    v_mul_f32 v254, v1, v254
    v_mul_f32 v255, v1, v255
    v_exp_f32 v0, v112
    v_exp_f32 v1, v113
    v_exp_f32 v2, v114
    v_cvt_pk_bf16_f32 v88, v0, v1
    v_exp_f32 v3, v115
    v_exp_f32 v4, v116
    v_cvt_pk_bf16_f32 v89, v2, v3
    v_exp_f32 v5, v117
    v_exp_f32 v6, v118
    v_cvt_pk_bf16_f32 v90, v4, v5
    v_exp_f32 v7, v119
    v_exp_f32 v0, v120
    v_cvt_pk_bf16_f32 v91, v6, v7
    v_exp_f32 v1, v121
    v_exp_f32 v2, v122
    v_cvt_pk_bf16_f32 v92, v0, v1
    v_exp_f32 v3, v123
    v_exp_f32 v4, v124
    v_cvt_pk_bf16_f32 v93, v2, v3
    v_exp_f32 v5, v125
    v_exp_f32 v6, v126
    v_cvt_pk_bf16_f32 v94, v4, v5
    v_exp_f32 v7, v127
    s_nop 0
    v_cvt_pk_bf16_f32 v95, v6, v7
    v_mfma_f32_16x16x32_bf16 v[68:71], a[160:163], v[88:91], v[64:67]
    s_nop 0
    v_mfma_f32_16x16x32_bf16 v[68:71], a[164:167], v[92:95], v[68:71]
    s_nop 7
    s_nop 3
    s_setpc_b64 s[78:79]
L_codeend:
.section .rodata,"a"
.p2align 6
.amdhsa_kernel concat_heads__gqa_block_cached__mha_block_cached__near_ridge_kernel
  .amdhsa_next_free_vgpr 512
  .amdhsa_next_free_sgpr 102
  .amdhsa_accum_offset 256
  .amdhsa_group_segment_fixed_size 0
  .amdhsa_kernarg_size 104
  .amdhsa_user_sgpr_count 2
  .amdhsa_user_sgpr_kernarg_segment_ptr 1
  .amdhsa_system_sgpr_workgroup_id_x 1
.end_amdhsa_kernel
```
